```python
import torch

def _softmax(x, axis=-1):
    return torch.softmax(x, dim=axis)
def _gelu(x):
    return torch.nn.functional.gelu(x, approximate="tanh")
def _silu(x):
    return torch.nn.functional.silu(x)
def _sigmoid(x):
    return torch.sigmoid(x)
def _layernorm(x, axis=-1, eps=1e-5):
    m = x.mean(dim=axis, keepdim=True)
    v = x.var(dim=axis, keepdim=True, unbiased=False)
    return (x - m) / torch.sqrt(v + eps)
def _scatter_add(tgt, idx, src, axis=0):
    return tgt.clone().index_add_(axis, idx, src)
def _segment_sum(src, seg, n):
    out = torch.zeros((n,) + src.shape[1:], dtype=src.dtype)
    return out.index_add_(0, seg, src)
def _pad(x, pw):
    flat = tuple(v for pair in reversed(pw) for v in pair)
    return torch.nn.functional.pad(x, flat)

kernel_name = 'gated_mix__spectral_gfnet__glu_gated_geglu__prompt'

def setup_inputs():

    _w = (lambda a: (lambda t: t.to(torch.bfloat16) if t.is_floating_point() else t)(torch.as_tensor(a)))
    def _A_setup():
        B, S, D = 1, 2048, 576
        Df = D // 2 + 1
        return {
            "x": _w((lambda *s: torch.randn(*s, dtype=torch.bfloat16) * 0.05)(B, S, D)),
            "w_r": _w((lambda *s: torch.randn(*s, dtype=torch.bfloat16) * 0.05)(S, Df) * 0.02),
            "w_i": _w((lambda *s: torch.randn(*s, dtype=torch.bfloat16) * 0.05)(S, Df) * 0.02),
        }
    _A_in = _A_setup()

    def _B_setup():
        B, S, Dm, Df = 1, 2048, 576, 4608
        return {
            "x": _w((lambda *s: torch.randn(*s, dtype=torch.bfloat16) * 0.05)(B, S, Dm)),
            "w_gate": _w((lambda *s: torch.randn(*s, dtype=torch.bfloat16) * 0.2)(Dm, Df) * (Dm ** -0.5)),
            "w_up": _w((lambda *s: torch.randn(*s, dtype=torch.bfloat16) * 0.2)(Dm, Df) * (Dm ** -0.5)),
            "w_down": _w((lambda *s: torch.randn(*s, dtype=torch.bfloat16) * 0.2)(Df, Dm) * (Df ** -0.5)),
        }
    _B_in = _B_setup()

    return {
        "A_x": _A_in["x"],
        "A_w_r": _A_in["w_r"],
        "A_w_i": _A_in["w_i"],
        "B_x": _B_in["x"],
        "B_w_gate": _B_in["w_gate"],
        "B_w_up": _B_in["w_up"],
        "B_w_down": _B_in["w_down"],
        "gate_w": _w((lambda *s: torch.randn(*s, dtype=torch.bfloat16) * 0.05)(576) * 16.0),
    }

def reference(A_x, A_w_r, A_w_i, B_x, B_w_gate, B_w_up, B_w_down, gate_w):
    def _A_ref(x, w_r, w_i):
        B, S, D = x.shape
        X = (lambda x, axes=(-2,-1): torch.fft.rfft2(x.float(), dim=axes))(x, axes=(-2, -1))
        W = w_r + 1j * w_i
        X = X * W
        y = (lambda x, s, axes=(-2,-1): torch.fft.irfft2(x, s=s, dim=axes).to(torch.bfloat16))(X, (S, D), axes=(-2, -1))
        return y

    def _B_ref(x, w_gate, w_up, w_down):
        g = torch.einsum("bsd,df->bsf", x, w_gate)
        u = torch.einsum("bsd,df->bsf", x, w_up)
        h = _gelu(g) * u
        return torch.einsum("bsf,fd->bsd", h, w_down)

    x = A_x
    g = _sigmoid((x * gate_w).sum(-1, keepdims=True))
    a = _A_ref(x, A_w_r, A_w_i)
    b = _B_ref(x, B_w_gate, B_w_up, B_w_down)
    return g * a + (1 - g) * b
```

```asm
; @launch grid=(256,1,1) block=(256,1,1) lds=163840
.amdgcn_target "amdgcn-amd-amdhsa--gfx950"
.text
.globl gated_mix__spectral_gfnet__glu_gated_geglu__prompt_kernel
.p2align 8
.type gated_mix__spectral_gfnet__glu_gated_geglu__prompt_kernel,@function
gated_mix__spectral_gfnet__glu_gated_geglu__prompt_kernel:
    s_cmp_ge_u32 s2, 256
    s_cbranch_scc1 gated_mix__spectral_gfnet__glu_gated_geglu__prompt_kernel_end
    s_load_dwordx2 s[64:65], s[0:1], 0
    s_load_dwordx4 s[68:71], s[0:1], 32
    s_load_dwordx4 s[72:75], s[0:1], 72
    s_load_dwordx2 s[76:77], s[0:1], 56
    s_load_dwordx2 s[78:79], s[0:1], 48
    s_load_dwordx2 s[88:89], s[0:1], 8
    s_load_dwordx2 s[92:93], s[0:1], 16
    v_mov_b32 v242, v0
    v_and_b32 v241, 63, v0
    v_readfirstlane_b32 s3, v0
    v_lshrrev_b32 v104, 3, v241
    v_and_b32 v105, 7, v241
    v_lshrrev_b32 v106, 4, v241
    s_lshr_b32 s3, s3, 6
    s_and_b32 s44, s2, 7
    s_lshr_b32 s45, s2, 3
    s_and_b32 s6, s44, 1
    s_lshl_b32 s6, s6, 3
    s_and_b32 s46, s45, 7
    s_add_u32 s6, s6, s46
    s_lshr_b32 s7, s44, 1
    s_lshl_b32 s7, s7, 2
    s_lshr_b32 s46, s45, 3
    s_add_u32 s7, s7, s46
    s_lshr_b32 s42, s7, 1
    s_mul_i32 s43, s42, 9
    s_and_b32 s62, s7, 1
    s_mul_i32 s45, s62, 5
    s_add_u32 s43, s43, s45
    v_and_b32 v107, 3, v106
    v_xor_b32 v107, v107, v105
    v_lshlrev_b32 v107, 4, v107
    v_mul_u32_u24 v128, 1152, v104
    v_add_u32 v128, v128, v107
    v_xor_b32 v129, 64, v128
    v_and_b32 v107, 1, v106
    v_lshlrev_b32 v107, 2, v107
    v_xor_b32 v107, v107, v105
    v_lshlrev_b32 v108, 4, v107
    v_xor_b32 v109, 32, v108
    v_mul_u32_u24 v110, 9216, v104
    s_lshl_b32 s44, s43, 7
    v_add_u32 v110, s44, v110
    v_add_u32 v130, v110, v108
    v_add_u32 v131, v110, v109
    v_add_u32 v200, 128, v130
    v_add_u32 v201, 128, v131
    s_mul_i32 s54, s6, 147456
    s_mul_i32 s55, s3, 36864
    s_add_u32 s54, s54, s55
    s_add_u32 s44, s54, 0
    s_add_u32 s45, s54, 8192
    s_add_u32 s46, s54, 16384
    s_add_u32 s47, s54, 24576
    s_mul_i32 s48, s3, 147456
    s_add_u32 s49, s48, 72704
    s_lshl_b32 s52, s3, 12
    s_lshl_b32 s53, s3, 11
    s_lshl_b32 s54, s2, 8
    v_add_u32 v64, s54, v242
    s_mov_b32 s55, 0x3333334
    v_mul_hi_u32 v65, v64, s55
    v_lshlrev_b32 v67, 1, v65
    s_waitcnt lgkmcnt(0)
    s_mov_b32 s8, s64
    s_mov_b32 s9, s65
    s_mov_b32 s10, 2359296
    s_mov_b32 s11, 0x20000
    s_mov_b32 s12, s68
    s_mov_b32 s13, s69
    s_mov_b32 s14, 5308416
    s_mov_b32 s15, 0x20000
    s_mov_b32 s16, s70
    s_mov_b32 s17, s71
    s_mov_b32 s18, 5308416
    s_mov_b32 s19, 0x20000
    s_mov_b32 s56, s76
    s_mov_b32 s57, s77
    s_mov_b32 s58, 1152
    s_mov_b32 s59, 0x20000
    buffer_load_ushort v68, v67, s[56:59], 0 offen
    s_cmp_lt_u32 s3, 2
    s_cselect_b32 s84, s12, s16
    s_cselect_b32 s85, s13, s17
    s_mov_b32 s86, 5308416
    s_mov_b32 s87, 0x20000
    s_lshr_b32 s54, s2, 3
    s_and_b32 s55, s54, 7
    s_mul_i32 s55, s55, 72
    s_and_b32 s63, s3, 1
    s_mul_i32 s63, s63, 36
    s_add_u32 s55, s55, s63
    v_min_u32 v245, 35, v241
    v_add_u32 v245, s55, v245
    v_mul_u32_u24 v245, 9216, v245
    s_lshl_b32 s55, s43, 7
    v_add_u32 v245, s55, v245
    s_lshr_b32 s54, s54, 3
    s_lshl_b32 s54, s54, 5
    s_lshl_b32 s55, s3, 3
    s_add_u32 s54, s54, s55
    s_lshl_b32 s55, s6, 7
    s_add_u32 s54, s54, s55
    s_mul_i32 s54, s54, 1152
    v_mul_u32_u24 v107, 1152, v104
    v_lshlrev_b32 v108, 7, v105
    v_add_u32 v107, v107, v108
    s_add_u32 m0, s52, 0
    s_nop 0
    buffer_load_dwordx4 v128, s[8:11], s44 offen offset:0 lds
    buffer_load_dwordx4 v129, s[8:11], s45 offen offset:1024 lds
    buffer_load_dwordx4 v128, s[8:11], s46 offen offset:2048 lds
    buffer_load_dwordx4 v129, s[8:11], s47 offen offset:3072 lds
    s_add_u32 m0, s53, 16384
    s_nop 0
    buffer_load_dwordx4 v130, s[12:15], s48 offen offset:0 lds
    buffer_load_dwordx4 v130, s[12:15], s49 offen offset:1024 lds
    s_add_u32 m0, s53, 24576
    s_nop 0
    buffer_load_dwordx4 v131, s[16:19], s48 offen offset:0 lds
    buffer_load_dwordx4 v131, s[16:19], s49 offen offset:1024 lds
    v_add_u32 v128, 128, v128
    v_add_u32 v129, 128, v129
    v_add_u32 v130, 589824, v130
    v_add_u32 v131, 589824, v131
    s_add_u32 m0, s52, 32768
    s_nop 0
    buffer_load_dwordx4 v128, s[8:11], s44 offen offset:0 lds
    buffer_load_dwordx4 v129, s[8:11], s45 offen offset:1024 lds
    buffer_load_dwordx4 v128, s[8:11], s46 offen offset:2048 lds
    buffer_load_dwordx4 v129, s[8:11], s47 offen offset:3072 lds
    s_add_u32 m0, s53, 49152
    s_nop 0
    buffer_load_dwordx4 v130, s[12:15], s48 offen offset:0 lds
    buffer_load_dwordx4 v130, s[12:15], s49 offen offset:1024 lds
    s_add_u32 m0, s53, 57344
    s_nop 0
    buffer_load_dwordx4 v131, s[16:19], s48 offen offset:0 lds
    buffer_load_dwordx4 v131, s[16:19], s49 offen offset:1024 lds
    v_add_u32 v128, 128, v128
    v_add_u32 v129, 128, v129
    v_add_u32 v130, 589824, v130
    v_add_u32 v131, 589824, v131
    s_lshr_b32 s64, s2, 6
    s_lshl_b32 s64, s64, 5
    s_lshl_b32 s65, s3, 3
    s_add_u32 s64, s64, s65
    s_lshl_b32 s65, s6, 7
    s_add_u32 s64, s64, s65
    s_mul_i32 s64, s64, 1152
    s_add_u32 s64, s64, 256
    v_min_u32 v112, 55, v241
    s_mov_b32 s65, 0x24924925
    v_mul_hi_u32 v113, v112, s65
    v_mul_u32_u24 v114, 7, v113
    v_sub_u32 v114, v112, v114
    v_mul_u32_u24 v113, 1152, v113
    v_lshl_add_u32 v113, v114, 7, v113
    buffer_load_dword v246, v113, s[8:11], s64 offen
    s_lshr_b32 s64, s2, 3
    s_and_b32 s64, s64, 7
    s_mul_i32 s64, s64, 56
    s_and_b32 s65, s3, 1
    s_mul_i32 s65, s65, 28
    s_add_u32 s64, s64, s65
    s_add_u32 s64, s64, 128
    s_mul_i32 s64, s64, 9216
    s_lshl_b32 s65, s43, 7
    s_add_u32 s64, s64, s65
    v_min_u32 v112, 27, v241
    v_mul_u32_u24 v112, 9216, v112
    buffer_load_dword v246, v112, s[84:87], s64 offen
    buffer_load_dword v246, v245, s[84:87], 0 offen offset:128
    s_mov_b32 s20, s74
    s_mov_b32 s21, s75
    s_mov_b32 s22, 268435456
    s_mov_b32 s23, 0x20000
    s_mov_b32 s24, s72
    s_mov_b32 s25, s73
    s_mov_b32 s26, 256
    s_mov_b32 s27, 0x20000
    s_mov_b32 s90, 1183744
    s_mov_b32 s91, 0x20000
    s_mov_b32 s94, 1183744
    s_mov_b32 s95, 0x20000
    s_lshr_b32 s4, s3, 1
    s_and_b32 s5, s3, 1
    s_cmp_lt_u32 s42, 5
    s_cselect_b32 s41, 1, 2
    s_cmp_eq_u32 s62, 0
    s_cselect_b32 s41, 0, s41
    s_mul_i32 s54, s3, 442368
    s_add_u32 s28, s54, 0
    s_add_u32 s29, s54, 72704
    s_add_u32 s30, s54, 145408
    s_add_u32 s31, s54, 218112
    s_add_u32 s32, s54, 294912
    s_add_u32 s33, s54, 367616
    s_mul_i32 s34, s3, 6144
    s_mov_b32 s35, 1769472
    s_mov_b32 s38, 98304
    s_mov_b32 s40, 1
    s_lshl_b32 s54, s6, 2
    s_lshl_b32 s55, s4, 1
    s_add_u32 s54, s54, s55
    s_mul_i32 s54, s54, 288
    s_lshl_b32 s55, s43, 2
    s_add_u32 s54, s54, s55
    s_lshl_b32 s55, s5, 1
    s_add_u32 s54, s54, s55
    s_lshl_b32 s36, s54, 10
    s_add_u32 s37, s36, 294912
    v_lshlrev_b32 v206, 4, v241
    v_mov_b32 v207, 0xbdd2d3e8
    v_mov_b32 v243, 0
    v_mov_b32 v232, -1
    v_mov_b32 v233, -1
    v_mov_b32 v234, -1
    v_mov_b32 v235, -1
    s_and_b32 s54, s2, 7
    s_mul_i32 s55, s54, 24
    s_lshr_b32 s60, s2, 3
    s_add_u32 s55, s55, s60
    s_lshl_b32 s54, s54, 3
    s_add_u32 s54, s54, s60
    s_sub_u32 s54, s54, 24
    s_lshl_b32 s54, s54, 2
    s_add_u32 s56, s54, 37789696
    s_mul_hi_u32 s54, s55, 0x5555556
    s_mul_i32 s61, s54, 48
    s_sub_u32 s55, s55, s61
    s_lshl_b32 s61, s55, 5
    s_add_u32 s61, s61, s54
    s_lshl_b32 s61, s61, 2
    s_add_u32 s61, s61, 37773312
    s_mul_hi_u32 s100, s55, 0x55555556
    s_mul_i32 s57, s100, 3
    s_sub_u32 s55, s55, s57
    s_lshl_b32 s100, s100, 2
    s_add_u32 s100, s100, s3
    s_lshl_b32 s54, s54, 6
    s_add_u32 s100, s100, s54
    s_mul_i32 s100, s100, 18
    s_mul_i32 s55, s55, 6
    s_add_u32 s100, s100, s55
    s_lshl_b32 s100, s100, 11
    s_add_u32 s100, s100, 27852800
    s_mov_b32 s55, 1073741824
    s_cmp_lt_u32 s60, 24
    s_cselect_b32 s61, s61, s55
    s_cselect_b32 s100, s100, s55
    s_cselect_b32 s56, s55, s56
    s_lshl_b32 s54, s6, 2
    s_lshr_b32 s60, s7, 2
    s_add_u32 s54, s54, s60
    s_lshl_b32 s54, s54, 5
    s_and_b32 s60, s7, 3
    s_add_u32 s54, s54, s60
    s_lshl_b32 s54, s54, 2
    s_add_u32 s54, s54, 37765120
    s_lshl_b32 s60, s6, 3
    s_add_u32 s60, s60, s42
    s_lshl_b32 s60, s60, 2
    s_add_u32 s60, s60, 37781504
    s_bitcmp1_b32 s7, 0
    s_cselect_b32 s60, s60, s55
    v_subrev_u32 v116, 2, v241
    v_lshlrev_b32 v116, 9, v116
    v_add_u32 v236, s60, v116
    v_subrev_u32 v116, 10, v241
    v_lshlrev_b32 v116, 8, v116
    v_add_u32 v116, s56, v116
    v_cmp_le_u32 vcc, 10, v241
    s_nop 1
    v_cndmask_b32 v236, v236, v116, vcc
    v_mov_b32 v116, s54
    v_cmp_eq_u32 vcc, 0, v241
    s_nop 1
    v_cndmask_b32 v236, v236, v116, vcc
    v_mov_b32 v116, s61
    v_cmp_eq_u32 vcc, 1, v241
    s_nop 1
    v_cndmask_b32 v236, v236, v116, vcc
    v_and_b32 v104, 3, v241
    v_bfe_u32 v105, v241, 2, 2
    v_lshrrev_b32 v106, 4, v241
    v_lshrrev_b32 v107, 1, v106
    v_lshlrev_b32 v107, 3, v107
    v_add_u32 v107, v107, v105
    v_lshlrev_b32 v107, 7, v107
    v_and_b32 v108, 1, v106
    v_lshrrev_b32 v109, 1, v104
    v_lshlrev_b32 v110, 1, v109
    v_xor_b32 v108, v108, v110
    v_lshrrev_b32 v110, 1, v105
    v_lshlrev_b32 v110, 2, v110
    v_xor_b32 v108, v108, v110
    s_lshl_b32 s54, s5, 2
    v_xor_b32 v108, s54, v108
    v_lshlrev_b32 v108, 4, v108
    v_add_u32 v107, v107, v108
    v_and_b32 v108, 1, v104
    v_lshlrev_b32 v108, 3, v108
    v_add_u32 v107, v107, v108
    v_mul_u32_u24 v108, 8192, v109
    v_add_u32 v140, v107, v108
    v_xor_b32 v141, 32, v140
    v_mul_u32_u24 v108, 24576, v109
    v_add_u32 v204, v107, v108
    v_xor_b32 v205, 32, v204
    v_and_b32 v107, 31, v241
    v_lshrrev_b32 v108, 5, v241
    v_bfe_u32 v110, v241, 1, 3
    v_xor_b32 v108, v108, v110
    v_lshlrev_b32 v108, 4, v108
    s_lshl_b32 s54, s4, 6
    v_add_u32 v107, s54, v107
    v_lshlrev_b32 v107, 7, v107
    v_add_u32 v132, v107, v108
    v_xor_b32 v133, 32, v132
    v_xor_b32 v134, 64, v132
    v_xor_b32 v135, 96, v132
    s_mov_b32 s64, 18874368
    s_mul_i32 s65, s2, 162
    s_mov_b32 s66, 0x71c71c8
    s_mov_b32 s67, 24772608
    s_cmp_eq_u32 s3, 0
    s_cbranch_scc0 gated_mix__spectral_gfnet__glu_gated_geglu__prompt_kernel_nofl
    v_cmp_gt_u32 vcc, 18, v241
    s_and_saveexec_b64 s[60:61], vcc
    buffer_store_dword v243, v236, s[20:23], 0 offen sc1
    s_mov_b64 exec, s[60:61]
gated_mix__spectral_gfnet__glu_gated_geglu__prompt_kernel_nofl:
gated_mix__spectral_gfnet__glu_gated_geglu__prompt_kernel_q0:
    s_waitcnt vmcnt(11)
    s_barrier
    v_add_u32 v136, 0, v132
    v_add_u32 v137, 0, v133
    v_add_u32 v138, 0, v134
    v_add_u32 v139, 0, v135
    v_add_u32 v142, 16384, v140
    v_add_u32 v143, 16384, v141
    ds_read_b128 a[0:3], v136 offset:0
    ds_read_b128 a[144:147], v136 offset:4096
    ds_read_b64_tr_b16 v[208:209], v142 offset:0
    ds_read_b64_tr_b16 v[210:211], v142 offset:512
    ds_read_b128 a[4:7], v137 offset:0
    ds_read_b128 a[148:151], v137 offset:4096
    ds_read_b64_tr_b16 v[212:213], v142 offset:2048
    ds_read_b64_tr_b16 v[214:215], v142 offset:2560
    ds_read_b128 a[8:11], v138 offset:0
    ds_read_b128 a[152:155], v138 offset:4096
    ds_read_b64_tr_b16 v[216:217], v142 offset:4096
    ds_read_b64_tr_b16 v[218:219], v142 offset:4608
    ds_read_b128 a[12:15], v139 offset:0
    ds_read_b128 a[156:159], v139 offset:4096
    ds_read_b64_tr_b16 v[220:221], v142 offset:6144
    ds_read_b64_tr_b16 v[222:223], v142 offset:6656
    s_waitcnt lgkmcnt(12)
    v_mfma_f32_32x32x16_bf16 v[0:15], v[208:211], a[0:3], 0
    s_add_u32 m0, s52, 65536
    ds_read_b64_tr_b16 v[224:225], v143 offset:0
    ds_read_b64_tr_b16 v[226:227], v143 offset:512
    buffer_load_dwordx4 v128, s[8:11], s44 offen offset:0 lds
    v_mul_u32_u24 v66, 80, v65
    v_mfma_f32_32x32x16_bf16 v[16:31], v[208:211], a[144:147], 0
    buffer_load_dwordx4 v129, s[8:11], s45 offen offset:1024 lds
    v_sub_u32 v66, v64, v66
    v_lshlrev_b32 v66, 3, v66
    v_mov_b32 v78, 0x3e800000
    v_mov_b32 v79, 0x3ae38e39
    s_waitcnt lgkmcnt(10)
    v_mfma_f32_32x32x16_bf16 v[0:15], v[212:215], a[4:7], v[0:15]
    ds_read_b64_tr_b16 v[228:229], v143 offset:2048
    ds_read_b64_tr_b16 v[230:231], v143 offset:2560
    buffer_load_dwordx4 v128, s[8:11], s46 offen offset:2048 lds
    v_add_u32 v72, 0, v66
    v_mfma_f32_32x32x16_bf16 v[16:31], v[212:215], a[148:151], v[16:31]
    buffer_load_dwordx4 v129, s[8:11], s47 offen offset:3072 lds
    v_cmp_lt_u32 vcc, 288, v72
    v_subrev_u32 v73, 288, v72
    v_mov_b32 v74, 0
    v_cndmask_b32 v73, v72, v73, vcc
    v_cndmask_b32 v74, v74, v78, vcc
    s_waitcnt lgkmcnt(8)
    v_mfma_f32_32x32x16_bf16 v[0:15], v[216:219], a[8:11], v[0:15]
    s_add_u32 m0, s53, 81920
    ds_read_b64_tr_b16 v[208:209], v143 offset:4096
    ds_read_b64_tr_b16 v[210:211], v143 offset:4608
    buffer_load_dwordx4 v130, s[12:15], s48 offen offset:0 lds
    v_mul_u32_u24 v73, v73, v65
    v_mfma_f32_32x32x16_bf16 v[16:31], v[216:219], a[152:155], v[16:31]
    buffer_load_dwordx4 v130, s[12:15], s49 offen offset:1024 lds
    v_cvt_f32_u32 v73, v73
    v_fmac_f32 v74, v79, v73
    v_fract_f32 v74, v74
    s_waitcnt lgkmcnt(6)
    v_mfma_f32_32x32x16_bf16 v[0:15], v[220:223], a[12:15], v[0:15]
    s_add_u32 m0, s53, 90112
    ds_read_b64_tr_b16 v[212:213], v143 offset:6144
    ds_read_b64_tr_b16 v[214:215], v143 offset:6656
    buffer_load_dwordx4 v131, s[16:19], s48 offen offset:0 lds
    v_cos_f32 v75, v74
    s_nop 0
    v_mfma_f32_32x32x16_bf16 v[16:31], v[220:223], a[156:159], v[16:31]
    v_add_u32 v136, 32768, v132
    v_add_u32 v137, 32768, v133
    v_add_u32 v138, 32768, v134
    v_add_u32 v139, 32768, v135
    v_add_u32 v142, 49152, v140
    v_add_u32 v143, 49152, v141
    buffer_load_dwordx4 v131, s[16:19], s49 offen offset:1024 lds
    v_add_u32 v128, 128, v128
    v_add_u32 v129, 128, v129
    v_add_u32 v130, 589824, v130
    v_add_u32 v131, 589824, v131
    s_waitcnt lgkmcnt(6)
    v_mfma_f32_32x32x16_bf16 v[32:47], v[224:227], a[0:3], 0
    s_add_u32 m0, s52, 98304
    s_waitcnt vmcnt(11) lgkmcnt(0)
    s_barrier
    ds_read_b64_tr_b16 v[216:217], v142 offset:0
    ds_read_b64_tr_b16 v[218:219], v142 offset:512
    buffer_load_dwordx4 v128, s[8:11], s44 offen offset:0 lds
    v_mfma_f32_32x32x16_bf16 v[48:63], v[224:227], a[144:147], 0
    ds_read_b128 a[16:19], v136 offset:0
    ds_read_b128 a[160:163], v136 offset:4096
    buffer_load_dwordx4 v129, s[8:11], s45 offen offset:1024 lds
    v_add_u32 v72, 1, v66
    v_mfma_f32_32x32x16_bf16 v[32:47], v[228:231], a[4:7], v[32:47]
    ds_read_b64_tr_b16 v[220:221], v142 offset:2048
    ds_read_b64_tr_b16 v[222:223], v142 offset:2560
    buffer_load_dwordx4 v128, s[8:11], s46 offen offset:2048 lds
    v_cmp_lt_u32 vcc, 288, v72
    v_subrev_u32 v73, 288, v72
    v_mov_b32 v74, 0
    v_cndmask_b32 v73, v72, v73, vcc
    v_cndmask_b32 v74, v74, v78, vcc
    v_mfma_f32_32x32x16_bf16 v[48:63], v[228:231], a[148:151], v[48:63]
    ds_read_b128 a[20:23], v137 offset:0
    ds_read_b128 a[164:167], v137 offset:4096
    buffer_load_dwordx4 v129, s[8:11], s47 offen offset:3072 lds
    v_mfma_f32_32x32x16_bf16 v[32:47], v[208:211], a[8:11], v[32:47]
    s_add_u32 m0, s53, 114688
    ds_read_b64_tr_b16 v[224:225], v142 offset:4096
    ds_read_b64_tr_b16 v[226:227], v142 offset:4608
    buffer_load_dwordx4 v130, s[12:15], s48 offen offset:0 lds
    v_mul_u32_u24 v73, v73, v65
    v_cvt_f32_u32 v73, v73
    v_mfma_f32_32x32x16_bf16 v[48:63], v[208:211], a[152:155], v[48:63]
    ds_read_b128 a[24:27], v138 offset:0
    ds_read_b128 a[168:171], v138 offset:4096
    buffer_load_dwordx4 v130, s[12:15], s49 offen offset:1024 lds
    v_fmac_f32 v74, v79, v73
    v_fract_f32 v74, v74
    v_mfma_f32_32x32x16_bf16 v[32:47], v[212:215], a[12:15], v[32:47]
    s_add_u32 m0, s53, 122880
    ds_read_b64_tr_b16 v[228:229], v142 offset:6144
    ds_read_b64_tr_b16 v[230:231], v142 offset:6656
    buffer_load_dwordx4 v131, s[16:19], s48 offen offset:0 lds
    v_mfma_f32_32x32x16_bf16 v[48:63], v[212:215], a[156:159], v[48:63]
    ds_read_b128 a[28:31], v139 offset:0
    ds_read_b128 a[172:175], v139 offset:4096
    buffer_load_dwordx4 v131, s[16:19], s49 offen offset:1024 lds
    v_add_u32 v128, 128, v128
    v_add_u32 v129, 128, v129
    v_add_u32 v130, 589824, v130
    v_add_u32 v131, 589824, v131
    s_waitcnt lgkmcnt(12)
    v_mfma_f32_32x32x16_bf16 v[0:15], v[216:219], a[16:19], v[0:15]
    s_add_u32 m0, s52, 131072
    ds_read_b64_tr_b16 v[208:209], v143 offset:0
    ds_read_b64_tr_b16 v[210:211], v143 offset:512
    buffer_load_dwordx4 v128, s[8:11], s44 offen offset:0 lds
    v_cos_f32 v76, v74
    s_nop 0
    v_mfma_f32_32x32x16_bf16 v[16:31], v[216:219], a[160:163], v[16:31]
    buffer_load_dwordx4 v129, s[8:11], s45 offen offset:1024 lds
    v_cvt_pk_bf16_f32 v80, v75, v76
    v_add_u32 v72, 2, v66
    s_waitcnt lgkmcnt(10)
    v_mfma_f32_32x32x16_bf16 v[0:15], v[220:223], a[20:23], v[0:15]
    ds_read_b64_tr_b16 v[212:213], v143 offset:2048
    ds_read_b64_tr_b16 v[214:215], v143 offset:2560
    buffer_load_dwordx4 v128, s[8:11], s46 offen offset:2048 lds
    v_cmp_lt_u32 vcc, 288, v72
    v_subrev_u32 v73, 288, v72
    v_mov_b32 v74, 0
    v_cndmask_b32 v73, v72, v73, vcc
    v_cndmask_b32 v74, v74, v78, vcc
    v_mfma_f32_32x32x16_bf16 v[16:31], v[220:223], a[164:167], v[16:31]
    buffer_load_dwordx4 v129, s[8:11], s47 offen offset:3072 lds
    v_mul_u32_u24 v73, v73, v65
    v_cvt_f32_u32 v73, v73
    s_waitcnt lgkmcnt(8)
    v_mfma_f32_32x32x16_bf16 v[0:15], v[224:227], a[24:27], v[0:15]
    s_add_u32 m0, s53, 147456
    ds_read_b64_tr_b16 v[216:217], v143 offset:4096
    ds_read_b64_tr_b16 v[218:219], v143 offset:4608
    buffer_load_dwordx4 v130, s[12:15], s48 offen offset:0 lds
    v_fmac_f32 v74, v79, v73
    v_mfma_f32_32x32x16_bf16 v[16:31], v[224:227], a[168:171], v[16:31]
    buffer_load_dwordx4 v130, s[12:15], s49 offen offset:1024 lds
    v_fract_f32 v74, v74
    v_cos_f32 v75, v74
    s_nop 0
    s_waitcnt lgkmcnt(6)
    v_mfma_f32_32x32x16_bf16 v[0:15], v[228:231], a[28:31], v[0:15]
    s_add_u32 m0, s53, 155648
    ds_read_b64_tr_b16 v[220:221], v143 offset:6144
    ds_read_b64_tr_b16 v[222:223], v143 offset:6656
    buffer_load_dwordx4 v131, s[16:19], s48 offen offset:0 lds
    v_add_u32 v72, 3, v66
    v_mfma_f32_32x32x16_bf16 v[16:31], v[228:231], a[172:175], v[16:31]
    v_add_u32 v136, 65536, v132
    v_add_u32 v137, 65536, v133
    v_add_u32 v138, 65536, v134
    v_add_u32 v139, 65536, v135
    v_add_u32 v142, 81920, v140
    v_add_u32 v143, 81920, v141
    buffer_load_dwordx4 v131, s[16:19], s49 offen offset:1024 lds
    v_add_u32 v128, 128, v128
    v_add_u32 v129, 128, v129
    v_add_u32 v130, 589824, v130
    v_add_u32 v131, 589824, v131
    s_waitcnt lgkmcnt(6)
    v_mfma_f32_32x32x16_bf16 v[32:47], v[208:211], a[16:19], v[32:47]
    s_add_u32 m0, s52, 0
    s_waitcnt vmcnt(16) lgkmcnt(0)
    s_barrier
    ds_read_b64_tr_b16 v[224:225], v142 offset:0
    ds_read_b64_tr_b16 v[226:227], v142 offset:512
    buffer_load_dwordx4 v128, s[8:11], s44 offen offset:0 lds
    v_mfma_f32_32x32x16_bf16 v[48:63], v[208:211], a[160:163], v[48:63]
    ds_read_b128 a[32:35], v136 offset:0
    ds_read_b128 a[176:179], v136 offset:4096
    buffer_load_dwordx4 v129, s[8:11], s45 offen offset:1024 lds
    v_cmp_lt_u32 vcc, 288, v72
    v_subrev_u32 v73, 288, v72
    v_mov_b32 v74, 0
    v_cndmask_b32 v73, v72, v73, vcc
    v_cndmask_b32 v74, v74, v78, vcc
    v_mfma_f32_32x32x16_bf16 v[32:47], v[212:215], a[20:23], v[32:47]
    ds_read_b64_tr_b16 v[228:229], v142 offset:2048
    ds_read_b64_tr_b16 v[230:231], v142 offset:2560
    buffer_load_dwordx4 v128, s[8:11], s46 offen offset:2048 lds
    v_mfma_f32_32x32x16_bf16 v[48:63], v[212:215], a[164:167], v[48:63]
    ds_read_b128 a[36:39], v137 offset:0
    ds_read_b128 a[180:183], v137 offset:4096
    buffer_load_dwordx4 v129, s[8:11], s47 offen offset:3072 lds
    v_mul_u32_u24 v73, v73, v65
    v_cvt_f32_u32 v73, v73
    v_fmac_f32 v74, v79, v73
    v_mfma_f32_32x32x16_bf16 v[32:47], v[216:219], a[24:27], v[32:47]
    s_add_u32 m0, s53, 16384
    ds_read_b64_tr_b16 v[208:209], v142 offset:4096
    ds_read_b64_tr_b16 v[210:211], v142 offset:4608
    buffer_load_dwordx4 v130, s[12:15], s48 offen offset:0 lds
    v_fract_f32 v74, v74
    v_mfma_f32_32x32x16_bf16 v[48:63], v[216:219], a[168:171], v[48:63]
    ds_read_b128 a[40:43], v138 offset:0
    ds_read_b128 a[184:187], v138 offset:4096
    buffer_load_dwordx4 v130, s[12:15], s49 offen offset:1024 lds
    v_cos_f32 v76, v74
    s_nop 0
    v_mfma_f32_32x32x16_bf16 v[32:47], v[220:223], a[28:31], v[32:47]
    s_add_u32 m0, s53, 24576
    ds_read_b64_tr_b16 v[212:213], v142 offset:6144
    ds_read_b64_tr_b16 v[214:215], v142 offset:6656
    buffer_load_dwordx4 v131, s[16:19], s48 offen offset:0 lds
    v_mfma_f32_32x32x16_bf16 v[48:63], v[220:223], a[172:175], v[48:63]
    ds_read_b128 a[44:47], v139 offset:0
    ds_read_b128 a[188:191], v139 offset:4096
    buffer_load_dwordx4 v131, s[16:19], s49 offen offset:1024 lds
    v_add_u32 v128, 128, v128
    v_add_u32 v129, 128, v129
    v_add_u32 v130, 589824, v130
    v_add_u32 v131, 589824, v131
    s_waitcnt lgkmcnt(12)
    v_mfma_f32_32x32x16_bf16 v[0:15], v[224:227], a[32:35], v[0:15]
    ds_read_b64_tr_b16 v[216:217], v143 offset:0
    ds_read_b64_tr_b16 v[218:219], v143 offset:512
    v_cvt_pk_bf16_f32 v81, v75, v76
    v_add_u32 v72, 4, v66
    v_cmp_lt_u32 vcc, 288, v72
    v_subrev_u32 v73, 288, v72
    v_mov_b32 v74, 0
    v_cndmask_b32 v73, v72, v73, vcc
    v_cndmask_b32 v74, v74, v78, vcc
    v_mfma_f32_32x32x16_bf16 v[16:31], v[224:227], a[176:179], v[16:31]
    v_mul_u32_u24 v73, v73, v65
    v_cvt_f32_u32 v73, v73
    v_fmac_f32 v74, v79, v73
    v_fract_f32 v74, v74
    s_waitcnt lgkmcnt(10)
    v_mfma_f32_32x32x16_bf16 v[0:15], v[228:231], a[36:39], v[0:15]
    ds_read_b64_tr_b16 v[220:221], v143 offset:2048
    ds_read_b64_tr_b16 v[222:223], v143 offset:2560
    v_cos_f32 v75, v74
    s_nop 0
    v_add_u32 v72, 5, v66
    v_mfma_f32_32x32x16_bf16 v[16:31], v[228:231], a[180:183], v[16:31]
    v_cmp_lt_u32 vcc, 288, v72
    v_subrev_u32 v73, 288, v72
    v_mov_b32 v74, 0
    v_cndmask_b32 v73, v72, v73, vcc
    v_cndmask_b32 v74, v74, v78, vcc
    v_mul_u32_u24 v73, v73, v65
    v_cvt_f32_u32 v73, v73
    s_waitcnt lgkmcnt(8)
    v_mfma_f32_32x32x16_bf16 v[0:15], v[208:211], a[40:43], v[0:15]
    ds_read_b64_tr_b16 v[224:225], v143 offset:4096
    ds_read_b64_tr_b16 v[226:227], v143 offset:4608
    v_fmac_f32 v74, v79, v73
    v_fract_f32 v74, v74
    v_cos_f32 v76, v74
    s_nop 0
    v_mfma_f32_32x32x16_bf16 v[16:31], v[208:211], a[184:187], v[16:31]
    v_cvt_pk_bf16_f32 v82, v75, v76
    v_add_u32 v72, 6, v66
    v_cmp_lt_u32 vcc, 288, v72
    v_subrev_u32 v73, 288, v72
    v_mov_b32 v74, 0
    v_cndmask_b32 v73, v72, v73, vcc
    v_cndmask_b32 v74, v74, v78, vcc
    s_waitcnt lgkmcnt(6)
    v_mfma_f32_32x32x16_bf16 v[0:15], v[212:215], a[44:47], v[0:15]
    ds_read_b64_tr_b16 v[228:229], v143 offset:6144
    ds_read_b64_tr_b16 v[230:231], v143 offset:6656
    v_mul_u32_u24 v73, v73, v65
    v_cvt_f32_u32 v73, v73
    v_fmac_f32 v74, v79, v73
    v_fract_f32 v74, v74
    v_mfma_f32_32x32x16_bf16 v[16:31], v[212:215], a[188:191], v[16:31]
    v_add_u32 v136, 98304, v132
    v_add_u32 v137, 98304, v133
    v_add_u32 v138, 98304, v134
    v_add_u32 v139, 98304, v135
    v_add_u32 v142, 114688, v140
    v_add_u32 v143, 114688, v141
    s_waitcnt lgkmcnt(6)
    v_mfma_f32_32x32x16_bf16 v[32:47], v[216:219], a[32:35], v[32:47]
    s_waitcnt vmcnt(16) lgkmcnt(0)
    s_barrier
    ds_read_b64_tr_b16 v[208:209], v142 offset:0
    ds_read_b64_tr_b16 v[210:211], v142 offset:512
    v_cos_f32 v75, v74
    s_nop 0
    v_mfma_f32_32x32x16_bf16 v[48:63], v[216:219], a[176:179], v[48:63]
    s_add_u32 m0, s52, 65536
    ds_read_b128 a[48:51], v136 offset:0
    ds_read_b128 a[192:195], v136 offset:4096
    buffer_load_dwordx4 v128, s[8:11], s44 offen offset:0 lds
    v_add_u32 v72, 7, v66
    v_mfma_f32_32x32x16_bf16 v[32:47], v[220:223], a[36:39], v[32:47]
    ds_read_b64_tr_b16 v[212:213], v142 offset:2048
    ds_read_b64_tr_b16 v[214:215], v142 offset:2560
    buffer_load_dwordx4 v129, s[8:11], s45 offen offset:1024 lds
    v_mfma_f32_32x32x16_bf16 v[48:63], v[220:223], a[180:183], v[48:63]
    ds_read_b128 a[52:55], v137 offset:0
    ds_read_b128 a[196:199], v137 offset:4096
    buffer_load_dwordx4 v128, s[8:11], s46 offen offset:2048 lds
    v_cmp_lt_u32 vcc, 288, v72
    v_subrev_u32 v73, 288, v72
    v_mov_b32 v74, 0
    v_cndmask_b32 v73, v72, v73, vcc
    v_cndmask_b32 v74, v74, v78, vcc
    v_mfma_f32_32x32x16_bf16 v[32:47], v[224:227], a[40:43], v[32:47]
    ds_read_b64_tr_b16 v[216:217], v142 offset:4096
    ds_read_b64_tr_b16 v[218:219], v142 offset:4608
    buffer_load_dwordx4 v129, s[8:11], s47 offen offset:3072 lds
    v_mul_u32_u24 v73, v73, v65
    v_cvt_f32_u32 v73, v73
    v_mfma_f32_32x32x16_bf16 v[48:63], v[224:227], a[184:187], v[48:63]
    s_add_u32 m0, s53, 81920
    ds_read_b128 a[56:59], v138 offset:0
    ds_read_b128 a[200:203], v138 offset:4096
    buffer_load_dwordx4 v130, s[12:15], s48 offen offset:0 lds
    v_fmac_f32 v74, v79, v73
    v_mfma_f32_32x32x16_bf16 v[32:47], v[228:231], a[44:47], v[32:47]
    ds_read_b64_tr_b16 v[220:221], v142 offset:6144
    ds_read_b64_tr_b16 v[222:223], v142 offset:6656
    buffer_load_dwordx4 v130, s[12:15], s49 offen offset:1024 lds
    v_fract_f32 v74, v74
    v_cos_f32 v76, v74
    s_nop 0
    v_mfma_f32_32x32x16_bf16 v[48:63], v[228:231], a[188:191], v[48:63]
    s_add_u32 m0, s53, 90112
    ds_read_b128 a[60:63], v139 offset:0
    ds_read_b128 a[204:207], v139 offset:4096
    buffer_load_dwordx4 v131, s[16:19], s48 offen offset:0 lds
    s_waitcnt lgkmcnt(12)
    v_mfma_f32_32x32x16_bf16 v[0:15], v[208:211], a[48:51], v[0:15]
    ds_read_b64_tr_b16 v[224:225], v143 offset:0
    ds_read_b64_tr_b16 v[226:227], v143 offset:512
    v_cvt_pk_bf16_f32 v83, v75, v76
    s_waitcnt vmcnt(58)
    v_mfma_f32_32x32x16_bf16 v[16:31], v[208:211], a[192:195], v[16:31]
    buffer_load_dwordx4 v131, s[16:19], s49 offen offset:1024 lds
    v_add_u32 v128, 128, v128
    v_add_u32 v129, 128, v129
    v_add_u32 v130, 589824, v130
    v_add_u32 v131, 589824, v131
    s_waitcnt lgkmcnt(10)
    v_mfma_f32_32x32x16_bf16 v[0:15], v[212:215], a[52:55], v[0:15]
    ds_read_b64_tr_b16 v[228:229], v143 offset:2048
    ds_read_b64_tr_b16 v[230:231], v143 offset:2560
    v_cmp_eq_u32 vcc, 576, v66
    s_nop 1
    v_cndmask_b32 v80, v80, v68, vcc
    v_mfma_f32_32x32x16_bf16 v[16:31], v[212:215], a[196:199], v[16:31]
    v_cmp_le_u32 vcc, 576, v66
    s_nop 1
    v_cndmask_b32 v81, v81, v243, vcc
    v_cndmask_b32 v82, v82, v243, vcc
    v_cndmask_b32 v83, v83, v243, vcc
    v_cmp_lt_u32 vcc, 576, v66
    s_nop 1
    v_cndmask_b32 v80, v80, v243, vcc
    s_waitcnt lgkmcnt(8)
    v_mfma_f32_32x32x16_bf16 v[0:15], v[216:219], a[56:59], v[0:15]
    ds_read_b64_tr_b16 v[208:209], v143 offset:4096
    ds_read_b64_tr_b16 v[210:211], v143 offset:4608
    v_lshlrev_b32 v67, 4, v64
    v_mov_b32 v69, 0x40000000
    v_mfma_f32_32x32x16_bf16 v[16:31], v[216:219], a[200:203], v[16:31]
    v_cmp_gt_u32 vcc, 46080, v64
    s_nop 1
    v_cndmask_b32 v67, v69, v67, vcc
    buffer_store_dwordx4 v[80:83], v67, s[20:23], s64 offen sc1
    v_add_u32 v84, s65, v242
    v_lshrrev_b32 v85, 6, v84
    s_waitcnt lgkmcnt(6)
    v_mfma_f32_32x32x16_bf16 v[0:15], v[220:223], a[60:63], v[0:15]
    ds_read_b64_tr_b16 v[212:213], v143 offset:6144
    ds_read_b64_tr_b16 v[214:215], v143 offset:6656
    v_mul_hi_u32 v86, v85, s66
    v_mul_u32_u24 v87, 36, v86
    v_sub_u32 v87, v85, v87
    v_lshlrev_b32 v87, 4, v87
    v_bfe_u32 v88, v84, 5, 1
    v_mfma_f32_32x32x16_bf16 v[16:31], v[220:223], a[204:207], v[16:31]
    v_add_u32 v136, 131072, v132
    v_add_u32 v137, 131072, v133
    v_add_u32 v138, 131072, v134
    v_add_u32 v139, 131072, v135
    v_add_u32 v142, 147456, v140
    v_add_u32 v143, 147456, v141
    s_waitcnt lgkmcnt(6)
    v_mfma_f32_32x32x16_bf16 v[32:47], v[224:227], a[48:51], v[32:47]
    s_waitcnt vmcnt(17) lgkmcnt(0)
    s_barrier
    ds_read_b64_tr_b16 v[216:217], v142 offset:0
    ds_read_b64_tr_b16 v[218:219], v142 offset:512
    v_lshlrev_b32 v88, 3, v88
    v_add_u32 v87, v87, v88
    v_mfma_f32_32x32x16_bf16 v[48:63], v[224:227], a[192:195], v[48:63]
    s_add_u32 m0, s52, 98304
    ds_read_b128 a[64:67], v136 offset:0
    ds_read_b128 a[208:211], v136 offset:4096
    buffer_load_dwordx4 v128, s[8:11], s44 offen offset:0 lds
    v_and_b32 v88, 31, v84
    v_mfma_f32_32x32x16_bf16 v[32:47], v[228:231], a[52:55], v[32:47]
    ds_read_b64_tr_b16 v[220:221], v142 offset:2048
    ds_read_b64_tr_b16 v[222:223], v142 offset:2560
    v_lshl_add_u32 v88, v86, 5, v88
    v_add_u32 v72, 0, v87
    v_cmp_lt_u32 vcc, 288, v72
    v_subrev_u32 v73, 288, v72
    v_mov_b32 v74, 0
    v_cndmask_b32 v73, v72, v73, vcc
    v_cndmask_b32 v74, v74, v78, vcc
    v_mfma_f32_32x32x16_bf16 v[48:63], v[228:231], a[196:199], v[48:63]
    ds_read_b128 a[68:71], v137 offset:0
    ds_read_b128 a[212:215], v137 offset:4096
    buffer_load_dwordx4 v129, s[8:11], s45 offen offset:1024 lds
    v_mul_u32_u24 v73, v73, v88
    v_mfma_f32_32x32x16_bf16 v[32:47], v[208:211], a[56:59], v[32:47]
    ds_read_b64_tr_b16 v[224:225], v142 offset:4096
    ds_read_b64_tr_b16 v[226:227], v142 offset:4608
    buffer_load_dword v246, v245, s[84:87], 0 offen offset:256
    v_cvt_f32_u32 v73, v73
    v_fmac_f32 v74, v79, v73
    v_mfma_f32_32x32x16_bf16 v[48:63], v[208:211], a[200:203], v[48:63]
    ds_read_b128 a[72:75], v138 offset:0
    ds_read_b128 a[216:219], v138 offset:4096
    buffer_load_dwordx4 v128, s[8:11], s46 offen offset:2048 lds
    v_fract_f32 v74, v74
    v_mfma_f32_32x32x16_bf16 v[32:47], v[212:215], a[60:63], v[32:47]
    ds_read_b64_tr_b16 v[228:229], v142 offset:6144
    ds_read_b64_tr_b16 v[230:231], v142 offset:6656
    v_cos_f32 v75, v74
    s_nop 0
    v_mul_f32 v75, 0x35e38e39, v75
    v_mul_f32 v74, 0.5, v75
    v_mfma_f32_32x32x16_bf16 v[48:63], v[212:215], a[204:207], v[48:63]
    ds_read_b128 a[76:79], v139 offset:0
    ds_read_b128 a[220:223], v139 offset:4096
    buffer_load_dwordx4 v129, s[8:11], s47 offen offset:3072 lds
    v_cmp_eq_u32 vcc, 0, v72
    s_nop 1
    v_cndmask_b32 v75, v75, v74, vcc
    s_waitcnt lgkmcnt(12)
    v_mfma_f32_32x32x16_bf16 v[0:15], v[216:219], a[64:67], v[0:15]
    ds_read_b64_tr_b16 v[208:209], v143 offset:0
    ds_read_b64_tr_b16 v[210:211], v143 offset:512
    v_cmp_eq_u32 vcc, 288, v72
    s_nop 1
    v_cndmask_b32 v75, v75, v74, vcc
    v_mfma_f32_32x32x16_bf16 v[16:31], v[216:219], a[208:211], v[16:31]
    s_add_u32 m0, s53, 114688
    s_nop 0
    buffer_load_dwordx4 v130, s[12:15], s48 offen offset:0 lds
    v_add_u32 v72, 1, v87
    s_waitcnt lgkmcnt(10)
    v_mfma_f32_32x32x16_bf16 v[0:15], v[220:223], a[68:71], v[0:15]
    ds_read_b64_tr_b16 v[212:213], v143 offset:2048
    ds_read_b64_tr_b16 v[214:215], v143 offset:2560
    v_cmp_lt_u32 vcc, 288, v72
    v_subrev_u32 v73, 288, v72
    v_mov_b32 v74, 0
    v_cndmask_b32 v73, v72, v73, vcc
    v_cndmask_b32 v74, v74, v78, vcc
    v_mfma_f32_32x32x16_bf16 v[16:31], v[220:223], a[212:215], v[16:31]
    buffer_load_dwordx4 v130, s[12:15], s49 offen offset:1024 lds
    v_mul_u32_u24 v73, v73, v88
    v_cvt_f32_u32 v73, v73
    v_fmac_f32 v74, v79, v73
    s_waitcnt lgkmcnt(8)
    v_mfma_f32_32x32x16_bf16 v[0:15], v[224:227], a[72:75], v[0:15]
    ds_read_b64_tr_b16 v[216:217], v143 offset:4096
    ds_read_b64_tr_b16 v[218:219], v143 offset:4608
    v_fract_f32 v74, v74
    v_cos_f32 v76, v74
    s_nop 0
    v_mul_f32 v76, 0x35e38e39, v76
    v_mfma_f32_32x32x16_bf16 v[16:31], v[224:227], a[216:219], v[16:31]
    s_add_u32 m0, s53, 122880
    s_nop 0
    buffer_load_dwordx4 v131, s[16:19], s48 offen offset:0 lds
    v_cvt_pk_bf16_f32 v80, v75, v76
    s_waitcnt lgkmcnt(6)
    v_mfma_f32_32x32x16_bf16 v[0:15], v[228:231], a[76:79], v[0:15]
    ds_read_b64_tr_b16 v[220:221], v143 offset:6144
    ds_read_b64_tr_b16 v[222:223], v143 offset:6656
    v_add_u32 v72, 2, v87
    v_cmp_lt_u32 vcc, 288, v72
    v_subrev_u32 v73, 288, v72
    v_mov_b32 v74, 0
    v_cndmask_b32 v73, v72, v73, vcc
    v_cndmask_b32 v74, v74, v78, vcc
    v_mfma_f32_32x32x16_bf16 v[16:31], v[228:231], a[220:223], v[16:31]
    v_add_u32 v136, 0, v132
    v_add_u32 v137, 0, v133
    v_add_u32 v138, 0, v134
    v_add_u32 v139, 0, v135
    v_add_u32 v142, 16384, v140
    v_add_u32 v143, 16384, v141
    buffer_load_dwordx4 v131, s[16:19], s49 offen offset:1024 lds
    v_add_u32 v128, 128, v128
    v_add_u32 v129, 128, v129
    v_add_u32 v130, 589824, v130
    v_add_u32 v131, 589824, v131
    s_waitcnt lgkmcnt(6)
    v_mfma_f32_32x32x16_bf16 v[32:47], v[208:211], a[64:67], v[32:47]
    s_waitcnt vmcnt(18) lgkmcnt(0)
    s_barrier
    ds_read_b64_tr_b16 v[224:225], v142 offset:0
    ds_read_b64_tr_b16 v[226:227], v142 offset:512
    v_mul_u32_u24 v73, v73, v88
    v_mfma_f32_32x32x16_bf16 v[48:63], v[208:211], a[208:211], v[48:63]
    s_add_u32 m0, s52, 131072
    ds_read_b128 a[80:83], v136 offset:0
    ds_read_b128 a[224:227], v136 offset:4096
    buffer_load_dwordx4 v128, s[8:11], s44 offen offset:0 lds
    v_cvt_f32_u32 v73, v73
    v_fmac_f32 v74, v79, v73
    v_mfma_f32_32x32x16_bf16 v[32:47], v[212:215], a[68:71], v[32:47]
    ds_read_b64_tr_b16 v[228:229], v142 offset:2048
    ds_read_b64_tr_b16 v[230:231], v142 offset:2560
    v_fract_f32 v74, v74
    v_cos_f32 v75, v74
    s_nop 0
    v_mul_f32 v75, 0x35e38e39, v75
    v_mfma_f32_32x32x16_bf16 v[48:63], v[212:215], a[212:215], v[48:63]
    ds_read_b128 a[84:87], v137 offset:0
    ds_read_b128 a[228:231], v137 offset:4096
    buffer_load_dwordx4 v129, s[8:11], s45 offen offset:1024 lds
    v_add_u32 v72, 3, v87
    v_mfma_f32_32x32x16_bf16 v[32:47], v[216:219], a[72:75], v[32:47]
    ds_read_b64_tr_b16 v[208:209], v142 offset:4096
    ds_read_b64_tr_b16 v[210:211], v142 offset:4608
    v_cmp_lt_u32 vcc, 288, v72
    v_subrev_u32 v73, 288, v72
    v_mov_b32 v74, 0
    v_cndmask_b32 v73, v72, v73, vcc
    v_cndmask_b32 v74, v74, v78, vcc
    v_mul_u32_u24 v73, v73, v88
    v_mfma_f32_32x32x16_bf16 v[48:63], v[216:219], a[216:219], v[48:63]
    ds_read_b128 a[88:91], v138 offset:0
    ds_read_b128 a[232:235], v138 offset:4096
    buffer_load_dwordx4 v128, s[8:11], s46 offen offset:2048 lds
    v_cvt_f32_u32 v73, v73
    v_fmac_f32 v74, v79, v73
    v_mfma_f32_32x32x16_bf16 v[32:47], v[220:223], a[76:79], v[32:47]
    ds_read_b64_tr_b16 v[212:213], v142 offset:6144
    ds_read_b64_tr_b16 v[214:215], v142 offset:6656
    v_fract_f32 v74, v74
    v_cos_f32 v76, v74
    s_nop 0
    v_mul_f32 v76, 0x35e38e39, v76
    v_mfma_f32_32x32x16_bf16 v[48:63], v[220:223], a[220:223], v[48:63]
    ds_read_b128 a[92:95], v139 offset:0
    ds_read_b128 a[236:239], v139 offset:4096
    buffer_load_dwordx4 v129, s[8:11], s47 offen offset:3072 lds
    v_cvt_pk_bf16_f32 v81, v75, v76
    s_waitcnt lgkmcnt(12)
    v_mfma_f32_32x32x16_bf16 v[0:15], v[224:227], a[80:83], v[0:15]
    ds_read_b64_tr_b16 v[216:217], v143 offset:0
    ds_read_b64_tr_b16 v[218:219], v143 offset:512
    v_add_u32 v72, 4, v87
    v_cmp_lt_u32 vcc, 288, v72
    v_subrev_u32 v73, 288, v72
    v_mov_b32 v74, 0
    v_cndmask_b32 v73, v72, v73, vcc
    v_cndmask_b32 v74, v74, v78, vcc
    v_mfma_f32_32x32x16_bf16 v[16:31], v[224:227], a[224:227], v[16:31]
    s_add_u32 m0, s53, 147456
    s_nop 0
    buffer_load_dwordx4 v130, s[12:15], s48 offen offset:0 lds
    v_mul_u32_u24 v73, v73, v88
    s_waitcnt lgkmcnt(10)
    v_mfma_f32_32x32x16_bf16 v[0:15], v[228:231], a[84:87], v[0:15]
    ds_read_b64_tr_b16 v[220:221], v143 offset:2048
    ds_read_b64_tr_b16 v[222:223], v143 offset:2560
    v_cvt_f32_u32 v73, v73
    v_fmac_f32 v74, v79, v73
    v_fract_f32 v74, v74
    v_mfma_f32_32x32x16_bf16 v[16:31], v[228:231], a[228:231], v[16:31]
    buffer_load_dwordx4 v130, s[12:15], s49 offen offset:1024 lds
    v_cos_f32 v75, v74
    s_nop 0
    v_mul_f32 v75, 0x35e38e39, v75
    v_add_u32 v72, 5, v87
    s_waitcnt lgkmcnt(8)
    v_mfma_f32_32x32x16_bf16 v[0:15], v[208:211], a[88:91], v[0:15]
    ds_read_b64_tr_b16 v[224:225], v143 offset:4096
    ds_read_b64_tr_b16 v[226:227], v143 offset:4608
    v_cmp_lt_u32 vcc, 288, v72
    v_subrev_u32 v73, 288, v72
    v_mov_b32 v74, 0
    v_cndmask_b32 v73, v72, v73, vcc
    v_cndmask_b32 v74, v74, v78, vcc
    v_mfma_f32_32x32x16_bf16 v[16:31], v[208:211], a[232:235], v[16:31]
    s_add_u32 m0, s53, 155648
    s_nop 0
    buffer_load_dwordx4 v131, s[16:19], s48 offen offset:0 lds
    v_mul_u32_u24 v73, v73, v88
    s_waitcnt lgkmcnt(6)
    v_mfma_f32_32x32x16_bf16 v[0:15], v[212:215], a[92:95], v[0:15]
    ds_read_b64_tr_b16 v[228:229], v143 offset:6144
    ds_read_b64_tr_b16 v[230:231], v143 offset:6656
    v_cvt_f32_u32 v73, v73
    v_fmac_f32 v74, v79, v73
    v_fract_f32 v74, v74
    v_cos_f32 v76, v74
    s_nop 0
    v_mfma_f32_32x32x16_bf16 v[16:31], v[212:215], a[236:239], v[16:31]
    v_add_u32 v136, 65536, v132
    v_add_u32 v137, 65536, v133
    v_add_u32 v138, 65536, v134
    v_add_u32 v139, 65536, v135
    v_add_u32 v142, 81920, v140
    v_add_u32 v143, 81920, v141
    buffer_load_dwordx4 v131, s[16:19], s49 offen offset:1024 lds
    v_add_u32 v128, 128, v128
    v_add_u32 v129, 128, v129
    v_add_u32 v130, 589824, v130
    v_add_u32 v131, 589824, v131
    s_waitcnt lgkmcnt(6)
    v_mfma_f32_32x32x16_bf16 v[32:47], v[216:219], a[80:83], v[32:47]
    s_waitcnt vmcnt(18) lgkmcnt(0)
    s_barrier
    ds_read_b64_tr_b16 v[208:209], v142 offset:0
    ds_read_b64_tr_b16 v[210:211], v142 offset:512
    v_mul_f32 v76, 0x35e38e39, v76
    v_mfma_f32_32x32x16_bf16 v[48:63], v[216:219], a[224:227], v[48:63]
    s_add_u32 m0, s34, 0
    ds_read_b128 a[96:99], v136 offset:0
    ds_read_b128 a[240:243], v136 offset:4096
    buffer_load_dwordx4 v200, s[12:15], s28 offen offset:0 lds
    v_cvt_pk_bf16_f32 v82, v75, v76
    v_add_u32 v72, 6, v87
    v_mfma_f32_32x32x16_bf16 v[32:47], v[220:223], a[84:87], v[32:47]
    ds_read_b64_tr_b16 v[212:213], v142 offset:2048
    ds_read_b64_tr_b16 v[214:215], v142 offset:2560
    v_cmp_lt_u32 vcc, 288, v72
    v_subrev_u32 v73, 288, v72
    v_mov_b32 v74, 0
    v_cndmask_b32 v73, v72, v73, vcc
    v_cndmask_b32 v74, v74, v78, vcc
    v_mfma_f32_32x32x16_bf16 v[48:63], v[220:223], a[228:231], v[48:63]
    ds_read_b128 a[100:103], v137 offset:0
    ds_read_b128 a[244:247], v137 offset:4096
    buffer_load_dwordx4 v200, s[12:15], s29 offen offset:1024 lds
    v_mul_u32_u24 v73, v73, v88
    v_cvt_f32_u32 v73, v73
    v_mfma_f32_32x32x16_bf16 v[32:47], v[224:227], a[88:91], v[32:47]
    ds_read_b64_tr_b16 v[216:217], v142 offset:4096
    ds_read_b64_tr_b16 v[218:219], v142 offset:4608
    v_fmac_f32 v74, v79, v73
    v_fract_f32 v74, v74
    v_cos_f32 v75, v74
    s_nop 0
    v_mfma_f32_32x32x16_bf16 v[48:63], v[224:227], a[232:235], v[48:63]
    ds_read_b128 a[104:107], v138 offset:0
    ds_read_b128 a[248:251], v138 offset:4096
    buffer_load_dwordx4 v200, s[12:15], s30 offen offset:2048 lds
    v_mul_f32 v75, 0x35e38e39, v75
    v_add_u32 v72, 7, v87
    v_mfma_f32_32x32x16_bf16 v[32:47], v[228:231], a[92:95], v[32:47]
    ds_read_b64_tr_b16 v[220:221], v142 offset:6144
    ds_read_b64_tr_b16 v[222:223], v142 offset:6656
    v_cmp_lt_u32 vcc, 288, v72
    v_subrev_u32 v73, 288, v72
    v_mov_b32 v74, 0
    v_cndmask_b32 v73, v72, v73, vcc
    v_cndmask_b32 v74, v74, v78, vcc
    v_mfma_f32_32x32x16_bf16 v[48:63], v[228:231], a[236:239], v[48:63]
    ds_read_b128 a[108:111], v139 offset:0
    ds_read_b128 a[252:255], v139 offset:4096
    buffer_load_dwordx4 v200, s[12:15], s31 offen offset:3072 lds
    v_mul_u32_u24 v73, v73, v88
    s_waitcnt lgkmcnt(12)
    v_mfma_f32_32x32x16_bf16 v[0:15], v[208:211], a[96:99], v[0:15]
    ds_read_b64_tr_b16 v[224:225], v143 offset:0
    ds_read_b64_tr_b16 v[226:227], v143 offset:512
    v_cvt_f32_u32 v73, v73
    v_fmac_f32 v74, v79, v73
    v_fract_f32 v74, v74
    v_cos_f32 v76, v74
    s_nop 0
    v_mfma_f32_32x32x16_bf16 v[16:31], v[208:211], a[240:243], v[16:31]
    s_add_u32 m0, s34, 4096
    s_nop 0
    buffer_load_dwordx4 v200, s[12:15], s32 offen offset:0 lds
    s_waitcnt lgkmcnt(10)
    v_mfma_f32_32x32x16_bf16 v[0:15], v[212:215], a[100:103], v[0:15]
    ds_read_b64_tr_b16 v[228:229], v143 offset:2048
    ds_read_b64_tr_b16 v[230:231], v143 offset:2560
    v_mul_f32 v76, 0x35e38e39, v76
    v_cvt_pk_bf16_f32 v83, v75, v76
    v_lshlrev_b32 v85, 4, v84
    v_cmp_gt_u32 vcc, 162, v242
    s_nop 1
    v_cndmask_b32 v85, v69, v85, vcc
    v_mfma_f32_32x32x16_bf16 v[16:31], v[212:215], a[244:247], v[16:31]
    buffer_load_dwordx4 v200, s[12:15], s33 offen offset:1024 lds
    buffer_store_dwordx4 v[80:83], v85, s[20:23], s67 offen sc1
    s_waitcnt lgkmcnt(8)
    v_mfma_f32_32x32x16_bf16 v[0:15], v[216:219], a[104:107], v[0:15]
    ds_read_b64_tr_b16 v[208:209], v143 offset:4096
    ds_read_b64_tr_b16 v[210:211], v143 offset:4608
    v_mfma_f32_32x32x16_bf16 v[16:31], v[216:219], a[248:251], v[16:31]
    s_add_u32 m0, s34, 24576
    s_nop 0
    buffer_load_dwordx4 v201, s[16:19], s28 offen offset:0 lds
    s_waitcnt lgkmcnt(6)
    v_mfma_f32_32x32x16_bf16 v[0:15], v[220:223], a[108:111], v[0:15]
    ds_read_b64_tr_b16 v[212:213], v143 offset:6144
    ds_read_b64_tr_b16 v[214:215], v143 offset:6656
    v_mfma_f32_32x32x16_bf16 v[16:31], v[220:223], a[252:255], v[16:31]
    v_add_u32 v136, 98304, v132
    v_add_u32 v137, 98304, v133
    v_add_u32 v138, 98304, v134
    v_add_u32 v139, 98304, v135
    v_add_u32 v142, 114688, v140
    v_add_u32 v143, 114688, v141
    buffer_load_dwordx4 v201, s[16:19], s29 offen offset:1024 lds
    s_waitcnt lgkmcnt(6)
    v_mfma_f32_32x32x16_bf16 v[32:47], v[224:227], a[96:99], v[32:47]
    s_waitcnt vmcnt(17) lgkmcnt(0)
    s_barrier
    ds_read_b64_tr_b16 v[216:217], v142 offset:0
    ds_read_b64_tr_b16 v[218:219], v142 offset:512
    v_mfma_f32_32x32x16_bf16 v[48:63], v[224:227], a[240:243], v[48:63]
    ds_read_b128 a[112:115], v136 offset:0
    ds_read_b128 v[144:147], v136 offset:4096
    buffer_load_dwordx4 v201, s[16:19], s30 offen offset:2048 lds
    v_mfma_f32_32x32x16_bf16 v[32:47], v[228:231], a[100:103], v[32:47]
    ds_read_b64_tr_b16 v[220:221], v142 offset:2048
    ds_read_b64_tr_b16 v[222:223], v142 offset:2560
    v_mfma_f32_32x32x16_bf16 v[48:63], v[228:231], a[244:247], v[48:63]
    ds_read_b128 a[116:119], v137 offset:0
    ds_read_b128 v[148:151], v137 offset:4096
    buffer_load_dwordx4 v201, s[16:19], s31 offen offset:3072 lds
    v_mfma_f32_32x32x16_bf16 v[32:47], v[208:211], a[104:107], v[32:47]
    ds_read_b64_tr_b16 v[224:225], v142 offset:4096
    ds_read_b64_tr_b16 v[226:227], v142 offset:4608
    v_mfma_f32_32x32x16_bf16 v[48:63], v[208:211], a[248:251], v[48:63]
    s_add_u32 m0, s34, 28672
    ds_read_b128 a[120:123], v138 offset:0
    ds_read_b128 v[152:155], v138 offset:4096
    buffer_load_dwordx4 v201, s[16:19], s32 offen offset:0 lds
    v_mfma_f32_32x32x16_bf16 v[32:47], v[212:215], a[108:111], v[32:47]
    ds_read_b64_tr_b16 v[228:229], v142 offset:6144
    ds_read_b64_tr_b16 v[230:231], v142 offset:6656
    v_mfma_f32_32x32x16_bf16 v[48:63], v[212:215], a[252:255], v[48:63]
    ds_read_b128 a[124:127], v139 offset:0
    ds_read_b128 v[156:159], v139 offset:4096
    buffer_load_dwordx4 v201, s[16:19], s33 offen offset:1024 lds
    v_add_u32 v200, s35, v200
    v_add_u32 v201, s35, v201
    s_waitcnt lgkmcnt(12)
    v_mfma_f32_32x32x16_bf16 v[0:15], v[216:219], a[112:115], v[0:15]
    ds_read_b64_tr_b16 v[208:209], v143 offset:0
    ds_read_b64_tr_b16 v[210:211], v143 offset:512
    v_mfma_f32_32x32x16_bf16 v[16:31], v[216:219], v[144:147], v[16:31]
    s_add_u32 m0, s34, 49152
    s_nop 0
    buffer_load_dwordx4 v200, s[12:15], s28 offen offset:0 lds
    s_waitcnt lgkmcnt(10)
    v_mfma_f32_32x32x16_bf16 v[0:15], v[220:223], a[116:119], v[0:15]
    ds_read_b64_tr_b16 v[212:213], v143 offset:2048
    ds_read_b64_tr_b16 v[214:215], v143 offset:2560
    v_mfma_f32_32x32x16_bf16 v[16:31], v[220:223], v[148:151], v[16:31]
    buffer_load_dwordx4 v200, s[12:15], s29 offen offset:1024 lds
    s_waitcnt lgkmcnt(8)
    v_mfma_f32_32x32x16_bf16 v[0:15], v[224:227], a[120:123], v[0:15]
    ds_read_b64_tr_b16 v[216:217], v143 offset:4096
    ds_read_b64_tr_b16 v[218:219], v143 offset:4608
    v_mfma_f32_32x32x16_bf16 v[16:31], v[224:227], v[152:155], v[16:31]
    buffer_load_dwordx4 v200, s[12:15], s30 offen offset:2048 lds
    s_waitcnt lgkmcnt(6)
    v_mfma_f32_32x32x16_bf16 v[0:15], v[228:231], a[124:127], v[0:15]
    ds_read_b64_tr_b16 v[220:221], v143 offset:6144
    ds_read_b64_tr_b16 v[222:223], v143 offset:6656
    v_mfma_f32_32x32x16_bf16 v[16:31], v[228:231], v[156:159], v[16:31]
    v_add_u32 v136, 131072, v132
    v_add_u32 v137, 131072, v133
    v_add_u32 v138, 131072, v134
    v_add_u32 v139, 131072, v135
    v_add_u32 v142, 147456, v140
    v_add_u32 v143, 147456, v141
    buffer_load_dwordx4 v200, s[12:15], s31 offen offset:3072 lds
    s_waitcnt lgkmcnt(6)
    v_mfma_f32_32x32x16_bf16 v[32:47], v[208:211], a[112:115], v[32:47]
    s_waitcnt vmcnt(17) lgkmcnt(0)
    s_barrier
    ds_read_b64_tr_b16 v[224:225], v142 offset:0
    ds_read_b64_tr_b16 v[226:227], v142 offset:512
    v_mfma_f32_32x32x16_bf16 v[48:63], v[208:211], v[144:147], v[48:63]
    s_add_u32 m0, s34, 53248
    ds_read_b128 a[128:131], v136 offset:0
    ds_read_b128 v[160:163], v136 offset:4096
    buffer_load_dwordx4 v200, s[12:15], s32 offen offset:0 lds
    v_mfma_f32_32x32x16_bf16 v[32:47], v[212:215], a[116:119], v[32:47]
    ds_read_b64_tr_b16 v[228:229], v142 offset:2048
    ds_read_b64_tr_b16 v[230:231], v142 offset:2560
    v_mfma_f32_32x32x16_bf16 v[48:63], v[212:215], v[148:151], v[48:63]
    ds_read_b128 a[132:135], v137 offset:0
    ds_read_b128 v[164:167], v137 offset:4096
    buffer_load_dwordx4 v200, s[12:15], s33 offen offset:1024 lds
    v_mfma_f32_32x32x16_bf16 v[32:47], v[216:219], a[120:123], v[32:47]
    ds_read_b64_tr_b16 v[208:209], v142 offset:4096
    ds_read_b64_tr_b16 v[210:211], v142 offset:4608
    v_mfma_f32_32x32x16_bf16 v[48:63], v[216:219], v[152:155], v[48:63]
    s_add_u32 m0, s34, 73728
    ds_read_b128 a[136:139], v138 offset:0
    ds_read_b128 v[168:171], v138 offset:4096
    buffer_load_dwordx4 v201, s[16:19], s28 offen offset:0 lds
    v_mfma_f32_32x32x16_bf16 v[32:47], v[220:223], a[124:127], v[32:47]
    ds_read_b64_tr_b16 v[212:213], v142 offset:6144
    ds_read_b64_tr_b16 v[214:215], v142 offset:6656
    v_mfma_f32_32x32x16_bf16 v[48:63], v[220:223], v[156:159], v[48:63]
    ds_read_b128 a[140:143], v139 offset:0
    ds_read_b128 v[172:175], v139 offset:4096
    buffer_load_dwordx4 v201, s[16:19], s29 offen offset:1024 lds
    s_waitcnt lgkmcnt(12)
    v_mfma_f32_32x32x16_bf16 v[0:15], v[224:227], a[128:131], v[0:15]
    ds_read_b64_tr_b16 v[216:217], v143 offset:0
    ds_read_b64_tr_b16 v[218:219], v143 offset:512
    v_mfma_f32_32x32x16_bf16 v[16:31], v[224:227], v[160:163], v[16:31]
    buffer_load_dwordx4 v201, s[16:19], s30 offen offset:2048 lds
    s_waitcnt lgkmcnt(10)
    v_mfma_f32_32x32x16_bf16 v[0:15], v[228:231], a[132:135], v[0:15]
    ds_read_b64_tr_b16 v[220:221], v143 offset:2048
    ds_read_b64_tr_b16 v[222:223], v143 offset:2560
    v_mfma_f32_32x32x16_bf16 v[16:31], v[228:231], v[164:167], v[16:31]
    buffer_load_dwordx4 v201, s[16:19], s31 offen offset:3072 lds
    s_waitcnt lgkmcnt(8)
    v_mfma_f32_32x32x16_bf16 v[0:15], v[208:211], a[136:139], v[0:15]
    ds_read_b64_tr_b16 v[224:225], v143 offset:4096
    ds_read_b64_tr_b16 v[226:227], v143 offset:4608
    v_mfma_f32_32x32x16_bf16 v[16:31], v[208:211], v[168:171], v[16:31]
    s_add_u32 m0, s34, 77824
    s_nop 0
    buffer_load_dwordx4 v201, s[16:19], s32 offen offset:0 lds
    s_waitcnt lgkmcnt(6)
    v_mfma_f32_32x32x16_bf16 v[0:15], v[212:215], a[140:143], v[0:15]
    ds_read_b64_tr_b16 v[228:229], v143 offset:6144
    ds_read_b64_tr_b16 v[230:231], v143 offset:6656
    v_mfma_f32_32x32x16_bf16 v[16:31], v[212:215], v[172:175], v[16:31]
    s_add_u32 s39, s38, s34
    s_add_u32 s38, s38, 49152
    s_cmp_eq_u32 s38, 147456
    s_cselect_b32 s38, 0, s38
    v_add_u32 v202, s38, v204
    v_add_u32 v203, s38, v205
    buffer_load_dwordx4 v201, s[16:19], s33 offen offset:1024 lds
    v_add_u32 v200, s35, v200
    v_add_u32 v201, s35, v201
    s_waitcnt lgkmcnt(6)
    v_mfma_f32_32x32x16_bf16 v[32:47], v[216:219], a[128:131], v[32:47]
    s_waitcnt vmcnt(18)
    s_waitcnt vmcnt(12) lgkmcnt(0)
    s_barrier
    ds_read_b64_tr_b16 v[208:209], v202 offset:0
    ds_read_b64_tr_b16 v[210:211], v202 offset:512
    v_mfma_f32_32x32x16_bf16 v[48:63], v[216:219], v[160:163], v[48:63]
    v_mfma_f32_32x32x16_bf16 v[32:47], v[220:223], a[132:135], v[32:47]
    ds_read_b64_tr_b16 v[212:213], v202 offset:2048
    ds_read_b64_tr_b16 v[214:215], v202 offset:2560
    v_mfma_f32_32x32x16_bf16 v[48:63], v[220:223], v[164:167], v[48:63]
    s_cmp_eq_u32 s3, 0
    s_cbranch_scc0 gated_mix__spectral_gfnet__glu_gated_geglu__prompt_kernel_nosig
    v_mov_b32 v96, 1
    v_cmp_eq_u32 vcc, 0, v241
    s_and_saveexec_b64 s[60:61], vcc
    buffer_atomic_add v96, v243, s[24:27], 0 offen sc1
    s_mov_b64 exec, s[60:61]
gated_mix__spectral_gfnet__glu_gated_geglu__prompt_kernel_nosig:
    v_mfma_f32_32x32x16_bf16 v[32:47], v[224:227], a[136:139], v[32:47]
    ds_read_b64_tr_b16 v[216:217], v202 offset:4096
    ds_read_b64_tr_b16 v[218:219], v202 offset:4608
    v_mfma_f32_32x32x16_bf16 v[48:63], v[224:227], v[168:171], v[48:63]
    v_mfma_f32_32x32x16_bf16 v[32:47], v[228:231], a[140:143], v[32:47]
    ds_read_b64_tr_b16 v[220:221], v202 offset:6144
    ds_read_b64_tr_b16 v[222:223], v202 offset:6656
    v_mfma_f32_32x32x16_bf16 v[48:63], v[228:231], v[172:175], v[48:63]
gated_mix__spectral_gfnet__glu_gated_geglu__prompt_kernel_bodyB:
    buffer_load_dword v246, v245, s[84:87], 0 offen offset:384
    s_waitcnt lgkmcnt(4)
    v_mfma_f32_32x32x16_bf16 v[64:79], v[208:211], a[0:3], 0
    ds_read_b64_tr_b16 v[224:225], v202 offset:8192
    ds_read_b64_tr_b16 v[226:227], v202 offset:8704
    s_add_u32 m0, s39, 0
    v_mfma_f32_32x32x16_bf16 v[80:95], v[208:211], a[144:147], 0
    buffer_load_dwordx4 v200, s[12:15], s28 offen offset:0 lds
    v_mul_f32 v176, v0, v0
    v_mul_f32 v177, v1, v1
    v_fmaak_f32 v176, v176, v207, 0xc0135761
    v_mfma_f32_32x32x16_bf16 v[64:79], v[212:215], a[4:7], v[64:79]
    ds_read_b64_tr_b16 v[228:229], v202 offset:10240
    ds_read_b64_tr_b16 v[230:231], v202 offset:10752
    v_fmaak_f32 v177, v177, v207, 0xc0135761
    v_mul_f32 v176, v176, v0
    v_mfma_f32_32x32x16_bf16 v[80:95], v[212:215], a[148:151], v[80:95]
    v_mul_f32 v177, v177, v1
    v_exp_f32 v176, v176
    s_waitcnt lgkmcnt(4)
    v_mfma_f32_32x32x16_bf16 v[64:79], v[216:219], a[8:11], v[64:79]
    ds_read_b64_tr_b16 v[208:209], v202 offset:12288
    ds_read_b64_tr_b16 v[210:211], v202 offset:12800
    v_mul_f32 v178, v0, v4
    v_exp_f32 v177, v177
    v_mfma_f32_32x32x16_bf16 v[80:95], v[216:219], a[152:155], v[80:95]
    buffer_load_dwordx4 v200, s[12:15], s29 offen offset:1024 lds
    v_mul_f32 v179, v1, v5
    v_add_f32 v176, 1.0, v176
    v_mfma_f32_32x32x16_bf16 v[64:79], v[220:223], a[12:15], v[64:79]
    ds_read_b64_tr_b16 v[212:213], v202 offset:14336
    ds_read_b64_tr_b16 v[214:215], v202 offset:14848
    v_add_f32 v177, 1.0, v177
    v_rcp_f32 v176, v176
    v_mfma_f32_32x32x16_bf16 v[80:95], v[220:223], a[156:159], v[80:95]
    v_rcp_f32 v177, v177
    v_mul_f32 v178, v178, v176
    s_waitcnt lgkmcnt(4)
    v_mfma_f32_32x32x16_bf16 v[64:79], v[224:227], a[16:19], v[64:79]
    ds_read_b64_tr_b16 v[216:217], v202 offset:16384
    ds_read_b64_tr_b16 v[218:219], v202 offset:16896
    v_mul_f32 v179, v179, v177
    v_cvt_pk_bf16_f32 v192, v178, v179
    v_mfma_f32_32x32x16_bf16 v[80:95], v[224:227], a[160:163], v[80:95]
    buffer_load_dwordx4 v200, s[12:15], s30 offen offset:2048 lds
    v_mul_f32 v180, v2, v2
    v_mul_f32 v181, v3, v3
    v_fmaak_f32 v180, v180, v207, 0xc0135761
    v_mfma_f32_32x32x16_bf16 v[64:79], v[228:231], a[20:23], v[64:79]
    ds_read_b64_tr_b16 v[220:221], v202 offset:18432
    ds_read_b64_tr_b16 v[222:223], v202 offset:18944
    v_fmaak_f32 v181, v181, v207, 0xc0135761
    v_mul_f32 v180, v180, v2
    v_mfma_f32_32x32x16_bf16 v[80:95], v[228:231], a[164:167], v[80:95]
    s_cmp_eq_u32 s40, 3
    s_cbranch_scc0 gated_mix__spectral_gfnet__glu_gated_geglu__prompt_kernel_np0
    buffer_store_dwordx4 v[232:235], v206, s[20:23], s100 offen sc1
    s_add_u32 s100, s100, 1024
    buffer_store_dwordx4 v[232:235], v206, s[20:23], s100 offen sc1
    s_add_u32 s100, s100, 1024
    buffer_store_dwordx4 v[232:235], v206, s[20:23], s100 offen sc1
    s_add_u32 s100, s100, 1024
    buffer_store_dwordx4 v[232:235], v206, s[20:23], s100 offen sc1
    s_add_u32 s100, s100, 1024
gated_mix__spectral_gfnet__glu_gated_geglu__prompt_kernel_np0:
    s_waitcnt lgkmcnt(4)
    v_mfma_f32_32x32x16_bf16 v[64:79], v[208:211], a[24:27], v[64:79]
    ds_read_b64_tr_b16 v[224:225], v202 offset:20480
    ds_read_b64_tr_b16 v[226:227], v202 offset:20992
    v_mul_f32 v181, v181, v3
    v_exp_f32 v180, v180
    v_mfma_f32_32x32x16_bf16 v[80:95], v[208:211], a[168:171], v[80:95]
    buffer_load_dwordx4 v200, s[12:15], s31 offen offset:3072 lds
    v_mul_f32 v182, v2, v6
    v_exp_f32 v181, v181
    v_mfma_f32_32x32x16_bf16 v[64:79], v[212:215], a[28:31], v[64:79]
    ds_read_b64_tr_b16 v[228:229], v202 offset:22528
    ds_read_b64_tr_b16 v[230:231], v202 offset:23040
    v_mul_f32 v183, v3, v7
    v_add_f32 v180, 1.0, v180
    v_mfma_f32_32x32x16_bf16 v[80:95], v[212:215], a[172:175], v[80:95]
    v_add_f32 v181, 1.0, v181
    v_rcp_f32 v180, v180
    s_waitcnt lgkmcnt(4)
    v_mfma_f32_32x32x16_bf16 v[64:79], v[216:219], a[32:35], v[64:79]
    ds_read_b64_tr_b16 v[208:209], v203 offset:0
    ds_read_b64_tr_b16 v[210:211], v203 offset:512
    s_add_u32 m0, s39, 4096
    v_rcp_f32 v181, v181
    v_mfma_f32_32x32x16_bf16 v[80:95], v[216:219], a[176:179], v[80:95]
    buffer_load_dwordx4 v200, s[12:15], s32 offen offset:0 lds
    v_mul_f32 v182, v182, v180
    v_mul_f32 v183, v183, v181
    v_mfma_f32_32x32x16_bf16 v[64:79], v[220:223], a[36:39], v[64:79]
    ds_read_b64_tr_b16 v[212:213], v203 offset:2048
    ds_read_b64_tr_b16 v[214:215], v203 offset:2560
    v_cvt_pk_bf16_f32 v193, v182, v183
    v_mul_f32 v184, v8, v8
    v_mul_f32 v185, v9, v9
    v_mfma_f32_32x32x16_bf16 v[80:95], v[220:223], a[180:183], v[80:95]
    v_fmaak_f32 v184, v184, v207, 0xc0135761
    v_fmaak_f32 v185, v185, v207, 0xc0135761
    v_mul_f32 v184, v184, v8
    s_waitcnt lgkmcnt(4)
    v_mfma_f32_32x32x16_bf16 v[64:79], v[224:227], a[40:43], v[64:79]
    ds_read_b64_tr_b16 v[216:217], v203 offset:4096
    ds_read_b64_tr_b16 v[218:219], v203 offset:4608
    v_mul_f32 v185, v185, v9
    v_exp_f32 v184, v184
    v_mfma_f32_32x32x16_bf16 v[80:95], v[224:227], a[184:187], v[80:95]
    buffer_load_dwordx4 v200, s[12:15], s33 offen offset:1024 lds
    v_mul_f32 v186, v8, v12
    v_exp_f32 v185, v185
    v_mfma_f32_32x32x16_bf16 v[64:79], v[228:231], a[44:47], v[64:79]
    ds_read_b64_tr_b16 v[220:221], v203 offset:6144
    ds_read_b64_tr_b16 v[222:223], v203 offset:6656
    v_mul_f32 v187, v9, v13
    v_add_f32 v184, 1.0, v184
    v_mfma_f32_32x32x16_bf16 v[80:95], v[228:231], a[188:191], v[80:95]
    v_add_f32 v185, 1.0, v185
    v_rcp_f32 v184, v184
    s_waitcnt lgkmcnt(4)
    v_mfma_f32_32x32x16_bf16 v[96:111], v[208:211], a[0:3], 0
    ds_read_b64_tr_b16 v[224:225], v203 offset:8192
    ds_read_b64_tr_b16 v[226:227], v203 offset:8704
    s_add_u32 m0, s39, 24576
    v_rcp_f32 v185, v185
    v_mfma_f32_32x32x16_bf16 v[112:127], v[208:211], a[144:147], 0
    buffer_load_dwordx4 v201, s[16:19], s28 offen offset:0 lds
    v_mul_f32 v186, v186, v184
    v_mul_f32 v187, v187, v185
    v_mfma_f32_32x32x16_bf16 v[96:111], v[212:215], a[4:7], v[96:111]
    ds_read_b64_tr_b16 v[228:229], v203 offset:10240
    ds_read_b64_tr_b16 v[230:231], v203 offset:10752
    v_cvt_pk_bf16_f32 v194, v186, v187
    v_mul_f32 v188, v10, v10
    v_mul_f32 v189, v11, v11
    v_mfma_f32_32x32x16_bf16 v[112:127], v[212:215], a[148:151], v[112:127]
    v_fmaak_f32 v188, v188, v207, 0xc0135761
    v_fmaak_f32 v189, v189, v207, 0xc0135761
    v_mul_f32 v188, v188, v10
    s_waitcnt lgkmcnt(4)
    v_mfma_f32_32x32x16_bf16 v[96:111], v[216:219], a[8:11], v[96:111]
    ds_read_b64_tr_b16 v[208:209], v203 offset:12288
    ds_read_b64_tr_b16 v[210:211], v203 offset:12800
    v_mul_f32 v189, v189, v11
    v_exp_f32 v188, v188
    v_mfma_f32_32x32x16_bf16 v[112:127], v[216:219], a[152:155], v[112:127]
    buffer_load_dwordx4 v201, s[16:19], s29 offen offset:1024 lds
    v_mul_f32 v190, v10, v14
    v_mfma_f32_32x32x16_bf16 v[96:111], v[220:223], a[12:15], v[96:111]
    ds_read_b64_tr_b16 v[212:213], v203 offset:14336
    ds_read_b64_tr_b16 v[214:215], v203 offset:14848
    v_exp_f32 v189, v189
    v_mul_f32 v191, v11, v15
    v_mfma_f32_32x32x16_bf16 v[112:127], v[220:223], a[156:159], v[112:127]
    v_add_f32 v188, 1.0, v188
    v_add_f32 v189, 1.0, v189
    v_rcp_f32 v188, v188
    s_waitcnt lgkmcnt(4)
    v_mfma_f32_32x32x16_bf16 v[96:111], v[224:227], a[16:19], v[96:111]
    ds_read_b64_tr_b16 v[216:217], v203 offset:16384
    ds_read_b64_tr_b16 v[218:219], v203 offset:16896
    v_rcp_f32 v189, v189
    v_mfma_f32_32x32x16_bf16 v[112:127], v[224:227], a[160:163], v[112:127]
    buffer_load_dwordx4 v201, s[16:19], s30 offen offset:2048 lds
    v_mul_f32 v190, v190, v188
    v_mul_f32 v191, v191, v189
    v_cvt_pk_bf16_f32 v195, v190, v191
    v_mfma_f32_32x32x16_bf16 v[96:111], v[228:231], a[20:23], v[96:111]
    ds_read_b64_tr_b16 v[220:221], v203 offset:18432
    ds_read_b64_tr_b16 v[222:223], v203 offset:18944
    buffer_store_dwordx4 v[192:195], v206, s[20:23], s36 offen offset:0 sc1
    v_mfma_f32_32x32x16_bf16 v[112:127], v[228:231], a[164:167], v[112:127]
    v_mul_f32 v176, v16, v16
    v_mul_f32 v177, v17, v17
    v_fmaak_f32 v176, v176, v207, 0xc0135761
    s_waitcnt lgkmcnt(4)
    v_mfma_f32_32x32x16_bf16 v[96:111], v[208:211], a[24:27], v[96:111]
    ds_read_b64_tr_b16 v[224:225], v203 offset:20480
    ds_read_b64_tr_b16 v[226:227], v203 offset:20992
    v_fmaak_f32 v177, v177, v207, 0xc0135761
    v_mul_f32 v176, v176, v16
    v_mul_f32 v177, v177, v17
    v_mfma_f32_32x32x16_bf16 v[112:127], v[208:211], a[168:171], v[112:127]
    buffer_load_dwordx4 v201, s[16:19], s31 offen offset:3072 lds
    v_exp_f32 v176, v176
    v_mfma_f32_32x32x16_bf16 v[96:111], v[212:215], a[28:31], v[96:111]
    ds_read_b64_tr_b16 v[228:229], v203 offset:22528
    ds_read_b64_tr_b16 v[230:231], v203 offset:23040
    v_mul_f32 v178, v16, v20
    v_exp_f32 v177, v177
    v_mfma_f32_32x32x16_bf16 v[112:127], v[212:215], a[172:175], v[112:127]
    v_mul_f32 v179, v17, v21
    v_add_f32 v176, 1.0, v176
    v_add_f32 v177, 1.0, v177
    s_waitcnt lgkmcnt(4)
    v_mfma_f32_32x32x16_bf16 v[96:111], v[216:219], a[32:35], v[96:111]
    s_add_u32 m0, s39, 28672
    v_rcp_f32 v176, v176
    v_mfma_f32_32x32x16_bf16 v[112:127], v[216:219], a[176:179], v[112:127]
    buffer_load_dwordx4 v201, s[16:19], s32 offen offset:0 lds
    v_rcp_f32 v177, v177
    v_mul_f32 v178, v178, v176
    v_mfma_f32_32x32x16_bf16 v[96:111], v[220:223], a[36:39], v[96:111]
    s_add_u32 s39, s38, s34
    s_add_u32 s38, s38, 49152
    s_cmp_eq_u32 s38, 147456
    s_cselect_b32 s38, 0, s38
    v_add_u32 v202, s38, v204
    v_add_u32 v203, s38, v205
    v_mfma_f32_32x32x16_bf16 v[112:127], v[220:223], a[180:183], v[112:127]
    v_mul_f32 v179, v179, v177
    v_cvt_pk_bf16_f32 v196, v178, v179
    v_mul_f32 v180, v18, v18
    v_mul_f32 v181, v19, v19
    s_waitcnt lgkmcnt(0)
    v_mfma_f32_32x32x16_bf16 v[96:111], v[224:227], a[40:43], v[96:111]
    s_waitcnt vmcnt(13) lgkmcnt(0)
    s_barrier
    ds_read_b64_tr_b16 v[208:209], v202 offset:0
    ds_read_b64_tr_b16 v[210:211], v202 offset:512
    ds_read_b64_tr_b16 v[212:213], v202 offset:2048
    ds_read_b64_tr_b16 v[214:215], v202 offset:2560
    v_mfma_f32_32x32x16_bf16 v[112:127], v[224:227], a[184:187], v[112:127]
    buffer_load_dwordx4 v201, s[16:19], s33 offen offset:1024 lds
    v_fmaak_f32 v180, v180, v207, 0xc0135761
    v_fmaak_f32 v181, v181, v207, 0xc0135761
    v_mfma_f32_32x32x16_bf16 v[96:111], v[228:231], a[44:47], v[96:111]
    ds_read_b64_tr_b16 v[216:217], v202 offset:4096
    ds_read_b64_tr_b16 v[218:219], v202 offset:4608
    ds_read_b64_tr_b16 v[220:221], v202 offset:6144
    ds_read_b64_tr_b16 v[222:223], v202 offset:6656
    v_mul_f32 v180, v180, v18
    v_mfma_f32_32x32x16_bf16 v[112:127], v[228:231], a[188:191], v[112:127]
    v_add_u32 v200, 0xffca0080, v200
    v_add_u32 v201, 0xffca0080, v201
    v_mul_f32 v181, v181, v19
    s_cmp_eq_u32 s40, 3
    s_cbranch_scc1 gated_mix__spectral_gfnet__glu_gated_geglu__prompt_kernel_h1
gated_mix__spectral_gfnet__glu_gated_geglu__prompt_kernel_h1r:
    s_waitcnt lgkmcnt(4)
    v_mfma_f32_32x32x16_bf16 v[64:79], v[208:211], a[48:51], v[64:79]
    ds_read_b64_tr_b16 v[224:225], v202 offset:8192
    ds_read_b64_tr_b16 v[226:227], v202 offset:8704
    s_add_u32 m0, s39, 0
    v_exp_f32 v180, v180
    v_mfma_f32_32x32x16_bf16 v[80:95], v[208:211], a[192:195], v[80:95]
    buffer_load_dwordx4 v200, s[12:15], s28 offen offset:0 lds
    v_mul_f32 v182, v18, v22
    v_exp_f32 v181, v181
    v_mfma_f32_32x32x16_bf16 v[64:79], v[212:215], a[52:55], v[64:79]
    ds_read_b64_tr_b16 v[228:229], v202 offset:10240
    ds_read_b64_tr_b16 v[230:231], v202 offset:10752
    v_mul_f32 v183, v19, v23
    v_add_f32 v180, 1.0, v180
    v_mfma_f32_32x32x16_bf16 v[80:95], v[212:215], a[196:199], v[80:95]
    s_cmp_eq_u32 s40, 3
    s_cbranch_scc0 gated_mix__spectral_gfnet__glu_gated_geglu__prompt_kernel_np1
    buffer_store_dwordx4 v[232:235], v206, s[20:23], s100 offen sc1
    s_add_u32 s100, s100, 1024
    buffer_store_dwordx4 v[232:235], v206, s[20:23], s100 offen sc1
    s_add_u32 s100, s100, 1024
    buffer_store_dwordx4 v[232:235], v206, s[20:23], s100 offen sc1
    s_add_u32 s100, s100, 1024
    buffer_store_dwordx4 v[232:235], v206, s[20:23], s100 offen sc1
    s_add_u32 s100, s100, 1024
gated_mix__spectral_gfnet__glu_gated_geglu__prompt_kernel_np1:
    s_waitcnt lgkmcnt(4)
    v_mfma_f32_32x32x16_bf16 v[64:79], v[216:219], a[56:59], v[64:79]
    ds_read_b64_tr_b16 v[208:209], v202 offset:12288
    ds_read_b64_tr_b16 v[210:211], v202 offset:12800
    v_add_f32 v181, 1.0, v181
    v_rcp_f32 v180, v180
    v_mfma_f32_32x32x16_bf16 v[80:95], v[216:219], a[200:203], v[80:95]
    buffer_load_dwordx4 v200, s[12:15], s29 offen offset:1024 lds
    v_rcp_f32 v181, v181
    v_mfma_f32_32x32x16_bf16 v[64:79], v[220:223], a[60:63], v[64:79]
    ds_read_b64_tr_b16 v[212:213], v202 offset:14336
    ds_read_b64_tr_b16 v[214:215], v202 offset:14848
    v_mul_f32 v182, v182, v180
    v_mul_f32 v183, v183, v181
    v_mfma_f32_32x32x16_bf16 v[80:95], v[220:223], a[204:207], v[80:95]
    v_cvt_pk_bf16_f32 v197, v182, v183
    v_mul_f32 v184, v24, v24
    v_mul_f32 v185, v25, v25
    v_fmaak_f32 v184, v184, v207, 0xc0135761
    s_waitcnt lgkmcnt(4)
    v_mfma_f32_32x32x16_bf16 v[64:79], v[224:227], a[64:67], v[64:79]
    ds_read_b64_tr_b16 v[216:217], v202 offset:16384
    ds_read_b64_tr_b16 v[218:219], v202 offset:16896
    v_fmaak_f32 v185, v185, v207, 0xc0135761
    v_mul_f32 v184, v184, v24
    v_mfma_f32_32x32x16_bf16 v[80:95], v[224:227], a[208:211], v[80:95]
    buffer_load_dwordx4 v200, s[12:15], s30 offen offset:2048 lds
    v_mul_f32 v185, v185, v25
    v_exp_f32 v184, v184
    v_mfma_f32_32x32x16_bf16 v[64:79], v[228:231], a[68:71], v[64:79]
    ds_read_b64_tr_b16 v[220:221], v202 offset:18432
    ds_read_b64_tr_b16 v[222:223], v202 offset:18944
    v_mul_f32 v186, v24, v28
    v_exp_f32 v185, v185
    v_mfma_f32_32x32x16_bf16 v[80:95], v[228:231], a[212:215], v[80:95]
    v_mul_f32 v187, v25, v29
    v_add_f32 v184, 1.0, v184
    s_waitcnt lgkmcnt(4)
    v_mfma_f32_32x32x16_bf16 v[64:79], v[208:211], a[72:75], v[64:79]
    ds_read_b64_tr_b16 v[224:225], v202 offset:20480
    ds_read_b64_tr_b16 v[226:227], v202 offset:20992
    v_add_f32 v185, 1.0, v185
    v_rcp_f32 v184, v184
    v_mfma_f32_32x32x16_bf16 v[80:95], v[208:211], a[216:219], v[80:95]
    buffer_load_dwordx4 v200, s[12:15], s31 offen offset:3072 lds
    v_rcp_f32 v185, v185
    v_mfma_f32_32x32x16_bf16 v[64:79], v[212:215], a[76:79], v[64:79]
    ds_read_b64_tr_b16 v[228:229], v202 offset:22528
    ds_read_b64_tr_b16 v[230:231], v202 offset:23040
    v_mul_f32 v186, v186, v184
    v_mul_f32 v187, v187, v185
    v_cvt_pk_bf16_f32 v198, v186, v187
    v_mfma_f32_32x32x16_bf16 v[80:95], v[212:215], a[220:223], v[80:95]
    v_mul_f32 v188, v26, v26
    v_mul_f32 v189, v27, v27
    v_fmaak_f32 v188, v188, v207, 0xc0135761
    s_waitcnt lgkmcnt(4)
    v_mfma_f32_32x32x16_bf16 v[64:79], v[216:219], a[80:83], v[64:79]
    ds_read_b64_tr_b16 v[208:209], v203 offset:0
    ds_read_b64_tr_b16 v[210:211], v203 offset:512
    s_add_u32 m0, s39, 4096
    v_fmaak_f32 v189, v189, v207, 0xc0135761
    v_mul_f32 v188, v188, v26
    v_mfma_f32_32x32x16_bf16 v[80:95], v[216:219], a[224:227], v[80:95]
    buffer_load_dwordx4 v200, s[12:15], s32 offen offset:0 lds
    v_mul_f32 v189, v189, v27
    v_exp_f32 v188, v188
    v_mfma_f32_32x32x16_bf16 v[64:79], v[220:223], a[84:87], v[64:79]
    ds_read_b64_tr_b16 v[212:213], v203 offset:2048
    ds_read_b64_tr_b16 v[214:215], v203 offset:2560
    v_mul_f32 v190, v26, v30
    v_mfma_f32_32x32x16_bf16 v[80:95], v[220:223], a[228:231], v[80:95]
    v_exp_f32 v189, v189
    v_mul_f32 v191, v27, v31
    v_add_f32 v188, 1.0, v188
    s_waitcnt lgkmcnt(4)
    v_mfma_f32_32x32x16_bf16 v[64:79], v[224:227], a[88:91], v[64:79]
    ds_read_b64_tr_b16 v[216:217], v203 offset:4096
    ds_read_b64_tr_b16 v[218:219], v203 offset:4608
    v_add_f32 v189, 1.0, v189
    v_rcp_f32 v188, v188
    v_mfma_f32_32x32x16_bf16 v[80:95], v[224:227], a[232:235], v[80:95]
    buffer_load_dwordx4 v200, s[12:15], s33 offen offset:1024 lds
    v_rcp_f32 v189, v189
    v_mfma_f32_32x32x16_bf16 v[64:79], v[228:231], a[92:95], v[64:79]
    ds_read_b64_tr_b16 v[220:221], v203 offset:6144
    ds_read_b64_tr_b16 v[222:223], v203 offset:6656
    v_mul_f32 v190, v190, v188
    v_mul_f32 v191, v191, v189
    v_cvt_pk_bf16_f32 v199, v190, v191
    v_mfma_f32_32x32x16_bf16 v[80:95], v[228:231], a[236:239], v[80:95]
    buffer_store_dwordx4 v[196:199], v206, s[20:23], s37 offen offset:0 sc1
    v_mul_f32 v176, v32, v32
    s_waitcnt lgkmcnt(4)
    v_mfma_f32_32x32x16_bf16 v[96:111], v[208:211], a[48:51], v[96:111]
    ds_read_b64_tr_b16 v[224:225], v203 offset:8192
    ds_read_b64_tr_b16 v[226:227], v203 offset:8704
    s_add_u32 m0, s39, 24576
    v_mul_f32 v177, v33, v33
    v_fmaak_f32 v176, v176, v207, 0xc0135761
    v_mfma_f32_32x32x16_bf16 v[112:127], v[208:211], a[192:195], v[112:127]
    buffer_load_dwordx4 v201, s[16:19], s28 offen offset:0 lds
    v_fmaak_f32 v177, v177, v207, 0xc0135761
    v_mul_f32 v176, v176, v32
    v_mfma_f32_32x32x16_bf16 v[96:111], v[212:215], a[52:55], v[96:111]
    ds_read_b64_tr_b16 v[228:229], v203 offset:10240
    ds_read_b64_tr_b16 v[230:231], v203 offset:10752
    v_mul_f32 v177, v177, v33
    v_exp_f32 v176, v176
    v_mfma_f32_32x32x16_bf16 v[112:127], v[212:215], a[196:199], v[112:127]
    v_mul_f32 v178, v32, v36
    v_exp_f32 v177, v177
    s_waitcnt lgkmcnt(4)
    v_mfma_f32_32x32x16_bf16 v[96:111], v[216:219], a[56:59], v[96:111]
    ds_read_b64_tr_b16 v[208:209], v203 offset:12288
    ds_read_b64_tr_b16 v[210:211], v203 offset:12800
    v_mul_f32 v179, v33, v37
    v_add_f32 v176, 1.0, v176
    v_mfma_f32_32x32x16_bf16 v[112:127], v[216:219], a[200:203], v[112:127]
    buffer_load_dwordx4 v201, s[16:19], s29 offen offset:1024 lds
    v_add_f32 v177, 1.0, v177
    v_rcp_f32 v176, v176
    v_mfma_f32_32x32x16_bf16 v[96:111], v[220:223], a[60:63], v[96:111]
    ds_read_b64_tr_b16 v[212:213], v203 offset:14336
    ds_read_b64_tr_b16 v[214:215], v203 offset:14848
    v_rcp_f32 v177, v177
    v_mfma_f32_32x32x16_bf16 v[112:127], v[220:223], a[204:207], v[112:127]
    v_mul_f32 v178, v178, v176
    v_mul_f32 v179, v179, v177
    v_cvt_pk_bf16_f32 v192, v178, v179
    s_waitcnt lgkmcnt(4)
    v_mfma_f32_32x32x16_bf16 v[96:111], v[224:227], a[64:67], v[96:111]
    ds_read_b64_tr_b16 v[216:217], v203 offset:16384
    ds_read_b64_tr_b16 v[218:219], v203 offset:16896
    v_mul_f32 v180, v34, v34
    v_mul_f32 v181, v35, v35
    v_fmaak_f32 v180, v180, v207, 0xc0135761
    v_mfma_f32_32x32x16_bf16 v[112:127], v[224:227], a[208:211], v[112:127]
    buffer_load_dwordx4 v201, s[16:19], s30 offen offset:2048 lds
    v_fmaak_f32 v181, v181, v207, 0xc0135761
    v_mul_f32 v180, v180, v34
    v_mfma_f32_32x32x16_bf16 v[96:111], v[228:231], a[68:71], v[96:111]
    ds_read_b64_tr_b16 v[220:221], v203 offset:18432
    ds_read_b64_tr_b16 v[222:223], v203 offset:18944
    v_mul_f32 v181, v181, v35
    v_exp_f32 v180, v180
    v_mfma_f32_32x32x16_bf16 v[112:127], v[228:231], a[212:215], v[112:127]
    v_mul_f32 v182, v34, v38
    v_exp_f32 v181, v181
    s_waitcnt lgkmcnt(4)
    v_mfma_f32_32x32x16_bf16 v[96:111], v[208:211], a[72:75], v[96:111]
    ds_read_b64_tr_b16 v[224:225], v203 offset:20480
    ds_read_b64_tr_b16 v[226:227], v203 offset:20992
    v_mul_f32 v183, v35, v39
    v_add_f32 v180, 1.0, v180
    v_add_f32 v181, 1.0, v181
    v_mfma_f32_32x32x16_bf16 v[112:127], v[208:211], a[216:219], v[112:127]
    buffer_load_dwordx4 v201, s[16:19], s31 offen offset:3072 lds
    v_rcp_f32 v180, v180
    v_mfma_f32_32x32x16_bf16 v[96:111], v[212:215], a[76:79], v[96:111]
    ds_read_b64_tr_b16 v[228:229], v203 offset:22528
    ds_read_b64_tr_b16 v[230:231], v203 offset:23040
    v_rcp_f32 v181, v181
    v_mul_f32 v182, v182, v180
    v_mfma_f32_32x32x16_bf16 v[112:127], v[212:215], a[220:223], v[112:127]
    v_mul_f32 v183, v183, v181
    v_cvt_pk_bf16_f32 v193, v182, v183
    v_mul_f32 v184, v40, v40
    s_waitcnt lgkmcnt(4)
    v_mfma_f32_32x32x16_bf16 v[96:111], v[216:219], a[80:83], v[96:111]
    s_add_u32 m0, s39, 28672
    v_mul_f32 v185, v41, v41
    v_fmaak_f32 v184, v184, v207, 0xc0135761
    v_fmaak_f32 v185, v185, v207, 0xc0135761
    v_mfma_f32_32x32x16_bf16 v[112:127], v[216:219], a[224:227], v[112:127]
    buffer_load_dwordx4 v201, s[16:19], s32 offen offset:0 lds
    v_mul_f32 v184, v184, v40
    v_mul_f32 v185, v185, v41
    v_mfma_f32_32x32x16_bf16 v[96:111], v[220:223], a[84:87], v[96:111]
    s_add_u32 s39, s38, s34
    s_add_u32 s38, s38, 49152
    s_cmp_eq_u32 s38, 147456
    s_cselect_b32 s38, 0, s38
    v_add_u32 v202, s38, v204
    v_add_u32 v203, s38, v205
    v_mfma_f32_32x32x16_bf16 v[112:127], v[220:223], a[228:231], v[112:127]
    s_cmp_eq_u32 s40, 3
    s_cbranch_scc0 gated_mix__spectral_gfnet__glu_gated_geglu__prompt_kernel_np2
    buffer_store_dwordx4 v[232:235], v206, s[20:23], s100 offen sc1
    s_add_u32 s100, s100, 1024
    buffer_store_dwordx4 v[232:235], v206, s[20:23], s100 offen sc1
    s_add_u32 s100, s100, 1024
    buffer_store_dwordx4 v[232:235], v206, s[20:23], s100 offen sc1
    s_add_u32 s100, s100, 1024
    buffer_store_dwordx4 v[232:235], v206, s[20:23], s100 offen sc1
    s_add_u32 s100, s100, 1024
gated_mix__spectral_gfnet__glu_gated_geglu__prompt_kernel_np2:
    s_waitcnt lgkmcnt(0)
    v_mfma_f32_32x32x16_bf16 v[96:111], v[224:227], a[88:91], v[96:111]
    s_waitcnt vmcnt(12) lgkmcnt(0)
    s_barrier
    ds_read_b64_tr_b16 v[208:209], v202 offset:0
    ds_read_b64_tr_b16 v[210:211], v202 offset:512
    ds_read_b64_tr_b16 v[212:213], v202 offset:2048
    ds_read_b64_tr_b16 v[214:215], v202 offset:2560
    v_mfma_f32_32x32x16_bf16 v[112:127], v[224:227], a[232:235], v[112:127]
    buffer_load_dwordx4 v201, s[16:19], s33 offen offset:1024 lds
    v_exp_f32 v184, v184
    v_mul_f32 v186, v40, v44
    v_mfma_f32_32x32x16_bf16 v[96:111], v[228:231], a[92:95], v[96:111]
    ds_read_b64_tr_b16 v[216:217], v202 offset:4096
    ds_read_b64_tr_b16 v[218:219], v202 offset:4608
    ds_read_b64_tr_b16 v[220:221], v202 offset:6144
    ds_read_b64_tr_b16 v[222:223], v202 offset:6656
    v_exp_f32 v185, v185
    v_mfma_f32_32x32x16_bf16 v[112:127], v[228:231], a[236:239], v[112:127]
    v_add_u32 v200, s35, v200
    v_add_u32 v201, s35, v201
    v_mul_f32 v187, v41, v45
    s_waitcnt lgkmcnt(4)
    v_mfma_f32_32x32x16_bf16 v[64:79], v[208:211], a[96:99], v[64:79]
    ds_read_b64_tr_b16 v[224:225], v202 offset:8192
    ds_read_b64_tr_b16 v[226:227], v202 offset:8704
    s_add_u32 m0, s39, 0
    v_add_f32 v184, 1.0, v184
    v_add_f32 v185, 1.0, v185
    v_mfma_f32_32x32x16_bf16 v[80:95], v[208:211], a[240:243], v[80:95]
    buffer_load_dwordx4 v200, s[12:15], s28 offen offset:0 lds
    v_rcp_f32 v184, v184
    v_mfma_f32_32x32x16_bf16 v[64:79], v[212:215], a[100:103], v[64:79]
    ds_read_b64_tr_b16 v[228:229], v202 offset:10240
    ds_read_b64_tr_b16 v[230:231], v202 offset:10752
    v_rcp_f32 v185, v185
    v_mul_f32 v186, v186, v184
    v_mfma_f32_32x32x16_bf16 v[80:95], v[212:215], a[244:247], v[80:95]
    v_mul_f32 v187, v187, v185
    v_cvt_pk_bf16_f32 v194, v186, v187
    v_mul_f32 v188, v42, v42
    s_waitcnt lgkmcnt(4)
    v_mfma_f32_32x32x16_bf16 v[64:79], v[216:219], a[104:107], v[64:79]
    ds_read_b64_tr_b16 v[208:209], v202 offset:12288
    ds_read_b64_tr_b16 v[210:211], v202 offset:12800
    v_mul_f32 v189, v43, v43
    v_fmaak_f32 v188, v188, v207, 0xc0135761
    v_fmaak_f32 v189, v189, v207, 0xc0135761
    v_mfma_f32_32x32x16_bf16 v[80:95], v[216:219], a[248:251], v[80:95]
    buffer_load_dwordx4 v200, s[12:15], s29 offen offset:1024 lds
    v_mul_f32 v188, v188, v42
    v_mul_f32 v189, v189, v43
    v_mfma_f32_32x32x16_bf16 v[64:79], v[220:223], a[108:111], v[64:79]
    ds_read_b64_tr_b16 v[212:213], v202 offset:14336
    ds_read_b64_tr_b16 v[214:215], v202 offset:14848
    v_exp_f32 v188, v188
    v_mul_f32 v190, v42, v46
    v_mfma_f32_32x32x16_bf16 v[80:95], v[220:223], a[252:255], v[80:95]
    v_exp_f32 v189, v189
    v_mul_f32 v191, v43, v47
    s_waitcnt lgkmcnt(4)
    v_mfma_f32_32x32x16_bf16 v[64:79], v[224:227], a[112:115], v[64:79]
    ds_read_b64_tr_b16 v[216:217], v202 offset:16384
    ds_read_b64_tr_b16 v[218:219], v202 offset:16896
    v_add_f32 v188, 1.0, v188
    v_add_f32 v189, 1.0, v189
    v_mfma_f32_32x32x16_bf16 v[80:95], v[224:227], v[144:147], v[80:95]
    buffer_load_dwordx4 v200, s[12:15], s30 offen offset:2048 lds
    v_rcp_f32 v188, v188
    v_mfma_f32_32x32x16_bf16 v[64:79], v[228:231], a[116:119], v[64:79]
    ds_read_b64_tr_b16 v[220:221], v202 offset:18432
    ds_read_b64_tr_b16 v[222:223], v202 offset:18944
    v_rcp_f32 v189, v189
    v_mul_f32 v190, v190, v188
    v_mfma_f32_32x32x16_bf16 v[80:95], v[228:231], v[148:151], v[80:95]
    v_mul_f32 v191, v191, v189
    v_cvt_pk_bf16_f32 v195, v190, v191
    buffer_store_dwordx4 v[192:195], v206, s[20:23], s36 offen offset:1024 sc1
    s_waitcnt lgkmcnt(4)
    v_mfma_f32_32x32x16_bf16 v[64:79], v[208:211], a[120:123], v[64:79]
    ds_read_b64_tr_b16 v[224:225], v202 offset:20480
    ds_read_b64_tr_b16 v[226:227], v202 offset:20992
    v_mul_f32 v176, v48, v48
    v_mul_f32 v177, v49, v49
    v_mfma_f32_32x32x16_bf16 v[80:95], v[208:211], v[152:155], v[80:95]
    buffer_load_dwordx4 v200, s[12:15], s31 offen offset:3072 lds
    v_fmaak_f32 v176, v176, v207, 0xc0135761
    v_fmaak_f32 v177, v177, v207, 0xc0135761
    v_mfma_f32_32x32x16_bf16 v[64:79], v[212:215], a[124:127], v[64:79]
    ds_read_b64_tr_b16 v[228:229], v202 offset:22528
    ds_read_b64_tr_b16 v[230:231], v202 offset:23040
    v_mul_f32 v176, v176, v48
    v_mul_f32 v177, v177, v49
    v_mfma_f32_32x32x16_bf16 v[80:95], v[212:215], v[156:159], v[80:95]
    v_exp_f32 v176, v176
    v_mul_f32 v178, v48, v52
    v_exp_f32 v177, v177
    s_waitcnt lgkmcnt(4)
    v_mfma_f32_32x32x16_bf16 v[64:79], v[216:219], a[128:131], v[64:79]
    ds_read_b64_tr_b16 v[208:209], v203 offset:0
    ds_read_b64_tr_b16 v[210:211], v203 offset:512
    s_add_u32 m0, s39, 4096
    v_mul_f32 v179, v49, v53
    v_mfma_f32_32x32x16_bf16 v[80:95], v[216:219], v[160:163], v[80:95]
    buffer_load_dwordx4 v200, s[12:15], s32 offen offset:0 lds
    v_add_f32 v176, 1.0, v176
    v_add_f32 v177, 1.0, v177
    v_mfma_f32_32x32x16_bf16 v[64:79], v[220:223], a[132:135], v[64:79]
    ds_read_b64_tr_b16 v[212:213], v203 offset:2048
    ds_read_b64_tr_b16 v[214:215], v203 offset:2560
    v_rcp_f32 v176, v176
    v_rcp_f32 v177, v177
    v_mfma_f32_32x32x16_bf16 v[80:95], v[220:223], v[164:167], v[80:95]
    v_mul_f32 v178, v178, v176
    v_mul_f32 v179, v179, v177
    s_waitcnt lgkmcnt(4)
    v_mfma_f32_32x32x16_bf16 v[64:79], v[224:227], a[136:139], v[64:79]
    ds_read_b64_tr_b16 v[216:217], v203 offset:4096
    ds_read_b64_tr_b16 v[218:219], v203 offset:4608
    v_cvt_pk_bf16_f32 v196, v178, v179
    v_mul_f32 v180, v50, v50
    v_mul_f32 v181, v51, v51
    v_mfma_f32_32x32x16_bf16 v[80:95], v[224:227], v[168:171], v[80:95]
    buffer_load_dwordx4 v200, s[12:15], s33 offen offset:1024 lds
    v_fmaak_f32 v180, v180, v207, 0xc0135761
    v_fmaak_f32 v181, v181, v207, 0xc0135761
    v_mfma_f32_32x32x16_bf16 v[64:79], v[228:231], a[140:143], v[64:79]
    ds_read_b64_tr_b16 v[220:221], v203 offset:6144
    ds_read_b64_tr_b16 v[222:223], v203 offset:6656
    v_mul_f32 v180, v180, v50
    v_mul_f32 v181, v181, v51
    v_mfma_f32_32x32x16_bf16 v[80:95], v[228:231], v[172:175], v[80:95]
    v_exp_f32 v180, v180
    v_mul_f32 v182, v50, v54
    s_waitcnt lgkmcnt(4)
    v_mfma_f32_32x32x16_bf16 v[96:111], v[208:211], a[96:99], v[96:111]
    ds_read_b64_tr_b16 v[224:225], v203 offset:8192
    ds_read_b64_tr_b16 v[226:227], v203 offset:8704
    s_add_u32 m0, s39, 24576
    v_exp_f32 v181, v181
    v_mul_f32 v183, v51, v55
    v_mfma_f32_32x32x16_bf16 v[112:127], v[208:211], a[240:243], v[112:127]
    buffer_load_dwordx4 v201, s[16:19], s28 offen offset:0 lds
    v_add_f32 v180, 1.0, v180
    v_add_f32 v181, 1.0, v181
    v_mfma_f32_32x32x16_bf16 v[96:111], v[212:215], a[100:103], v[96:111]
    ds_read_b64_tr_b16 v[228:229], v203 offset:10240
    ds_read_b64_tr_b16 v[230:231], v203 offset:10752
    v_rcp_f32 v180, v180
    v_mfma_f32_32x32x16_bf16 v[112:127], v[212:215], a[244:247], v[112:127]
    v_rcp_f32 v181, v181
    v_mul_f32 v182, v182, v180
    v_mul_f32 v183, v183, v181
    s_waitcnt lgkmcnt(4)
    v_mfma_f32_32x32x16_bf16 v[96:111], v[216:219], a[104:107], v[96:111]
    ds_read_b64_tr_b16 v[208:209], v203 offset:12288
    ds_read_b64_tr_b16 v[210:211], v203 offset:12800
    v_cvt_pk_bf16_f32 v197, v182, v183
    v_mul_f32 v184, v56, v56
    v_mfma_f32_32x32x16_bf16 v[112:127], v[216:219], a[248:251], v[112:127]
    buffer_load_dwordx4 v201, s[16:19], s29 offen offset:1024 lds
    v_mul_f32 v185, v57, v57
    v_fmaak_f32 v184, v184, v207, 0xc0135761
    v_fmaak_f32 v185, v185, v207, 0xc0135761
    v_mfma_f32_32x32x16_bf16 v[96:111], v[220:223], a[108:111], v[96:111]
    ds_read_b64_tr_b16 v[212:213], v203 offset:14336
    ds_read_b64_tr_b16 v[214:215], v203 offset:14848
    v_mul_f32 v184, v184, v56
    v_mul_f32 v185, v185, v57
    v_mfma_f32_32x32x16_bf16 v[112:127], v[220:223], a[252:255], v[112:127]
    v_exp_f32 v184, v184
    v_mul_f32 v186, v56, v60
    s_waitcnt lgkmcnt(4)
    v_mfma_f32_32x32x16_bf16 v[96:111], v[224:227], a[112:115], v[96:111]
    ds_read_b64_tr_b16 v[216:217], v203 offset:16384
    ds_read_b64_tr_b16 v[218:219], v203 offset:16896
    v_exp_f32 v185, v185
    v_mul_f32 v187, v57, v61
    v_mfma_f32_32x32x16_bf16 v[112:127], v[224:227], v[144:147], v[112:127]
    buffer_load_dwordx4 v201, s[16:19], s30 offen offset:2048 lds
    v_add_f32 v184, 1.0, v184
    v_add_f32 v185, 1.0, v185
    v_mfma_f32_32x32x16_bf16 v[96:111], v[228:231], a[116:119], v[96:111]
    ds_read_b64_tr_b16 v[220:221], v203 offset:18432
    ds_read_b64_tr_b16 v[222:223], v203 offset:18944
    v_rcp_f32 v184, v184
    v_rcp_f32 v185, v185
    v_mfma_f32_32x32x16_bf16 v[112:127], v[228:231], v[148:151], v[112:127]
    v_mul_f32 v186, v186, v184
    v_mul_f32 v187, v187, v185
    s_waitcnt lgkmcnt(4)
    v_mfma_f32_32x32x16_bf16 v[96:111], v[208:211], a[120:123], v[96:111]
    ds_read_b64_tr_b16 v[224:225], v203 offset:20480
    ds_read_b64_tr_b16 v[226:227], v203 offset:20992
    v_cvt_pk_bf16_f32 v198, v186, v187
    v_mul_f32 v188, v58, v58
    v_mul_f32 v189, v59, v59
    v_mfma_f32_32x32x16_bf16 v[112:127], v[208:211], v[152:155], v[112:127]
    buffer_load_dwordx4 v201, s[16:19], s31 offen offset:3072 lds
    v_fmaak_f32 v188, v188, v207, 0xc0135761
    v_fmaak_f32 v189, v189, v207, 0xc0135761
    v_mfma_f32_32x32x16_bf16 v[96:111], v[212:215], a[124:127], v[96:111]
    ds_read_b64_tr_b16 v[228:229], v203 offset:22528
    ds_read_b64_tr_b16 v[230:231], v203 offset:23040
    v_mul_f32 v188, v188, v58
    v_mul_f32 v189, v189, v59
    v_mfma_f32_32x32x16_bf16 v[112:127], v[212:215], v[156:159], v[112:127]
    v_exp_f32 v188, v188
    v_mul_f32 v190, v58, v62
    s_waitcnt lgkmcnt(4)
    v_mfma_f32_32x32x16_bf16 v[96:111], v[216:219], a[128:131], v[96:111]
    s_add_u32 m0, s39, 28672
    v_exp_f32 v189, v189
    v_mul_f32 v191, v59, v63
    v_add_f32 v188, 1.0, v188
    v_mfma_f32_32x32x16_bf16 v[112:127], v[216:219], v[160:163], v[112:127]
    buffer_load_dwordx4 v201, s[16:19], s32 offen offset:0 lds
    v_add_f32 v189, 1.0, v189
    v_rcp_f32 v188, v188
    v_mfma_f32_32x32x16_bf16 v[96:111], v[220:223], a[132:135], v[96:111]
    s_add_u32 s39, s38, s34
    s_add_u32 s38, s38, 49152
    s_cmp_eq_u32 s38, 147456
    s_cselect_b32 s38, 0, s38
    v_add_u32 v202, s38, v204
    v_add_u32 v203, s38, v205
    v_mfma_f32_32x32x16_bf16 v[112:127], v[220:223], v[164:167], v[112:127]
    v_rcp_f32 v189, v189
    v_mul_f32 v190, v190, v188
    s_waitcnt lgkmcnt(0)
    v_mfma_f32_32x32x16_bf16 v[96:111], v[224:227], a[136:139], v[96:111]
    s_waitcnt vmcnt(12) lgkmcnt(0)
    s_barrier
    ds_read_b64_tr_b16 v[208:209], v202 offset:0
    ds_read_b64_tr_b16 v[210:211], v202 offset:512
    ds_read_b64_tr_b16 v[212:213], v202 offset:2048
    ds_read_b64_tr_b16 v[214:215], v202 offset:2560
    v_mfma_f32_32x32x16_bf16 v[112:127], v[224:227], v[168:171], v[112:127]
    buffer_load_dwordx4 v201, s[16:19], s33 offen offset:1024 lds
    v_mul_f32 v191, v191, v189
    v_cvt_pk_bf16_f32 v199, v190, v191
    v_mfma_f32_32x32x16_bf16 v[96:111], v[228:231], a[140:143], v[96:111]
    ds_read_b64_tr_b16 v[216:217], v202 offset:4096
    ds_read_b64_tr_b16 v[218:219], v202 offset:4608
    ds_read_b64_tr_b16 v[220:221], v202 offset:6144
    ds_read_b64_tr_b16 v[222:223], v202 offset:6656
    buffer_store_dwordx4 v[196:199], v206, s[20:23], s37 offen offset:1024 sc1
    v_mfma_f32_32x32x16_bf16 v[112:127], v[228:231], v[172:175], v[112:127]
    v_add_u32 v200, s35, v200
    v_add_u32 v201, s35, v201
    s_add_u32 s36, s36, 4096
    s_add_u32 s37, s37, 4096
    s_add_u32 s40, s40, 1
    s_cmp_eq_u32 s40, 4
    s_cbranch_scc0 gated_mix__spectral_gfnet__glu_gated_geglu__prompt_kernel_bodyA
    s_cmp_lg_u32 s41, 0
    s_cbranch_scc1 gated_mix__spectral_gfnet__glu_gated_geglu__prompt_kernel_ytail
gated_mix__spectral_gfnet__glu_gated_geglu__prompt_kernel_bodyA:
    buffer_load_dword v240, v243, s[24:27], 0 offen sc1
    buffer_load_dword v246, v245, s[84:87], 0 offen offset:512
    s_lshl_b32 s54, s2, 2
    s_add_u32 s54, s54, s3
    s_mul_i32 s54, s54, 1280
    v_min_u32 v132, 9, v241
    v_lshlrev_b32 v132, 7, v132
    buffer_load_dword v246, v132, s[88:91], s54 offen
    buffer_load_dword v246, v132, s[92:95], s54 offen
    s_mov_b32 s96, s78
    s_mov_b32 s97, s79
    s_mov_b32 s98, 5308416
    s_mov_b32 s99, 0x20000
    s_lshl_b32 s54, s2, 2
    s_add_u32 s54, s54, s3
    s_mul_i32 s54, s54, 5248
    v_min_u32 v245, 40, v241
    v_lshlrev_b32 v245, 7, v245
    buffer_load_dword v246, v245, s[96:99], s54 offen
    s_waitcnt lgkmcnt(4)
    v_mfma_f32_32x32x16_bf16 v[0:15], v[208:211], a[0:3], 0
    ds_read_b64_tr_b16 v[224:225], v202 offset:8192
    ds_read_b64_tr_b16 v[226:227], v202 offset:8704
    s_add_u32 m0, s39, 0
    v_mfma_f32_32x32x16_bf16 v[16:31], v[208:211], a[144:147], 0
    buffer_load_dwordx4 v200, s[12:15], s28 offen offset:0 lds
    v_mul_f32 v176, v64, v64
    v_mul_f32 v177, v65, v65
    v_mfma_f32_32x32x16_bf16 v[0:15], v[212:215], a[4:7], v[0:15]
    ds_read_b64_tr_b16 v[228:229], v202 offset:10240
    ds_read_b64_tr_b16 v[230:231], v202 offset:10752
    v_fmaak_f32 v176, v176, v207, 0xc0135761
    v_fmaak_f32 v177, v177, v207, 0xc0135761
    v_mul_f32 v176, v176, v64
    v_mfma_f32_32x32x16_bf16 v[16:31], v[212:215], a[148:151], v[16:31]
    v_mul_f32 v177, v177, v65
    v_exp_f32 v176, v176
    s_waitcnt lgkmcnt(4)
    v_mfma_f32_32x32x16_bf16 v[0:15], v[216:219], a[8:11], v[0:15]
    ds_read_b64_tr_b16 v[208:209], v202 offset:12288
    ds_read_b64_tr_b16 v[210:211], v202 offset:12800
    v_mul_f32 v178, v64, v68
    v_exp_f32 v177, v177
    v_mfma_f32_32x32x16_bf16 v[16:31], v[216:219], a[152:155], v[16:31]
    buffer_load_dwordx4 v200, s[12:15], s29 offen offset:1024 lds
    v_mul_f32 v179, v65, v69
    v_add_f32 v176, 1.0, v176
    v_mfma_f32_32x32x16_bf16 v[0:15], v[220:223], a[12:15], v[0:15]
    ds_read_b64_tr_b16 v[212:213], v202 offset:14336
    ds_read_b64_tr_b16 v[214:215], v202 offset:14848
    v_add_f32 v177, 1.0, v177
    v_rcp_f32 v176, v176
    v_mfma_f32_32x32x16_bf16 v[16:31], v[220:223], a[156:159], v[16:31]
    v_rcp_f32 v177, v177
    s_waitcnt lgkmcnt(4)
    v_mfma_f32_32x32x16_bf16 v[0:15], v[224:227], a[16:19], v[0:15]
    ds_read_b64_tr_b16 v[216:217], v202 offset:16384
    ds_read_b64_tr_b16 v[218:219], v202 offset:16896
    v_mul_f32 v178, v178, v176
    v_mul_f32 v179, v179, v177
    v_cvt_pk_bf16_f32 v192, v178, v179
    v_mfma_f32_32x32x16_bf16 v[16:31], v[224:227], a[160:163], v[16:31]
    buffer_load_dwordx4 v200, s[12:15], s30 offen offset:2048 lds
    v_mul_f32 v180, v66, v66
    v_mul_f32 v181, v67, v67
    v_mfma_f32_32x32x16_bf16 v[0:15], v[228:231], a[20:23], v[0:15]
    ds_read_b64_tr_b16 v[220:221], v202 offset:18432
    ds_read_b64_tr_b16 v[222:223], v202 offset:18944
    v_fmaak_f32 v180, v180, v207, 0xc0135761
    v_fmaak_f32 v181, v181, v207, 0xc0135761
    v_mul_f32 v180, v180, v66
    v_mfma_f32_32x32x16_bf16 v[16:31], v[228:231], a[164:167], v[16:31]
    v_mul_f32 v181, v181, v67
    v_exp_f32 v180, v180
    s_waitcnt lgkmcnt(4)
    v_mfma_f32_32x32x16_bf16 v[0:15], v[208:211], a[24:27], v[0:15]
    ds_read_b64_tr_b16 v[224:225], v202 offset:20480
    ds_read_b64_tr_b16 v[226:227], v202 offset:20992
    v_mul_f32 v182, v66, v70
    v_exp_f32 v181, v181
    v_mfma_f32_32x32x16_bf16 v[16:31], v[208:211], a[168:171], v[16:31]
    buffer_load_dwordx4 v200, s[12:15], s31 offen offset:3072 lds
    v_mul_f32 v183, v67, v71
    v_add_f32 v180, 1.0, v180
    v_mfma_f32_32x32x16_bf16 v[0:15], v[212:215], a[28:31], v[0:15]
    ds_read_b64_tr_b16 v[228:229], v202 offset:22528
    ds_read_b64_tr_b16 v[230:231], v202 offset:23040
    v_add_f32 v181, 1.0, v181
    v_rcp_f32 v180, v180
    v_mfma_f32_32x32x16_bf16 v[16:31], v[212:215], a[172:175], v[16:31]
    v_rcp_f32 v181, v181
    s_waitcnt lgkmcnt(4)
    v_mfma_f32_32x32x16_bf16 v[0:15], v[216:219], a[32:35], v[0:15]
    ds_read_b64_tr_b16 v[208:209], v203 offset:0
    ds_read_b64_tr_b16 v[210:211], v203 offset:512
    s_add_u32 m0, s39, 4096
    v_mul_f32 v182, v182, v180
    v_mul_f32 v183, v183, v181
    v_mfma_f32_32x32x16_bf16 v[16:31], v[216:219], a[176:179], v[16:31]
    buffer_load_dwordx4 v200, s[12:15], s32 offen offset:0 lds
    v_cvt_pk_bf16_f32 v193, v182, v183
    v_mul_f32 v184, v72, v72
    v_mfma_f32_32x32x16_bf16 v[0:15], v[220:223], a[36:39], v[0:15]
    ds_read_b64_tr_b16 v[212:213], v203 offset:2048
    ds_read_b64_tr_b16 v[214:215], v203 offset:2560
    v_mul_f32 v185, v73, v73
    v_fmaak_f32 v184, v184, v207, 0xc0135761
    v_fmaak_f32 v185, v185, v207, 0xc0135761
    v_mfma_f32_32x32x16_bf16 v[16:31], v[220:223], a[180:183], v[16:31]
    v_mul_f32 v184, v184, v72
    v_mul_f32 v185, v185, v73
    s_waitcnt lgkmcnt(4)
    v_mfma_f32_32x32x16_bf16 v[0:15], v[224:227], a[40:43], v[0:15]
    ds_read_b64_tr_b16 v[216:217], v203 offset:4096
    ds_read_b64_tr_b16 v[218:219], v203 offset:4608
    v_exp_f32 v184, v184
    v_mul_f32 v186, v72, v76
    v_mfma_f32_32x32x16_bf16 v[16:31], v[224:227], a[184:187], v[16:31]
    buffer_load_dwordx4 v200, s[12:15], s33 offen offset:1024 lds
    v_exp_f32 v185, v185
    v_mul_f32 v187, v73, v77
    v_mfma_f32_32x32x16_bf16 v[0:15], v[228:231], a[44:47], v[0:15]
    ds_read_b64_tr_b16 v[220:221], v203 offset:6144
    ds_read_b64_tr_b16 v[222:223], v203 offset:6656
    v_add_f32 v184, 1.0, v184
    v_add_f32 v185, 1.0, v185
    v_mfma_f32_32x32x16_bf16 v[16:31], v[228:231], a[188:191], v[16:31]
    v_rcp_f32 v184, v184
    v_rcp_f32 v185, v185
    s_waitcnt lgkmcnt(4)
    v_mfma_f32_32x32x16_bf16 v[32:47], v[208:211], a[0:3], 0
    ds_read_b64_tr_b16 v[224:225], v203 offset:8192
    ds_read_b64_tr_b16 v[226:227], v203 offset:8704
    s_add_u32 m0, s39, 24576
    v_mul_f32 v186, v186, v184
    v_mfma_f32_32x32x16_bf16 v[48:63], v[208:211], a[144:147], 0
    buffer_load_dwordx4 v201, s[16:19], s28 offen offset:0 lds
    v_mul_f32 v187, v187, v185
    v_cvt_pk_bf16_f32 v194, v186, v187
    v_mul_f32 v188, v74, v74
    v_mfma_f32_32x32x16_bf16 v[32:47], v[212:215], a[4:7], v[32:47]
    ds_read_b64_tr_b16 v[228:229], v203 offset:10240
    ds_read_b64_tr_b16 v[230:231], v203 offset:10752
    v_mul_f32 v189, v75, v75
    v_fmaak_f32 v188, v188, v207, 0xc0135761
    v_mfma_f32_32x32x16_bf16 v[48:63], v[212:215], a[148:151], v[48:63]
    v_fmaak_f32 v189, v189, v207, 0xc0135761
    v_mul_f32 v188, v188, v74
    v_mul_f32 v189, v189, v75
    s_waitcnt lgkmcnt(4)
    v_mfma_f32_32x32x16_bf16 v[32:47], v[216:219], a[8:11], v[32:47]
    ds_read_b64_tr_b16 v[208:209], v203 offset:12288
    ds_read_b64_tr_b16 v[210:211], v203 offset:12800
    v_exp_f32 v188, v188
    v_mul_f32 v190, v74, v78
    v_mfma_f32_32x32x16_bf16 v[48:63], v[216:219], a[152:155], v[48:63]
    buffer_load_dwordx4 v201, s[16:19], s29 offen offset:1024 lds
    v_exp_f32 v189, v189
    v_mfma_f32_32x32x16_bf16 v[32:47], v[220:223], a[12:15], v[32:47]
    ds_read_b64_tr_b16 v[212:213], v203 offset:14336
    ds_read_b64_tr_b16 v[214:215], v203 offset:14848
    v_mul_f32 v191, v75, v79
    v_add_f32 v188, 1.0, v188
    v_add_f32 v189, 1.0, v189
    v_mfma_f32_32x32x16_bf16 v[48:63], v[220:223], a[156:159], v[48:63]
    v_rcp_f32 v188, v188
    s_waitcnt lgkmcnt(4)
    v_mfma_f32_32x32x16_bf16 v[32:47], v[224:227], a[16:19], v[32:47]
    ds_read_b64_tr_b16 v[216:217], v203 offset:16384
    ds_read_b64_tr_b16 v[218:219], v203 offset:16896
    v_rcp_f32 v189, v189
    v_mul_f32 v190, v190, v188
    v_mfma_f32_32x32x16_bf16 v[48:63], v[224:227], a[160:163], v[48:63]
    buffer_load_dwordx4 v201, s[16:19], s30 offen offset:2048 lds
    v_mul_f32 v191, v191, v189
    v_cvt_pk_bf16_f32 v195, v190, v191
    v_mfma_f32_32x32x16_bf16 v[32:47], v[228:231], a[20:23], v[32:47]
    ds_read_b64_tr_b16 v[220:221], v203 offset:18432
    ds_read_b64_tr_b16 v[222:223], v203 offset:18944
    buffer_store_dwordx4 v[192:195], v206, s[20:23], s36 offen offset:0 sc1
    v_mul_f32 v176, v80, v80
    v_mfma_f32_32x32x16_bf16 v[48:63], v[228:231], a[164:167], v[48:63]
    v_mul_f32 v177, v81, v81
    v_fmaak_f32 v176, v176, v207, 0xc0135761
    v_fmaak_f32 v177, v177, v207, 0xc0135761
    s_waitcnt lgkmcnt(4)
    v_mfma_f32_32x32x16_bf16 v[32:47], v[208:211], a[24:27], v[32:47]
    ds_read_b64_tr_b16 v[224:225], v203 offset:20480
    ds_read_b64_tr_b16 v[226:227], v203 offset:20992
    v_mul_f32 v176, v176, v80
    v_mul_f32 v177, v177, v81
    v_mfma_f32_32x32x16_bf16 v[48:63], v[208:211], a[168:171], v[48:63]
    buffer_load_dwordx4 v201, s[16:19], s31 offen offset:3072 lds
    v_exp_f32 v176, v176
    v_mul_f32 v178, v80, v84
    v_mfma_f32_32x32x16_bf16 v[32:47], v[212:215], a[28:31], v[32:47]
    ds_read_b64_tr_b16 v[228:229], v203 offset:22528
    ds_read_b64_tr_b16 v[230:231], v203 offset:23040
    v_exp_f32 v177, v177
    v_mfma_f32_32x32x16_bf16 v[48:63], v[212:215], a[172:175], v[48:63]
    v_mul_f32 v179, v81, v85
    v_add_f32 v176, 1.0, v176
    v_add_f32 v177, 1.0, v177
    s_waitcnt lgkmcnt(4)
    v_mfma_f32_32x32x16_bf16 v[32:47], v[216:219], a[32:35], v[32:47]
    s_add_u32 m0, s39, 28672
    v_rcp_f32 v176, v176
    v_rcp_f32 v177, v177
    v_mfma_f32_32x32x16_bf16 v[48:63], v[216:219], a[176:179], v[48:63]
    buffer_load_dwordx4 v201, s[16:19], s32 offen offset:0 lds
    v_mul_f32 v178, v178, v176
    v_mul_f32 v179, v179, v177
    v_mfma_f32_32x32x16_bf16 v[32:47], v[220:223], a[36:39], v[32:47]
    s_add_u32 s39, s38, s34
    s_add_u32 s38, s38, 49152
    s_cmp_eq_u32 s38, 147456
    s_cselect_b32 s38, 0, s38
    v_add_u32 v202, s38, v204
    v_add_u32 v203, s38, v205
    v_mfma_f32_32x32x16_bf16 v[48:63], v[220:223], a[180:183], v[48:63]
    v_cvt_pk_bf16_f32 v196, v178, v179
    v_mul_f32 v180, v82, v82
    v_mul_f32 v181, v83, v83
    s_waitcnt lgkmcnt(0)
    v_mfma_f32_32x32x16_bf16 v[32:47], v[224:227], a[40:43], v[32:47]
    s_waitcnt vmcnt(18) lgkmcnt(0)
    s_barrier
    ds_read_b64_tr_b16 v[208:209], v202 offset:0
    ds_read_b64_tr_b16 v[210:211], v202 offset:512
    ds_read_b64_tr_b16 v[212:213], v202 offset:2048
    ds_read_b64_tr_b16 v[214:215], v202 offset:2560
    v_mfma_f32_32x32x16_bf16 v[48:63], v[224:227], a[184:187], v[48:63]
    buffer_load_dwordx4 v201, s[16:19], s33 offen offset:1024 lds
    v_fmaak_f32 v180, v180, v207, 0xc0135761
    v_fmaak_f32 v181, v181, v207, 0xc0135761
    v_mfma_f32_32x32x16_bf16 v[32:47], v[228:231], a[44:47], v[32:47]
    ds_read_b64_tr_b16 v[216:217], v202 offset:4096
    ds_read_b64_tr_b16 v[218:219], v202 offset:4608
    ds_read_b64_tr_b16 v[220:221], v202 offset:6144
    ds_read_b64_tr_b16 v[222:223], v202 offset:6656
    v_mul_f32 v180, v180, v82
    v_mul_f32 v181, v181, v83
    v_mfma_f32_32x32x16_bf16 v[48:63], v[228:231], a[188:191], v[48:63]
    v_add_u32 v200, 0xffca0080, v200
    v_add_u32 v201, 0xffca0080, v201
    s_cmp_eq_u32 s40, 4
    s_cselect_b32 s14, 0, s14
    s_cselect_b32 s18, 0, s18
    s_waitcnt lgkmcnt(4)
    v_mfma_f32_32x32x16_bf16 v[0:15], v[208:211], a[48:51], v[0:15]
    ds_read_b64_tr_b16 v[224:225], v202 offset:8192
    ds_read_b64_tr_b16 v[226:227], v202 offset:8704
    s_add_u32 m0, s39, 0
    v_exp_f32 v180, v180
    v_mfma_f32_32x32x16_bf16 v[16:31], v[208:211], a[192:195], v[16:31]
    buffer_load_dwordx4 v200, s[12:15], s28 offen offset:0 lds
    v_mul_f32 v182, v82, v86
    v_mfma_f32_32x32x16_bf16 v[0:15], v[212:215], a[52:55], v[0:15]
    ds_read_b64_tr_b16 v[228:229], v202 offset:10240
    ds_read_b64_tr_b16 v[230:231], v202 offset:10752
    v_exp_f32 v181, v181
    v_mul_f32 v183, v83, v87
    v_mfma_f32_32x32x16_bf16 v[16:31], v[212:215], a[196:199], v[16:31]
    v_add_f32 v180, 1.0, v180
    v_add_f32 v181, 1.0, v181
    v_rcp_f32 v180, v180
    s_waitcnt lgkmcnt(4)
    v_mfma_f32_32x32x16_bf16 v[0:15], v[216:219], a[56:59], v[0:15]
    ds_read_b64_tr_b16 v[208:209], v202 offset:12288
    ds_read_b64_tr_b16 v[210:211], v202 offset:12800
    v_rcp_f32 v181, v181
    v_mfma_f32_32x32x16_bf16 v[16:31], v[216:219], a[200:203], v[16:31]
    buffer_load_dwordx4 v200, s[12:15], s29 offen offset:1024 lds
    v_mul_f32 v182, v182, v180
    v_mul_f32 v183, v183, v181
    v_mfma_f32_32x32x16_bf16 v[0:15], v[220:223], a[60:63], v[0:15]
    ds_read_b64_tr_b16 v[212:213], v202 offset:14336
    ds_read_b64_tr_b16 v[214:215], v202 offset:14848
    v_cvt_pk_bf16_f32 v197, v182, v183
    v_mul_f32 v184, v88, v88
    v_mul_f32 v185, v89, v89
    v_mfma_f32_32x32x16_bf16 v[16:31], v[220:223], a[204:207], v[16:31]
    v_fmaak_f32 v184, v184, v207, 0xc0135761
    v_fmaak_f32 v185, v185, v207, 0xc0135761
    v_mul_f32 v184, v184, v88
    s_waitcnt lgkmcnt(4)
    v_mfma_f32_32x32x16_bf16 v[0:15], v[224:227], a[64:67], v[0:15]
    ds_read_b64_tr_b16 v[216:217], v202 offset:16384
    ds_read_b64_tr_b16 v[218:219], v202 offset:16896
    v_mul_f32 v185, v185, v89
    v_exp_f32 v184, v184
    v_mfma_f32_32x32x16_bf16 v[16:31], v[224:227], a[208:211], v[16:31]
    buffer_load_dwordx4 v200, s[12:15], s30 offen offset:2048 lds
    v_mul_f32 v186, v88, v92
    v_mfma_f32_32x32x16_bf16 v[0:15], v[228:231], a[68:71], v[0:15]
    ds_read_b64_tr_b16 v[220:221], v202 offset:18432
    ds_read_b64_tr_b16 v[222:223], v202 offset:18944
    v_exp_f32 v185, v185
    v_mul_f32 v187, v89, v93
    v_mfma_f32_32x32x16_bf16 v[16:31], v[228:231], a[212:215], v[16:31]
    v_add_f32 v184, 1.0, v184
    v_add_f32 v185, 1.0, v185
    v_rcp_f32 v184, v184
    s_waitcnt lgkmcnt(4)
    v_mfma_f32_32x32x16_bf16 v[0:15], v[208:211], a[72:75], v[0:15]
    ds_read_b64_tr_b16 v[224:225], v202 offset:20480
    ds_read_b64_tr_b16 v[226:227], v202 offset:20992
    v_rcp_f32 v185, v185
    v_mfma_f32_32x32x16_bf16 v[16:31], v[208:211], a[216:219], v[16:31]
    buffer_load_dwordx4 v200, s[12:15], s31 offen offset:3072 lds
    v_mul_f32 v186, v186, v184
    v_mul_f32 v187, v187, v185
    v_mfma_f32_32x32x16_bf16 v[0:15], v[212:215], a[76:79], v[0:15]
    ds_read_b64_tr_b16 v[228:229], v202 offset:22528
    ds_read_b64_tr_b16 v[230:231], v202 offset:23040
    v_cvt_pk_bf16_f32 v198, v186, v187
    v_mul_f32 v188, v90, v90
    v_mul_f32 v189, v91, v91
    v_mfma_f32_32x32x16_bf16 v[16:31], v[212:215], a[220:223], v[16:31]
    v_fmaak_f32 v188, v188, v207, 0xc0135761
    v_fmaak_f32 v189, v189, v207, 0xc0135761
    v_mul_f32 v188, v188, v90
    s_waitcnt lgkmcnt(4)
    v_mfma_f32_32x32x16_bf16 v[0:15], v[216:219], a[80:83], v[0:15]
    ds_read_b64_tr_b16 v[208:209], v203 offset:0
    ds_read_b64_tr_b16 v[210:211], v203 offset:512
    s_add_u32 m0, s39, 4096
    v_mul_f32 v189, v189, v91
    v_mfma_f32_32x32x16_bf16 v[16:31], v[216:219], a[224:227], v[16:31]
    buffer_load_dwordx4 v200, s[12:15], s32 offen offset:0 lds
    v_exp_f32 v188, v188
    v_mul_f32 v190, v90, v94
    v_mfma_f32_32x32x16_bf16 v[0:15], v[220:223], a[84:87], v[0:15]
    ds_read_b64_tr_b16 v[212:213], v203 offset:2048
    ds_read_b64_tr_b16 v[214:215], v203 offset:2560
    v_exp_f32 v189, v189
    v_mfma_f32_32x32x16_bf16 v[16:31], v[220:223], a[228:231], v[16:31]
    v_mul_f32 v191, v91, v95
    v_add_f32 v188, 1.0, v188
    v_add_f32 v189, 1.0, v189
    s_waitcnt lgkmcnt(4)
    v_mfma_f32_32x32x16_bf16 v[0:15], v[224:227], a[88:91], v[0:15]
    ds_read_b64_tr_b16 v[216:217], v203 offset:4096
    ds_read_b64_tr_b16 v[218:219], v203 offset:4608
    v_rcp_f32 v188, v188
    v_mfma_f32_32x32x16_bf16 v[16:31], v[224:227], a[232:235], v[16:31]
    buffer_load_dwordx4 v200, s[12:15], s33 offen offset:1024 lds
    v_rcp_f32 v189, v189
    v_mul_f32 v190, v190, v188
    v_mfma_f32_32x32x16_bf16 v[0:15], v[228:231], a[92:95], v[0:15]
    ds_read_b64_tr_b16 v[220:221], v203 offset:6144
    ds_read_b64_tr_b16 v[222:223], v203 offset:6656
    v_mul_f32 v191, v191, v189
    v_cvt_pk_bf16_f32 v199, v190, v191
    v_mfma_f32_32x32x16_bf16 v[16:31], v[228:231], a[236:239], v[16:31]
    buffer_store_dwordx4 v[196:199], v206, s[20:23], s37 offen offset:0 sc1
    v_mul_f32 v176, v96, v96
    v_mul_f32 v177, v97, v97
    s_waitcnt lgkmcnt(4)
    v_mfma_f32_32x32x16_bf16 v[32:47], v[208:211], a[48:51], v[32:47]
    ds_read_b64_tr_b16 v[224:225], v203 offset:8192
    ds_read_b64_tr_b16 v[226:227], v203 offset:8704
    s_add_u32 m0, s39, 24576
    v_fmaak_f32 v176, v176, v207, 0xc0135761
    v_fmaak_f32 v177, v177, v207, 0xc0135761
    v_mfma_f32_32x32x16_bf16 v[48:63], v[208:211], a[192:195], v[48:63]
    buffer_load_dwordx4 v201, s[16:19], s28 offen offset:0 lds
    v_mul_f32 v176, v176, v96
    v_mul_f32 v177, v177, v97
    v_mfma_f32_32x32x16_bf16 v[32:47], v[212:215], a[52:55], v[32:47]
    ds_read_b64_tr_b16 v[228:229], v203 offset:10240
    ds_read_b64_tr_b16 v[230:231], v203 offset:10752
    v_exp_f32 v176, v176
    v_mul_f32 v178, v96, v100
    v_mfma_f32_32x32x16_bf16 v[48:63], v[212:215], a[196:199], v[48:63]
    v_exp_f32 v177, v177
    v_mul_f32 v179, v97, v101
    s_waitcnt lgkmcnt(4)
    v_mfma_f32_32x32x16_bf16 v[32:47], v[216:219], a[56:59], v[32:47]
    ds_read_b64_tr_b16 v[208:209], v203 offset:12288
    ds_read_b64_tr_b16 v[210:211], v203 offset:12800
    v_add_f32 v176, 1.0, v176
    v_add_f32 v177, 1.0, v177
    v_mfma_f32_32x32x16_bf16 v[48:63], v[216:219], a[200:203], v[48:63]
    buffer_load_dwordx4 v201, s[16:19], s29 offen offset:1024 lds
    v_rcp_f32 v176, v176
    v_mfma_f32_32x32x16_bf16 v[32:47], v[220:223], a[60:63], v[32:47]
    ds_read_b64_tr_b16 v[212:213], v203 offset:14336
    ds_read_b64_tr_b16 v[214:215], v203 offset:14848
    v_rcp_f32 v177, v177
    v_mul_f32 v178, v178, v176
    v_mfma_f32_32x32x16_bf16 v[48:63], v[220:223], a[204:207], v[48:63]
    v_mul_f32 v179, v179, v177
    v_cvt_pk_bf16_f32 v192, v178, v179
    v_mul_f32 v180, v98, v98
    s_waitcnt lgkmcnt(4)
    v_mfma_f32_32x32x16_bf16 v[32:47], v[224:227], a[64:67], v[32:47]
    ds_read_b64_tr_b16 v[216:217], v203 offset:16384
    ds_read_b64_tr_b16 v[218:219], v203 offset:16896
    v_mul_f32 v181, v99, v99
    v_fmaak_f32 v180, v180, v207, 0xc0135761
    v_fmaak_f32 v181, v181, v207, 0xc0135761
    v_mfma_f32_32x32x16_bf16 v[48:63], v[224:227], a[208:211], v[48:63]
    buffer_load_dwordx4 v201, s[16:19], s30 offen offset:2048 lds
    v_mul_f32 v180, v180, v98
    v_mul_f32 v181, v181, v99
    v_mfma_f32_32x32x16_bf16 v[32:47], v[228:231], a[68:71], v[32:47]
    ds_read_b64_tr_b16 v[220:221], v203 offset:18432
    ds_read_b64_tr_b16 v[222:223], v203 offset:18944
    v_exp_f32 v180, v180
    v_mfma_f32_32x32x16_bf16 v[48:63], v[228:231], a[212:215], v[48:63]
    v_mul_f32 v182, v98, v102
    v_exp_f32 v181, v181
    v_mul_f32 v183, v99, v103
    s_waitcnt lgkmcnt(4)
    v_mfma_f32_32x32x16_bf16 v[32:47], v[208:211], a[72:75], v[32:47]
    ds_read_b64_tr_b16 v[224:225], v203 offset:20480
    ds_read_b64_tr_b16 v[226:227], v203 offset:20992
    v_add_f32 v180, 1.0, v180
    v_add_f32 v181, 1.0, v181
    v_mfma_f32_32x32x16_bf16 v[48:63], v[208:211], a[216:219], v[48:63]
    buffer_load_dwordx4 v201, s[16:19], s31 offen offset:3072 lds
    v_rcp_f32 v180, v180
    v_mfma_f32_32x32x16_bf16 v[32:47], v[212:215], a[76:79], v[32:47]
    ds_read_b64_tr_b16 v[228:229], v203 offset:22528
    ds_read_b64_tr_b16 v[230:231], v203 offset:23040
    v_rcp_f32 v181, v181
    v_mul_f32 v182, v182, v180
    v_mfma_f32_32x32x16_bf16 v[48:63], v[212:215], a[220:223], v[48:63]
    v_mul_f32 v183, v183, v181
    v_cvt_pk_bf16_f32 v193, v182, v183
    v_mul_f32 v184, v104, v104
    s_waitcnt lgkmcnt(4)
    v_mfma_f32_32x32x16_bf16 v[32:47], v[216:219], a[80:83], v[32:47]
    s_add_u32 m0, s39, 28672
    v_mul_f32 v185, v105, v105
    v_fmaak_f32 v184, v184, v207, 0xc0135761
    v_fmaak_f32 v185, v185, v207, 0xc0135761
    v_mfma_f32_32x32x16_bf16 v[48:63], v[216:219], a[224:227], v[48:63]
    buffer_load_dwordx4 v201, s[16:19], s32 offen offset:0 lds
    v_mul_f32 v184, v184, v104
    v_mul_f32 v185, v185, v105
    v_mfma_f32_32x32x16_bf16 v[32:47], v[220:223], a[84:87], v[32:47]
    s_add_u32 s39, s38, s34
    s_add_u32 s38, s38, 49152
    s_cmp_eq_u32 s38, 147456
    s_cselect_b32 s38, 0, s38
    v_add_u32 v202, s38, v204
    v_add_u32 v203, s38, v205
    v_mfma_f32_32x32x16_bf16 v[48:63], v[220:223], a[228:231], v[48:63]
    v_exp_f32 v184, v184
    v_mul_f32 v186, v104, v108
    s_waitcnt lgkmcnt(0)
    v_mfma_f32_32x32x16_bf16 v[32:47], v[224:227], a[88:91], v[32:47]
    s_waitcnt vmcnt(12) lgkmcnt(0)
    s_barrier
    ds_read_b64_tr_b16 v[208:209], v202 offset:0
    ds_read_b64_tr_b16 v[210:211], v202 offset:512
    ds_read_b64_tr_b16 v[212:213], v202 offset:2048
    ds_read_b64_tr_b16 v[214:215], v202 offset:2560
    v_mfma_f32_32x32x16_bf16 v[48:63], v[224:227], a[232:235], v[48:63]
    buffer_load_dwordx4 v201, s[16:19], s33 offen offset:1024 lds
    v_exp_f32 v185, v185
    v_mul_f32 v187, v105, v109
    v_mfma_f32_32x32x16_bf16 v[32:47], v[228:231], a[92:95], v[32:47]
    ds_read_b64_tr_b16 v[216:217], v202 offset:4096
    ds_read_b64_tr_b16 v[218:219], v202 offset:4608
    ds_read_b64_tr_b16 v[220:221], v202 offset:6144
    ds_read_b64_tr_b16 v[222:223], v202 offset:6656
    v_add_f32 v184, 1.0, v184
    v_mfma_f32_32x32x16_bf16 v[48:63], v[228:231], a[236:239], v[48:63]
    v_add_u32 v200, s35, v200
    v_add_u32 v201, s35, v201
    v_add_f32 v185, 1.0, v185
    v_rcp_f32 v184, v184
    s_waitcnt lgkmcnt(4)
    v_mfma_f32_32x32x16_bf16 v[0:15], v[208:211], a[96:99], v[0:15]
    ds_read_b64_tr_b16 v[224:225], v202 offset:8192
    ds_read_b64_tr_b16 v[226:227], v202 offset:8704
    s_add_u32 m0, s39, 0
    v_mfma_f32_32x32x16_bf16 v[16:31], v[208:211], a[240:243], v[16:31]
    buffer_load_dwordx4 v200, s[12:15], s28 offen offset:0 lds
    v_rcp_f32 v185, v185
    v_mul_f32 v186, v186, v184
    v_mfma_f32_32x32x16_bf16 v[0:15], v[212:215], a[100:103], v[0:15]
    ds_read_b64_tr_b16 v[228:229], v202 offset:10240
    ds_read_b64_tr_b16 v[230:231], v202 offset:10752
    v_mul_f32 v187, v187, v185
    v_cvt_pk_bf16_f32 v194, v186, v187
    v_mul_f32 v188, v106, v106
    v_mfma_f32_32x32x16_bf16 v[16:31], v[212:215], a[244:247], v[16:31]
    v_mul_f32 v189, v107, v107
    v_fmaak_f32 v188, v188, v207, 0xc0135761
    v_fmaak_f32 v189, v189, v207, 0xc0135761
    s_waitcnt lgkmcnt(4)
    v_mfma_f32_32x32x16_bf16 v[0:15], v[216:219], a[104:107], v[0:15]
    ds_read_b64_tr_b16 v[208:209], v202 offset:12288
    ds_read_b64_tr_b16 v[210:211], v202 offset:12800
    v_mul_f32 v188, v188, v106
    v_mul_f32 v189, v189, v107
    v_mfma_f32_32x32x16_bf16 v[16:31], v[216:219], a[248:251], v[16:31]
    buffer_load_dwordx4 v200, s[12:15], s29 offen offset:1024 lds
    v_exp_f32 v188, v188
    v_mul_f32 v190, v106, v110
    v_mfma_f32_32x32x16_bf16 v[0:15], v[220:223], a[108:111], v[0:15]
    ds_read_b64_tr_b16 v[212:213], v202 offset:14336
    ds_read_b64_tr_b16 v[214:215], v202 offset:14848
    v_exp_f32 v189, v189
    v_mfma_f32_32x32x16_bf16 v[16:31], v[220:223], a[252:255], v[16:31]
    v_mul_f32 v191, v107, v111
    v_add_f32 v188, 1.0, v188
    v_add_f32 v189, 1.0, v189
    s_waitcnt lgkmcnt(4)
    v_mfma_f32_32x32x16_bf16 v[0:15], v[224:227], a[112:115], v[0:15]
    ds_read_b64_tr_b16 v[216:217], v202 offset:16384
    ds_read_b64_tr_b16 v[218:219], v202 offset:16896
    v_rcp_f32 v188, v188
    v_mfma_f32_32x32x16_bf16 v[16:31], v[224:227], v[144:147], v[16:31]
    buffer_load_dwordx4 v200, s[12:15], s30 offen offset:2048 lds
    v_rcp_f32 v189, v189
    v_mul_f32 v190, v190, v188
    v_mfma_f32_32x32x16_bf16 v[0:15], v[228:231], a[116:119], v[0:15]
    ds_read_b64_tr_b16 v[220:221], v202 offset:18432
    ds_read_b64_tr_b16 v[222:223], v202 offset:18944
    v_mul_f32 v191, v191, v189
    v_cvt_pk_bf16_f32 v195, v190, v191
    v_mfma_f32_32x32x16_bf16 v[16:31], v[228:231], v[148:151], v[16:31]
    buffer_store_dwordx4 v[192:195], v206, s[20:23], s36 offen offset:1024 sc1
    v_mul_f32 v176, v112, v112
    v_mul_f32 v177, v113, v113
    s_waitcnt lgkmcnt(4)
    v_mfma_f32_32x32x16_bf16 v[0:15], v[208:211], a[120:123], v[0:15]
    ds_read_b64_tr_b16 v[224:225], v202 offset:20480
    ds_read_b64_tr_b16 v[226:227], v202 offset:20992
    v_fmaak_f32 v176, v176, v207, 0xc0135761
    v_fmaak_f32 v177, v177, v207, 0xc0135761
    v_mfma_f32_32x32x16_bf16 v[16:31], v[208:211], v[152:155], v[16:31]
    buffer_load_dwordx4 v200, s[12:15], s31 offen offset:3072 lds
    v_mul_f32 v176, v176, v112
    v_mul_f32 v177, v177, v113
    v_mfma_f32_32x32x16_bf16 v[0:15], v[212:215], a[124:127], v[0:15]
    ds_read_b64_tr_b16 v[228:229], v202 offset:22528
    ds_read_b64_tr_b16 v[230:231], v202 offset:23040
    v_exp_f32 v176, v176
    v_mul_f32 v178, v112, v116
    v_mfma_f32_32x32x16_bf16 v[16:31], v[212:215], v[156:159], v[16:31]
    v_exp_f32 v177, v177
    v_mul_f32 v179, v113, v117
    s_waitcnt lgkmcnt(4)
    v_mfma_f32_32x32x16_bf16 v[0:15], v[216:219], a[128:131], v[0:15]
    ds_read_b64_tr_b16 v[208:209], v203 offset:0
    ds_read_b64_tr_b16 v[210:211], v203 offset:512
    s_add_u32 m0, s39, 4096
    v_add_f32 v176, 1.0, v176
    v_add_f32 v177, 1.0, v177
    v_mfma_f32_32x32x16_bf16 v[16:31], v[216:219], v[160:163], v[16:31]
    buffer_load_dwordx4 v200, s[12:15], s32 offen offset:0 lds
    v_rcp_f32 v176, v176
    v_mfma_f32_32x32x16_bf16 v[0:15], v[220:223], a[132:135], v[0:15]
    ds_read_b64_tr_b16 v[212:213], v203 offset:2048
    ds_read_b64_tr_b16 v[214:215], v203 offset:2560
    v_rcp_f32 v177, v177
    v_mul_f32 v178, v178, v176
    v_mfma_f32_32x32x16_bf16 v[16:31], v[220:223], v[164:167], v[16:31]
    v_mul_f32 v179, v179, v177
    v_cvt_pk_bf16_f32 v196, v178, v179
    v_mul_f32 v180, v114, v114
    s_waitcnt lgkmcnt(4)
    v_mfma_f32_32x32x16_bf16 v[0:15], v[224:227], a[136:139], v[0:15]
    ds_read_b64_tr_b16 v[216:217], v203 offset:4096
    ds_read_b64_tr_b16 v[218:219], v203 offset:4608
    v_mul_f32 v181, v115, v115
    v_fmaak_f32 v180, v180, v207, 0xc0135761
    v_mfma_f32_32x32x16_bf16 v[16:31], v[224:227], v[168:171], v[16:31]
    buffer_load_dwordx4 v200, s[12:15], s33 offen offset:1024 lds
    v_fmaak_f32 v181, v181, v207, 0xc0135761
    v_mul_f32 v180, v180, v114
    v_mul_f32 v181, v181, v115
    v_mfma_f32_32x32x16_bf16 v[0:15], v[228:231], a[140:143], v[0:15]
    ds_read_b64_tr_b16 v[220:221], v203 offset:6144
    ds_read_b64_tr_b16 v[222:223], v203 offset:6656
    v_exp_f32 v180, v180
    v_mfma_f32_32x32x16_bf16 v[16:31], v[228:231], v[172:175], v[16:31]
    v_mul_f32 v182, v114, v118
    v_exp_f32 v181, v181
    s_waitcnt lgkmcnt(4)
    v_mfma_f32_32x32x16_bf16 v[32:47], v[208:211], a[96:99], v[32:47]
    ds_read_b64_tr_b16 v[224:225], v203 offset:8192
    ds_read_b64_tr_b16 v[226:227], v203 offset:8704
    s_add_u32 m0, s39, 24576
    v_mul_f32 v183, v115, v119
    v_add_f32 v180, 1.0, v180
    v_mfma_f32_32x32x16_bf16 v[48:63], v[208:211], a[240:243], v[48:63]
    buffer_load_dwordx4 v201, s[16:19], s28 offen offset:0 lds
    v_add_f32 v181, 1.0, v181
    v_rcp_f32 v180, v180
    v_mfma_f32_32x32x16_bf16 v[32:47], v[212:215], a[100:103], v[32:47]
    ds_read_b64_tr_b16 v[228:229], v203 offset:10240
    ds_read_b64_tr_b16 v[230:231], v203 offset:10752
    v_rcp_f32 v181, v181
    v_mfma_f32_32x32x16_bf16 v[48:63], v[212:215], a[244:247], v[48:63]
    v_mul_f32 v182, v182, v180
    v_mul_f32 v183, v183, v181
    v_cvt_pk_bf16_f32 v197, v182, v183
    s_waitcnt lgkmcnt(4)
    v_mfma_f32_32x32x16_bf16 v[32:47], v[216:219], a[104:107], v[32:47]
    ds_read_b64_tr_b16 v[208:209], v203 offset:12288
    ds_read_b64_tr_b16 v[210:211], v203 offset:12800
    v_mul_f32 v184, v120, v120
    v_mul_f32 v185, v121, v121
    v_fmaak_f32 v184, v184, v207, 0xc0135761
    v_mfma_f32_32x32x16_bf16 v[48:63], v[216:219], a[248:251], v[48:63]
    buffer_load_dwordx4 v201, s[16:19], s29 offen offset:1024 lds
    v_fmaak_f32 v185, v185, v207, 0xc0135761
    v_mul_f32 v184, v184, v120
    v_mfma_f32_32x32x16_bf16 v[32:47], v[220:223], a[108:111], v[32:47]
    ds_read_b64_tr_b16 v[212:213], v203 offset:14336
    ds_read_b64_tr_b16 v[214:215], v203 offset:14848
    v_mul_f32 v185, v185, v121
    v_exp_f32 v184, v184
    v_mfma_f32_32x32x16_bf16 v[48:63], v[220:223], a[252:255], v[48:63]
    v_mul_f32 v186, v120, v124
    v_exp_f32 v185, v185
    s_waitcnt lgkmcnt(4)
    v_mfma_f32_32x32x16_bf16 v[32:47], v[224:227], a[112:115], v[32:47]
    ds_read_b64_tr_b16 v[216:217], v203 offset:16384
    ds_read_b64_tr_b16 v[218:219], v203 offset:16896
    v_mul_f32 v187, v121, v125
    v_add_f32 v184, 1.0, v184
    v_mfma_f32_32x32x16_bf16 v[48:63], v[224:227], v[144:147], v[48:63]
    buffer_load_dwordx4 v201, s[16:19], s30 offen offset:2048 lds
    v_add_f32 v185, 1.0, v185
    v_rcp_f32 v184, v184
    v_mfma_f32_32x32x16_bf16 v[32:47], v[228:231], a[116:119], v[32:47]
    ds_read_b64_tr_b16 v[220:221], v203 offset:18432
    ds_read_b64_tr_b16 v[222:223], v203 offset:18944
    v_rcp_f32 v185, v185
    v_mfma_f32_32x32x16_bf16 v[48:63], v[228:231], v[148:151], v[48:63]
    v_mul_f32 v186, v186, v184
    v_mul_f32 v187, v187, v185
    v_cvt_pk_bf16_f32 v198, v186, v187
    s_waitcnt lgkmcnt(4)
    v_mfma_f32_32x32x16_bf16 v[32:47], v[208:211], a[120:123], v[32:47]
    ds_read_b64_tr_b16 v[224:225], v203 offset:20480
    ds_read_b64_tr_b16 v[226:227], v203 offset:20992
    v_mul_f32 v188, v122, v122
    v_mul_f32 v189, v123, v123
    v_mfma_f32_32x32x16_bf16 v[48:63], v[208:211], v[152:155], v[48:63]
    buffer_load_dwordx4 v201, s[16:19], s31 offen offset:3072 lds
    v_fmaak_f32 v188, v188, v207, 0xc0135761
    v_fmaak_f32 v189, v189, v207, 0xc0135761
    v_mul_f32 v188, v188, v122
    v_mfma_f32_32x32x16_bf16 v[32:47], v[212:215], a[124:127], v[32:47]
    ds_read_b64_tr_b16 v[228:229], v203 offset:22528
    ds_read_b64_tr_b16 v[230:231], v203 offset:23040
    v_mul_f32 v189, v189, v123
    v_exp_f32 v188, v188
    v_mfma_f32_32x32x16_bf16 v[48:63], v[212:215], v[156:159], v[48:63]
    v_mul_f32 v190, v122, v126
    v_exp_f32 v189, v189
    s_waitcnt lgkmcnt(4)
    v_mfma_f32_32x32x16_bf16 v[32:47], v[216:219], a[128:131], v[32:47]
    s_add_u32 m0, s39, 28672
    v_mul_f32 v191, v123, v127
    v_add_f32 v188, 1.0, v188
    v_mfma_f32_32x32x16_bf16 v[48:63], v[216:219], v[160:163], v[48:63]
    buffer_load_dwordx4 v201, s[16:19], s32 offen offset:0 lds
    v_add_f32 v189, 1.0, v189
    v_rcp_f32 v188, v188
    v_mfma_f32_32x32x16_bf16 v[32:47], v[220:223], a[132:135], v[32:47]
    s_add_u32 s39, s38, s34
    s_add_u32 s38, s38, 49152
    s_cmp_eq_u32 s38, 147456
    s_cselect_b32 s38, 0, s38
    v_add_u32 v202, s38, v204
    v_add_u32 v203, s38, v205
    v_mfma_f32_32x32x16_bf16 v[48:63], v[220:223], v[164:167], v[48:63]
    v_rcp_f32 v189, v189
    v_mul_f32 v190, v190, v188
    s_waitcnt lgkmcnt(0)
    v_mfma_f32_32x32x16_bf16 v[32:47], v[224:227], a[136:139], v[32:47]
    s_waitcnt vmcnt(12) lgkmcnt(0)
    s_barrier
    ds_read_b64_tr_b16 v[208:209], v202 offset:0
    ds_read_b64_tr_b16 v[210:211], v202 offset:512
    ds_read_b64_tr_b16 v[212:213], v202 offset:2048
    ds_read_b64_tr_b16 v[214:215], v202 offset:2560
    v_mfma_f32_32x32x16_bf16 v[48:63], v[224:227], v[168:171], v[48:63]
    buffer_load_dwordx4 v201, s[16:19], s33 offen offset:1024 lds
    v_mul_f32 v191, v191, v189
    v_cvt_pk_bf16_f32 v199, v190, v191
    v_mfma_f32_32x32x16_bf16 v[32:47], v[228:231], a[140:143], v[32:47]
    ds_read_b64_tr_b16 v[216:217], v202 offset:4096
    ds_read_b64_tr_b16 v[218:219], v202 offset:4608
    ds_read_b64_tr_b16 v[220:221], v202 offset:6144
    ds_read_b64_tr_b16 v[222:223], v202 offset:6656
    buffer_store_dwordx4 v[196:199], v206, s[20:23], s37 offen offset:1024 sc1
    v_mfma_f32_32x32x16_bf16 v[48:63], v[228:231], v[172:175], v[48:63]
    v_add_u32 v200, s35, v200
    v_add_u32 v201, s35, v201
    s_add_u32 s36, s36, 4096
    s_add_u32 s37, s37, 4096
    s_add_u32 s40, s40, 1
    s_cmp_eq_u32 s40, 3
    s_cbranch_scc1 gated_mix__spectral_gfnet__glu_gated_geglu__prompt_kernel_bodyB
gated_mix__spectral_gfnet__glu_gated_geglu__prompt_kernel_xtail:
    s_nop 7
    s_nop 3
    v_mul_f32 v176, v0, v0
    v_mul_f32 v177, v1, v1
    v_fmaak_f32 v176, v176, v207, 0xc0135761
    v_fmaak_f32 v177, v177, v207, 0xc0135761
    v_mul_f32 v176, v176, v0
    v_mul_f32 v177, v177, v1
    v_exp_f32 v176, v176
    v_mul_f32 v178, v0, v4
    v_exp_f32 v177, v177
    v_mul_f32 v179, v1, v5
    v_add_f32 v176, 1.0, v176
    v_add_f32 v177, 1.0, v177
    v_rcp_f32 v176, v176
    v_rcp_f32 v177, v177
    v_mul_f32 v178, v178, v176
    v_mul_f32 v179, v179, v177
    v_cvt_pk_bf16_f32 v192, v178, v179
    v_mul_f32 v180, v2, v2
    v_mul_f32 v181, v3, v3
    v_fmaak_f32 v180, v180, v207, 0xc0135761
    v_fmaak_f32 v181, v181, v207, 0xc0135761
    v_mul_f32 v180, v180, v2
    v_mul_f32 v181, v181, v3
    v_exp_f32 v180, v180
    v_mul_f32 v182, v2, v6
    v_exp_f32 v181, v181
    v_mul_f32 v183, v3, v7
    v_add_f32 v180, 1.0, v180
    v_add_f32 v181, 1.0, v181
    v_rcp_f32 v180, v180
    v_rcp_f32 v181, v181
    v_mul_f32 v182, v182, v180
    v_mul_f32 v183, v183, v181
    v_cvt_pk_bf16_f32 v193, v182, v183
    v_mul_f32 v184, v8, v8
    v_mul_f32 v185, v9, v9
    v_fmaak_f32 v184, v184, v207, 0xc0135761
    v_fmaak_f32 v185, v185, v207, 0xc0135761
    v_mul_f32 v184, v184, v8
    v_mul_f32 v185, v185, v9
    v_exp_f32 v184, v184
    v_mul_f32 v186, v8, v12
    v_exp_f32 v185, v185
    v_mul_f32 v187, v9, v13
    v_add_f32 v184, 1.0, v184
    v_add_f32 v185, 1.0, v185
    v_rcp_f32 v184, v184
    v_rcp_f32 v185, v185
    v_mul_f32 v186, v186, v184
    v_mul_f32 v187, v187, v185
    v_cvt_pk_bf16_f32 v194, v186, v187
    v_mul_f32 v188, v10, v10
    v_mul_f32 v189, v11, v11
    v_fmaak_f32 v188, v188, v207, 0xc0135761
    v_fmaak_f32 v189, v189, v207, 0xc0135761
    v_mul_f32 v188, v188, v10
    v_mul_f32 v189, v189, v11
    v_exp_f32 v188, v188
    v_mul_f32 v190, v10, v14
    v_exp_f32 v189, v189
    v_mul_f32 v191, v11, v15
    v_add_f32 v188, 1.0, v188
    v_add_f32 v189, 1.0, v189
    v_rcp_f32 v188, v188
    v_rcp_f32 v189, v189
    v_mul_f32 v190, v190, v188
    v_mul_f32 v191, v191, v189
    v_cvt_pk_bf16_f32 v195, v190, v191
    buffer_store_dwordx4 v[192:195], v206, s[20:23], s36 offen offset:0 sc1
    v_mul_f32 v176, v16, v16
    v_mul_f32 v177, v17, v17
    v_fmaak_f32 v176, v176, v207, 0xc0135761
    v_fmaak_f32 v177, v177, v207, 0xc0135761
    v_mul_f32 v176, v176, v16
    v_mul_f32 v177, v177, v17
    v_exp_f32 v176, v176
    v_mul_f32 v178, v16, v20
    v_exp_f32 v177, v177
    v_mul_f32 v179, v17, v21
    v_add_f32 v176, 1.0, v176
    v_add_f32 v177, 1.0, v177
    v_rcp_f32 v176, v176
    v_rcp_f32 v177, v177
    v_mul_f32 v178, v178, v176
    v_mul_f32 v179, v179, v177
    v_cvt_pk_bf16_f32 v196, v178, v179
    v_mul_f32 v180, v18, v18
    v_mul_f32 v181, v19, v19
    v_fmaak_f32 v180, v180, v207, 0xc0135761
    v_fmaak_f32 v181, v181, v207, 0xc0135761
    v_mul_f32 v180, v180, v18
    v_mul_f32 v181, v181, v19
    v_exp_f32 v180, v180
    v_mul_f32 v182, v18, v22
    v_exp_f32 v181, v181
    v_mul_f32 v183, v19, v23
    v_add_f32 v180, 1.0, v180
    v_add_f32 v181, 1.0, v181
    v_rcp_f32 v180, v180
    v_rcp_f32 v181, v181
    v_mul_f32 v182, v182, v180
    v_mul_f32 v183, v183, v181
    v_cvt_pk_bf16_f32 v197, v182, v183
    v_mul_f32 v184, v24, v24
    v_mul_f32 v185, v25, v25
    v_fmaak_f32 v184, v184, v207, 0xc0135761
    v_fmaak_f32 v185, v185, v207, 0xc0135761
    v_mul_f32 v184, v184, v24
    v_mul_f32 v185, v185, v25
    v_exp_f32 v184, v184
    v_mul_f32 v186, v24, v28
    v_exp_f32 v185, v185
    v_mul_f32 v187, v25, v29
    v_add_f32 v184, 1.0, v184
    v_add_f32 v185, 1.0, v185
    v_rcp_f32 v184, v184
    v_rcp_f32 v185, v185
    v_mul_f32 v186, v186, v184
    v_mul_f32 v187, v187, v185
    v_cvt_pk_bf16_f32 v198, v186, v187
    v_mul_f32 v188, v26, v26
    v_mul_f32 v189, v27, v27
    v_fmaak_f32 v188, v188, v207, 0xc0135761
    v_fmaak_f32 v189, v189, v207, 0xc0135761
    v_mul_f32 v188, v188, v26
    v_mul_f32 v189, v189, v27
    v_exp_f32 v188, v188
    v_mul_f32 v190, v26, v30
    v_exp_f32 v189, v189
    v_mul_f32 v191, v27, v31
    v_add_f32 v188, 1.0, v188
    v_add_f32 v189, 1.0, v189
    v_rcp_f32 v188, v188
    v_rcp_f32 v189, v189
    v_mul_f32 v190, v190, v188
    v_mul_f32 v191, v191, v189
    v_cvt_pk_bf16_f32 v199, v190, v191
    buffer_store_dwordx4 v[196:199], v206, s[20:23], s37 offen offset:0 sc1
    v_mul_f32 v176, v32, v32
    v_mul_f32 v177, v33, v33
    v_fmaak_f32 v176, v176, v207, 0xc0135761
    v_fmaak_f32 v177, v177, v207, 0xc0135761
    v_mul_f32 v176, v176, v32
    v_mul_f32 v177, v177, v33
    v_exp_f32 v176, v176
    v_mul_f32 v178, v32, v36
    v_exp_f32 v177, v177
    v_mul_f32 v179, v33, v37
    v_add_f32 v176, 1.0, v176
    v_add_f32 v177, 1.0, v177
    v_rcp_f32 v176, v176
    v_rcp_f32 v177, v177
    v_mul_f32 v178, v178, v176
    v_mul_f32 v179, v179, v177
    v_cvt_pk_bf16_f32 v192, v178, v179
    v_mul_f32 v180, v34, v34
    v_mul_f32 v181, v35, v35
    v_fmaak_f32 v180, v180, v207, 0xc0135761
    v_fmaak_f32 v181, v181, v207, 0xc0135761
    v_mul_f32 v180, v180, v34
    v_mul_f32 v181, v181, v35
    v_exp_f32 v180, v180
    v_mul_f32 v182, v34, v38
    v_exp_f32 v181, v181
    v_mul_f32 v183, v35, v39
    v_add_f32 v180, 1.0, v180
    v_add_f32 v181, 1.0, v181
    v_rcp_f32 v180, v180
    v_rcp_f32 v181, v181
    v_mul_f32 v182, v182, v180
    v_mul_f32 v183, v183, v181
    v_cvt_pk_bf16_f32 v193, v182, v183
    v_mul_f32 v184, v40, v40
    v_mul_f32 v185, v41, v41
    v_fmaak_f32 v184, v184, v207, 0xc0135761
    v_fmaak_f32 v185, v185, v207, 0xc0135761
    v_mul_f32 v184, v184, v40
    v_mul_f32 v185, v185, v41
    v_exp_f32 v184, v184
    v_mul_f32 v186, v40, v44
    v_exp_f32 v185, v185
    v_mul_f32 v187, v41, v45
    v_add_f32 v184, 1.0, v184
    v_add_f32 v185, 1.0, v185
    v_rcp_f32 v184, v184
    v_rcp_f32 v185, v185
    v_mul_f32 v186, v186, v184
    v_mul_f32 v187, v187, v185
    v_cvt_pk_bf16_f32 v194, v186, v187
    v_mul_f32 v188, v42, v42
    v_mul_f32 v189, v43, v43
    v_fmaak_f32 v188, v188, v207, 0xc0135761
    v_fmaak_f32 v189, v189, v207, 0xc0135761
    v_mul_f32 v188, v188, v42
    v_mul_f32 v189, v189, v43
    v_exp_f32 v188, v188
    v_mul_f32 v190, v42, v46
    v_exp_f32 v189, v189
    v_mul_f32 v191, v43, v47
    v_add_f32 v188, 1.0, v188
    v_add_f32 v189, 1.0, v189
    v_rcp_f32 v188, v188
    v_rcp_f32 v189, v189
    v_mul_f32 v190, v190, v188
    v_mul_f32 v191, v191, v189
    v_cvt_pk_bf16_f32 v195, v190, v191
    buffer_store_dwordx4 v[192:195], v206, s[20:23], s36 offen offset:1024 sc1
    v_mul_f32 v176, v48, v48
    v_mul_f32 v177, v49, v49
    v_fmaak_f32 v176, v176, v207, 0xc0135761
    v_fmaak_f32 v177, v177, v207, 0xc0135761
    v_mul_f32 v176, v176, v48
    v_mul_f32 v177, v177, v49
    v_exp_f32 v176, v176
    v_mul_f32 v178, v48, v52
    v_exp_f32 v177, v177
    v_mul_f32 v179, v49, v53
    v_add_f32 v176, 1.0, v176
    v_add_f32 v177, 1.0, v177
    v_rcp_f32 v176, v176
    v_rcp_f32 v177, v177
    v_mul_f32 v178, v178, v176
    v_mul_f32 v179, v179, v177
    v_cvt_pk_bf16_f32 v196, v178, v179
    v_mul_f32 v180, v50, v50
    v_mul_f32 v181, v51, v51
    v_fmaak_f32 v180, v180, v207, 0xc0135761
    v_fmaak_f32 v181, v181, v207, 0xc0135761
    v_mul_f32 v180, v180, v50
    v_mul_f32 v181, v181, v51
    v_exp_f32 v180, v180
    v_mul_f32 v182, v50, v54
    v_exp_f32 v181, v181
    v_mul_f32 v183, v51, v55
    v_add_f32 v180, 1.0, v180
    v_add_f32 v181, 1.0, v181
    v_rcp_f32 v180, v180
    v_rcp_f32 v181, v181
    v_mul_f32 v182, v182, v180
    v_mul_f32 v183, v183, v181
    v_cvt_pk_bf16_f32 v197, v182, v183
    v_mul_f32 v184, v56, v56
    v_mul_f32 v185, v57, v57
    v_fmaak_f32 v184, v184, v207, 0xc0135761
    v_fmaak_f32 v185, v185, v207, 0xc0135761
    v_mul_f32 v184, v184, v56
    v_mul_f32 v185, v185, v57
    v_exp_f32 v184, v184
    v_mul_f32 v186, v56, v60
    v_exp_f32 v185, v185
    v_mul_f32 v187, v57, v61
    v_add_f32 v184, 1.0, v184
    v_add_f32 v185, 1.0, v185
    v_rcp_f32 v184, v184
    v_rcp_f32 v185, v185
    v_mul_f32 v186, v186, v184
    v_mul_f32 v187, v187, v185
    v_cvt_pk_bf16_f32 v198, v186, v187
    v_mul_f32 v188, v58, v58
    v_mul_f32 v189, v59, v59
    v_fmaak_f32 v188, v188, v207, 0xc0135761
    v_fmaak_f32 v189, v189, v207, 0xc0135761
    v_mul_f32 v188, v188, v58
    v_mul_f32 v189, v189, v59
    v_exp_f32 v188, v188
    v_mul_f32 v190, v58, v62
    v_exp_f32 v189, v189
    v_mul_f32 v191, v59, v63
    v_add_f32 v188, 1.0, v188
    v_add_f32 v189, 1.0, v189
    v_rcp_f32 v188, v188
    v_rcp_f32 v189, v189
    v_mul_f32 v190, v190, v188
    v_mul_f32 v191, v191, v189
    v_cvt_pk_bf16_f32 v199, v190, v191
    buffer_store_dwordx4 v[196:199], v206, s[20:23], s37 offen offset:1024 sc1
    s_branch gated_mix__spectral_gfnet__glu_gated_geglu__prompt_kernel_fin
gated_mix__spectral_gfnet__glu_gated_geglu__prompt_kernel_h1:
    s_cmp_eq_u32 s41, 0
    s_cbranch_scc1 gated_mix__spectral_gfnet__glu_gated_geglu__prompt_kernel_h1r
    s_cmp_eq_u32 s41, 1
    s_cbranch_scc1 gated_mix__spectral_gfnet__glu_gated_geglu__prompt_kernel_h1d
    s_mov_b32 s14, 0
    s_mov_b32 s18, 0
    s_branch gated_mix__spectral_gfnet__glu_gated_geglu__prompt_kernel_h1r
gated_mix__spectral_gfnet__glu_gated_geglu__prompt_kernel_h1d:
    s_waitcnt vmcnt(58)
    s_mov_b32 s55, 0
gated_mix__spectral_gfnet__glu_gated_geglu__prompt_kernel_spin:
    v_readfirstlane_b32 s54, v240
    s_add_u32 s55, s55, 1
    s_cmp_ge_u32 s55, 0x100000
    s_cbranch_scc1 gated_mix__spectral_gfnet__glu_gated_geglu__prompt_kernel_spun
    s_cmp_ge_u32 s54, 256
    s_cbranch_scc1 gated_mix__spectral_gfnet__glu_gated_geglu__prompt_kernel_spun
    buffer_load_dword v240, v243, s[24:27], 0 offen sc1
    s_waitcnt vmcnt(0)
    s_branch gated_mix__spectral_gfnet__glu_gated_geglu__prompt_kernel_spin
gated_mix__spectral_gfnet__glu_gated_geglu__prompt_kernel_spun:
    s_add_u32 s12, s74, 18874368
    s_addc_u32 s13, s75, 0
    s_mov_b32 s14, 737280
    s_mov_b32 s16, s12
    s_mov_b32 s17, s13
    s_mov_b32 s18, 737280
    s_mov_b32 s35, 245760
    s_mul_i32 s54, s3, 61440
    s_add_u32 s28, s54, 0
    s_add_u32 s29, s54, 9216
    s_add_u32 s30, s54, 18432
    s_add_u32 s31, s54, 27648
    s_add_u32 s32, s54, 40960
    s_add_u32 s33, s54, 50176
    v_lshrrev_b32 v132, 3, v241
    v_and_b32 v133, 7, v241
    v_bfe_u32 v134, v241, 4, 1
    v_lshlrev_b32 v134, 2, v134
    v_xor_b32 v134, v134, v133
    v_lshlrev_b32 v135, 4, v134
    v_xor_b32 v136, 32, v135
    v_mul_u32_u24 v137, 1280, v132
    s_lshl_b32 s54, s42, 8
    v_add_u32 v137, s54, v137
    v_add_u32 v200, v137, v135
    v_add_u32 v201, v137, v136
    v_add_u32 v201, 128, v201
    s_branch gated_mix__spectral_gfnet__glu_gated_geglu__prompt_kernel_h1r
gated_mix__spectral_gfnet__glu_gated_geglu__prompt_kernel_ytail:
    s_cmp_eq_u32 s41, 2
    s_cbranch_scc1 gated_mix__spectral_gfnet__glu_gated_geglu__prompt_kernel_spare
gated_mix__spectral_gfnet__glu_gated_geglu__prompt_kernel_bodyD:
    s_waitcnt lgkmcnt(4)
    v_mfma_f32_32x32x16_bf16 v[0:15], a[0:3], v[208:211], 0
    ds_read_b64_tr_b16 v[224:225], v202 offset:8192
    ds_read_b64_tr_b16 v[226:227], v202 offset:8704
    s_add_u32 m0, s39, 0
    v_mfma_f32_32x32x16_bf16 v[16:31], a[144:147], v[208:211], 0
    buffer_load_dwordx4 v200, s[12:15], s28 offen offset:0 lds
    v_mul_f32 v176, v64, v64
    v_mul_f32 v177, v65, v65
    v_mfma_f32_32x32x16_bf16 v[0:15], a[4:7], v[212:215], v[0:15]
    ds_read_b64_tr_b16 v[228:229], v202 offset:10240
    ds_read_b64_tr_b16 v[230:231], v202 offset:10752
    v_fmaak_f32 v176, v176, v207, 0xc0135761
    v_fmaak_f32 v177, v177, v207, 0xc0135761
    v_mfma_f32_32x32x16_bf16 v[16:31], a[148:151], v[212:215], v[16:31]
    v_mul_f32 v176, v176, v64
    v_mul_f32 v177, v177, v65
    s_waitcnt lgkmcnt(4)
    v_mfma_f32_32x32x16_bf16 v[0:15], a[8:11], v[216:219], v[0:15]
    ds_read_b64_tr_b16 v[208:209], v202 offset:12288
    ds_read_b64_tr_b16 v[210:211], v202 offset:12800
    v_exp_f32 v176, v176
    v_mul_f32 v178, v64, v68
    v_mfma_f32_32x32x16_bf16 v[16:31], a[152:155], v[216:219], v[16:31]
    buffer_load_dwordx4 v200, s[12:15], s29 offen offset:1024 lds
    v_exp_f32 v177, v177
    v_mfma_f32_32x32x16_bf16 v[0:15], a[12:15], v[220:223], v[0:15]
    ds_read_b64_tr_b16 v[212:213], v202 offset:14336
    ds_read_b64_tr_b16 v[214:215], v202 offset:14848
    v_mul_f32 v179, v65, v69
    v_add_f32 v176, 1.0, v176
    v_mfma_f32_32x32x16_bf16 v[16:31], a[156:159], v[220:223], v[16:31]
    v_add_f32 v177, 1.0, v177
    v_rcp_f32 v176, v176
    s_waitcnt lgkmcnt(4)
    v_mfma_f32_32x32x16_bf16 v[0:15], a[16:19], v[224:227], v[0:15]
    ds_read_b64_tr_b16 v[216:217], v202 offset:16384
    ds_read_b64_tr_b16 v[218:219], v202 offset:16896
    v_rcp_f32 v177, v177
    v_mfma_f32_32x32x16_bf16 v[16:31], a[160:163], v[224:227], v[16:31]
    buffer_load_dwordx4 v200, s[12:15], s30 offen offset:2048 lds
    v_mul_f32 v178, v178, v176
    v_mul_f32 v179, v179, v177
    v_mfma_f32_32x32x16_bf16 v[0:15], a[20:23], v[228:231], v[0:15]
    ds_read_b64_tr_b16 v[220:221], v202 offset:18432
    ds_read_b64_tr_b16 v[222:223], v202 offset:18944
    v_cvt_pk_bf16_f32 v192, v178, v179
    v_mul_f32 v180, v66, v66
    v_mfma_f32_32x32x16_bf16 v[16:31], a[164:167], v[228:231], v[16:31]
    v_mul_f32 v181, v67, v67
    v_fmaak_f32 v180, v180, v207, 0xc0135761
    v_fmaak_f32 v181, v181, v207, 0xc0135761
    s_waitcnt lgkmcnt(4)
    v_mfma_f32_32x32x16_bf16 v[0:15], a[24:27], v[208:211], v[0:15]
    ds_read_b64_tr_b16 v[224:225], v202 offset:20480
    ds_read_b64_tr_b16 v[226:227], v202 offset:20992
    v_mul_f32 v180, v180, v66
    v_mul_f32 v181, v181, v67
    v_mfma_f32_32x32x16_bf16 v[16:31], a[168:171], v[208:211], v[16:31]
    buffer_load_dwordx4 v200, s[12:15], s31 offen offset:3072 lds
    v_exp_f32 v180, v180
    v_mfma_f32_32x32x16_bf16 v[0:15], a[28:31], v[212:215], v[0:15]
    ds_read_b64_tr_b16 v[228:229], v202 offset:22528
    ds_read_b64_tr_b16 v[230:231], v202 offset:23040
    v_mul_f32 v182, v66, v70
    v_exp_f32 v181, v181
    v_mfma_f32_32x32x16_bf16 v[16:31], a[172:175], v[212:215], v[16:31]
    v_mul_f32 v183, v67, v71
    v_add_f32 v180, 1.0, v180
    s_waitcnt lgkmcnt(4)
    v_mfma_f32_32x32x16_bf16 v[0:15], a[32:35], v[216:219], v[0:15]
    ds_read_b64_tr_b16 v[208:209], v203 offset:0
    ds_read_b64_tr_b16 v[210:211], v203 offset:512
    s_add_u32 m0, s39, 4096
    v_add_f32 v181, 1.0, v181
    v_mfma_f32_32x32x16_bf16 v[16:31], a[176:179], v[216:219], v[16:31]
    buffer_load_dwordx4 v200, s[12:15], s32 offen offset:0 lds
    v_rcp_f32 v180, v180
    v_mfma_f32_32x32x16_bf16 v[0:15], a[36:39], v[220:223], v[0:15]
    ds_read_b64_tr_b16 v[212:213], v203 offset:2048
    ds_read_b64_tr_b16 v[214:215], v203 offset:2560
    v_rcp_f32 v181, v181
    v_mul_f32 v182, v182, v180
    v_mfma_f32_32x32x16_bf16 v[16:31], a[180:183], v[220:223], v[16:31]
    v_mul_f32 v183, v183, v181
    v_cvt_pk_bf16_f32 v193, v182, v183
    v_mul_f32 v184, v72, v72
    s_waitcnt lgkmcnt(4)
    v_mfma_f32_32x32x16_bf16 v[0:15], a[40:43], v[224:227], v[0:15]
    ds_read_b64_tr_b16 v[216:217], v203 offset:4096
    ds_read_b64_tr_b16 v[218:219], v203 offset:4608
    v_mul_f32 v185, v73, v73
    v_fmaak_f32 v184, v184, v207, 0xc0135761
    v_mfma_f32_32x32x16_bf16 v[16:31], a[184:187], v[224:227], v[16:31]
    buffer_load_dwordx4 v200, s[12:15], s33 offen offset:1024 lds
    v_fmaak_f32 v185, v185, v207, 0xc0135761
    v_mul_f32 v184, v184, v72
    v_mfma_f32_32x32x16_bf16 v[0:15], a[44:47], v[228:231], v[0:15]
    ds_read_b64_tr_b16 v[220:221], v203 offset:6144
    ds_read_b64_tr_b16 v[222:223], v203 offset:6656
    v_mul_f32 v185, v185, v73
    v_mfma_f32_32x32x16_bf16 v[16:31], a[188:191], v[228:231], v[16:31]
    v_exp_f32 v184, v184
    v_mul_f32 v186, v72, v76
    s_waitcnt lgkmcnt(4)
    v_mfma_f32_32x32x16_bf16 v[32:47], a[0:3], v[208:211], 0
    ds_read_b64_tr_b16 v[224:225], v203 offset:8192
    ds_read_b64_tr_b16 v[226:227], v203 offset:8704
    s_add_u32 m0, s39, 24576
    v_exp_f32 v185, v185
    v_mfma_f32_32x32x16_bf16 v[48:63], a[144:147], v[208:211], 0
    buffer_load_dwordx4 v201, s[16:19], s28 offen offset:0 lds
    v_mul_f32 v187, v73, v77
    v_add_f32 v184, 1.0, v184
    v_mfma_f32_32x32x16_bf16 v[32:47], a[4:7], v[212:215], v[32:47]
    ds_read_b64_tr_b16 v[228:229], v203 offset:10240
    ds_read_b64_tr_b16 v[230:231], v203 offset:10752
    v_add_f32 v185, 1.0, v185
    v_rcp_f32 v184, v184
    v_mfma_f32_32x32x16_bf16 v[48:63], a[148:151], v[212:215], v[48:63]
    v_rcp_f32 v185, v185
    s_waitcnt lgkmcnt(4)
    v_mfma_f32_32x32x16_bf16 v[32:47], a[8:11], v[216:219], v[32:47]
    ds_read_b64_tr_b16 v[208:209], v203 offset:12288
    ds_read_b64_tr_b16 v[210:211], v203 offset:12800
    v_mul_f32 v186, v186, v184
    v_mul_f32 v187, v187, v185
    v_mfma_f32_32x32x16_bf16 v[48:63], a[152:155], v[216:219], v[48:63]
    buffer_load_dwordx4 v201, s[16:19], s29 offen offset:1024 lds
    v_cvt_pk_bf16_f32 v194, v186, v187
    v_mul_f32 v188, v74, v74
    v_mfma_f32_32x32x16_bf16 v[32:47], a[12:15], v[220:223], v[32:47]
    ds_read_b64_tr_b16 v[212:213], v203 offset:14336
    ds_read_b64_tr_b16 v[214:215], v203 offset:14848
    v_mul_f32 v189, v75, v75
    v_fmaak_f32 v188, v188, v207, 0xc0135761
    v_fmaak_f32 v189, v189, v207, 0xc0135761
    v_mfma_f32_32x32x16_bf16 v[48:63], a[156:159], v[220:223], v[48:63]
    v_mul_f32 v188, v188, v74
    v_mul_f32 v189, v189, v75
    s_waitcnt lgkmcnt(4)
    v_mfma_f32_32x32x16_bf16 v[32:47], a[16:19], v[224:227], v[32:47]
    ds_read_b64_tr_b16 v[216:217], v203 offset:16384
    ds_read_b64_tr_b16 v[218:219], v203 offset:16896
    v_exp_f32 v188, v188
    v_mfma_f32_32x32x16_bf16 v[48:63], a[160:163], v[224:227], v[48:63]
    buffer_load_dwordx4 v201, s[16:19], s30 offen offset:2048 lds
    v_mul_f32 v190, v74, v78
    v_exp_f32 v189, v189
    v_mfma_f32_32x32x16_bf16 v[32:47], a[20:23], v[228:231], v[32:47]
    ds_read_b64_tr_b16 v[220:221], v203 offset:18432
    ds_read_b64_tr_b16 v[222:223], v203 offset:18944
    v_mul_f32 v191, v75, v79
    v_add_f32 v188, 1.0, v188
    v_mfma_f32_32x32x16_bf16 v[48:63], a[164:167], v[228:231], v[48:63]
    v_add_f32 v189, 1.0, v189
    v_rcp_f32 v188, v188
    s_waitcnt lgkmcnt(4)
    v_mfma_f32_32x32x16_bf16 v[32:47], a[24:27], v[208:211], v[32:47]
    ds_read_b64_tr_b16 v[224:225], v203 offset:20480
    ds_read_b64_tr_b16 v[226:227], v203 offset:20992
    v_rcp_f32 v189, v189
    v_mfma_f32_32x32x16_bf16 v[48:63], a[168:171], v[208:211], v[48:63]
    buffer_load_dwordx4 v201, s[16:19], s31 offen offset:3072 lds
    v_mul_f32 v190, v190, v188
    v_mul_f32 v191, v191, v189
    v_mfma_f32_32x32x16_bf16 v[32:47], a[28:31], v[212:215], v[32:47]
    ds_read_b64_tr_b16 v[228:229], v203 offset:22528
    ds_read_b64_tr_b16 v[230:231], v203 offset:23040
    v_cvt_pk_bf16_f32 v195, v190, v191
    v_mfma_f32_32x32x16_bf16 v[48:63], a[172:175], v[212:215], v[48:63]
    buffer_store_dwordx4 v[192:195], v206, s[20:23], s36 offen offset:0 sc1
    v_mul_f32 v176, v80, v80
    s_waitcnt lgkmcnt(4)
    v_mfma_f32_32x32x16_bf16 v[32:47], a[32:35], v[216:219], v[32:47]
    s_add_u32 m0, s39, 28672
    v_mul_f32 v177, v81, v81
    v_fmaak_f32 v176, v176, v207, 0xc0135761
    v_fmaak_f32 v177, v177, v207, 0xc0135761
    v_mfma_f32_32x32x16_bf16 v[48:63], a[176:179], v[216:219], v[48:63]
    buffer_load_dwordx4 v201, s[16:19], s32 offen offset:0 lds
    v_mul_f32 v176, v176, v80
    v_mul_f32 v177, v177, v81
    v_mfma_f32_32x32x16_bf16 v[32:47], a[36:39], v[220:223], v[32:47]
    s_add_u32 s39, s38, s34
    s_add_u32 s38, s38, 49152
    s_cmp_eq_u32 s38, 147456
    s_cselect_b32 s38, 0, s38
    v_add_u32 v202, s38, v204
    v_add_u32 v203, s38, v205
    v_mfma_f32_32x32x16_bf16 v[48:63], a[180:183], v[220:223], v[48:63]
    v_exp_f32 v176, v176
    v_mul_f32 v178, v80, v84
    s_waitcnt lgkmcnt(0)
    v_mfma_f32_32x32x16_bf16 v[32:47], a[40:43], v[224:227], v[32:47]
    s_waitcnt vmcnt(13) lgkmcnt(0)
    s_barrier
    ds_read_b64_tr_b16 v[208:209], v202 offset:0
    ds_read_b64_tr_b16 v[210:211], v202 offset:512
    ds_read_b64_tr_b16 v[212:213], v202 offset:2048
    ds_read_b64_tr_b16 v[214:215], v202 offset:2560
    v_mfma_f32_32x32x16_bf16 v[48:63], a[184:187], v[224:227], v[48:63]
    buffer_load_dwordx4 v201, s[16:19], s33 offen offset:1024 lds
    v_exp_f32 v177, v177
    v_mfma_f32_32x32x16_bf16 v[32:47], a[44:47], v[228:231], v[32:47]
    ds_read_b64_tr_b16 v[216:217], v202 offset:4096
    ds_read_b64_tr_b16 v[218:219], v202 offset:4608
    ds_read_b64_tr_b16 v[220:221], v202 offset:6144
    ds_read_b64_tr_b16 v[222:223], v202 offset:6656
    v_mul_f32 v179, v81, v85
    v_mfma_f32_32x32x16_bf16 v[48:63], a[188:191], v[228:231], v[48:63]
    v_add_f32 v176, 1.0, v176
    v_add_f32 v177, 1.0, v177
    s_waitcnt lgkmcnt(4)
    v_mfma_f32_32x32x16_bf16 v[0:15], a[48:51], v[208:211], v[0:15]
    ds_read_b64_tr_b16 v[224:225], v202 offset:8192
    ds_read_b64_tr_b16 v[226:227], v202 offset:8704
    v_rcp_f32 v176, v176
    v_mfma_f32_32x32x16_bf16 v[16:31], a[192:195], v[208:211], v[16:31]
    v_rcp_f32 v177, v177
    v_mul_f32 v178, v178, v176
    v_mul_f32 v179, v179, v177
    v_mfma_f32_32x32x16_bf16 v[0:15], a[52:55], v[212:215], v[0:15]
    ds_read_b64_tr_b16 v[228:229], v202 offset:10240
    ds_read_b64_tr_b16 v[230:231], v202 offset:10752
    v_cvt_pk_bf16_f32 v196, v178, v179
    v_mul_f32 v180, v82, v82
    v_mfma_f32_32x32x16_bf16 v[16:31], a[196:199], v[212:215], v[16:31]
    v_mul_f32 v181, v83, v83
    v_fmaak_f32 v180, v180, v207, 0xc0135761
    v_fmaak_f32 v181, v181, v207, 0xc0135761
    s_waitcnt lgkmcnt(4)
    v_mfma_f32_32x32x16_bf16 v[0:15], a[56:59], v[216:219], v[0:15]
    ds_read_b64_tr_b16 v[208:209], v202 offset:12288
    ds_read_b64_tr_b16 v[210:211], v202 offset:12800
    v_mul_f32 v180, v180, v82
    v_mul_f32 v181, v181, v83
    v_mfma_f32_32x32x16_bf16 v[16:31], a[200:203], v[216:219], v[16:31]
    v_exp_f32 v180, v180
    v_mul_f32 v182, v82, v86
    v_mfma_f32_32x32x16_bf16 v[0:15], a[60:63], v[220:223], v[0:15]
    ds_read_b64_tr_b16 v[212:213], v202 offset:14336
    ds_read_b64_tr_b16 v[214:215], v202 offset:14848
    v_exp_f32 v181, v181
    v_mfma_f32_32x32x16_bf16 v[16:31], a[204:207], v[220:223], v[16:31]
    v_mul_f32 v183, v83, v87
    v_add_f32 v180, 1.0, v180
    v_add_f32 v181, 1.0, v181
    s_waitcnt lgkmcnt(4)
    v_mfma_f32_32x32x16_bf16 v[0:15], a[64:67], v[224:227], v[0:15]
    ds_read_b64_tr_b16 v[216:217], v202 offset:16384
    ds_read_b64_tr_b16 v[218:219], v202 offset:16896
    v_rcp_f32 v180, v180
    v_mfma_f32_32x32x16_bf16 v[16:31], a[208:211], v[224:227], v[16:31]
    v_rcp_f32 v181, v181
    v_mul_f32 v182, v182, v180
    v_mfma_f32_32x32x16_bf16 v[0:15], a[68:71], v[228:231], v[0:15]
    ds_read_b64_tr_b16 v[220:221], v202 offset:18432
    ds_read_b64_tr_b16 v[222:223], v202 offset:18944
    v_mul_f32 v183, v183, v181
    v_cvt_pk_bf16_f32 v197, v182, v183
    v_mfma_f32_32x32x16_bf16 v[16:31], a[212:215], v[228:231], v[16:31]
    v_mul_f32 v184, v88, v88
    v_mul_f32 v185, v89, v89
    v_fmaak_f32 v184, v184, v207, 0xc0135761
    s_waitcnt lgkmcnt(4)
    v_mfma_f32_32x32x16_bf16 v[0:15], a[72:75], v[208:211], v[0:15]
    ds_read_b64_tr_b16 v[224:225], v202 offset:20480
    ds_read_b64_tr_b16 v[226:227], v202 offset:20992
    v_fmaak_f32 v185, v185, v207, 0xc0135761
    v_mul_f32 v184, v184, v88
    v_mfma_f32_32x32x16_bf16 v[16:31], a[216:219], v[208:211], v[16:31]
    v_mul_f32 v185, v185, v89
    v_exp_f32 v184, v184
    v_mfma_f32_32x32x16_bf16 v[0:15], a[76:79], v[212:215], v[0:15]
    ds_read_b64_tr_b16 v[228:229], v202 offset:22528
    ds_read_b64_tr_b16 v[230:231], v202 offset:23040
    v_mul_f32 v186, v88, v92
    v_exp_f32 v185, v185
    v_mfma_f32_32x32x16_bf16 v[16:31], a[220:223], v[212:215], v[16:31]
    v_mul_f32 v187, v89, v93
    v_add_f32 v184, 1.0, v184
    s_waitcnt lgkmcnt(4)
    v_mfma_f32_32x32x16_bf16 v[0:15], a[80:83], v[216:219], v[0:15]
    ds_read_b64_tr_b16 v[208:209], v203 offset:0
    ds_read_b64_tr_b16 v[210:211], v203 offset:512
    v_add_f32 v185, 1.0, v185
    v_rcp_f32 v184, v184
    v_mfma_f32_32x32x16_bf16 v[16:31], a[224:227], v[216:219], v[16:31]
    v_rcp_f32 v185, v185
    v_mfma_f32_32x32x16_bf16 v[0:15], a[84:87], v[220:223], v[0:15]
    ds_read_b64_tr_b16 v[212:213], v203 offset:2048
    ds_read_b64_tr_b16 v[214:215], v203 offset:2560
    v_mul_f32 v186, v186, v184
    v_mul_f32 v187, v187, v185
    v_cvt_pk_bf16_f32 v198, v186, v187
    v_mfma_f32_32x32x16_bf16 v[16:31], a[228:231], v[220:223], v[16:31]
    v_mul_f32 v188, v90, v90
    v_mul_f32 v189, v91, v91
    s_waitcnt lgkmcnt(4)
    v_mfma_f32_32x32x16_bf16 v[0:15], a[88:91], v[224:227], v[0:15]
    ds_read_b64_tr_b16 v[216:217], v203 offset:4096
    ds_read_b64_tr_b16 v[218:219], v203 offset:4608
    v_fmaak_f32 v188, v188, v207, 0xc0135761
    v_fmaak_f32 v189, v189, v207, 0xc0135761
    v_mfma_f32_32x32x16_bf16 v[16:31], a[232:235], v[224:227], v[16:31]
    v_mul_f32 v188, v188, v90
    v_mul_f32 v189, v189, v91
    v_exp_f32 v188, v188
    v_mfma_f32_32x32x16_bf16 v[0:15], a[92:95], v[228:231], v[0:15]
    ds_read_b64_tr_b16 v[220:221], v203 offset:6144
    ds_read_b64_tr_b16 v[222:223], v203 offset:6656
    v_mul_f32 v190, v90, v94
    v_mfma_f32_32x32x16_bf16 v[16:31], a[236:239], v[228:231], v[16:31]
    v_exp_f32 v189, v189
    v_mul_f32 v191, v91, v95
    s_waitcnt lgkmcnt(4)
    v_mfma_f32_32x32x16_bf16 v[32:47], a[48:51], v[208:211], v[32:47]
    ds_read_b64_tr_b16 v[224:225], v203 offset:8192
    ds_read_b64_tr_b16 v[226:227], v203 offset:8704
    v_add_f32 v188, 1.0, v188
    v_add_f32 v189, 1.0, v189
    v_mfma_f32_32x32x16_bf16 v[48:63], a[192:195], v[208:211], v[48:63]
    v_rcp_f32 v188, v188
    v_rcp_f32 v189, v189
    v_mfma_f32_32x32x16_bf16 v[32:47], a[52:55], v[212:215], v[32:47]
    ds_read_b64_tr_b16 v[228:229], v203 offset:10240
    ds_read_b64_tr_b16 v[230:231], v203 offset:10752
    v_mul_f32 v190, v190, v188
    v_mul_f32 v191, v191, v189
    v_mfma_f32_32x32x16_bf16 v[48:63], a[196:199], v[212:215], v[48:63]
    v_cvt_pk_bf16_f32 v199, v190, v191
    buffer_store_dwordx4 v[196:199], v206, s[20:23], s37 offen offset:0 sc1
    s_waitcnt lgkmcnt(4)
    v_mfma_f32_32x32x16_bf16 v[32:47], a[56:59], v[216:219], v[32:47]
    ds_read_b64_tr_b16 v[208:209], v203 offset:12288
    ds_read_b64_tr_b16 v[210:211], v203 offset:12800
    v_mul_f32 v176, v96, v96
    v_mul_f32 v177, v97, v97
    v_mfma_f32_32x32x16_bf16 v[48:63], a[200:203], v[216:219], v[48:63]
    v_fmaak_f32 v176, v176, v207, 0xc0135761
    v_fmaak_f32 v177, v177, v207, 0xc0135761
    v_mul_f32 v176, v176, v96
    v_mfma_f32_32x32x16_bf16 v[32:47], a[60:63], v[220:223], v[32:47]
    ds_read_b64_tr_b16 v[212:213], v203 offset:14336
    ds_read_b64_tr_b16 v[214:215], v203 offset:14848
    v_mul_f32 v177, v177, v97
    v_mfma_f32_32x32x16_bf16 v[48:63], a[204:207], v[220:223], v[48:63]
    v_exp_f32 v176, v176
    v_mul_f32 v178, v96, v100
    s_waitcnt lgkmcnt(4)
    v_mfma_f32_32x32x16_bf16 v[32:47], a[64:67], v[224:227], v[32:47]
    ds_read_b64_tr_b16 v[216:217], v203 offset:16384
    ds_read_b64_tr_b16 v[218:219], v203 offset:16896
    v_exp_f32 v177, v177
    v_mul_f32 v179, v97, v101
    v_mfma_f32_32x32x16_bf16 v[48:63], a[208:211], v[224:227], v[48:63]
    v_add_f32 v176, 1.0, v176
    v_add_f32 v177, 1.0, v177
    v_mfma_f32_32x32x16_bf16 v[32:47], a[68:71], v[228:231], v[32:47]
    ds_read_b64_tr_b16 v[220:221], v203 offset:18432
    ds_read_b64_tr_b16 v[222:223], v203 offset:18944
    v_rcp_f32 v176, v176
    v_rcp_f32 v177, v177
    v_mfma_f32_32x32x16_bf16 v[48:63], a[212:215], v[228:231], v[48:63]
    v_mul_f32 v178, v178, v176
    v_mul_f32 v179, v179, v177
    s_waitcnt lgkmcnt(4)
    v_mfma_f32_32x32x16_bf16 v[32:47], a[72:75], v[208:211], v[32:47]
    ds_read_b64_tr_b16 v[224:225], v203 offset:20480
    ds_read_b64_tr_b16 v[226:227], v203 offset:20992
    v_cvt_pk_bf16_f32 v192, v178, v179
    v_mul_f32 v180, v98, v98
    v_mfma_f32_32x32x16_bf16 v[48:63], a[216:219], v[208:211], v[48:63]
    v_mul_f32 v181, v99, v99
    v_fmaak_f32 v180, v180, v207, 0xc0135761
    v_fmaak_f32 v181, v181, v207, 0xc0135761
    v_mfma_f32_32x32x16_bf16 v[32:47], a[76:79], v[212:215], v[32:47]
    ds_read_b64_tr_b16 v[228:229], v203 offset:22528
    ds_read_b64_tr_b16 v[230:231], v203 offset:23040
    v_mul_f32 v180, v180, v98
    v_mul_f32 v181, v181, v99
    v_mfma_f32_32x32x16_bf16 v[48:63], a[220:223], v[212:215], v[48:63]
    v_exp_f32 v180, v180
    v_mul_f32 v182, v98, v102
    s_waitcnt lgkmcnt(4)
    v_mfma_f32_32x32x16_bf16 v[32:47], a[80:83], v[216:219], v[32:47]
    v_exp_f32 v181, v181
    v_mul_f32 v183, v99, v103
    v_mfma_f32_32x32x16_bf16 v[48:63], a[224:227], v[216:219], v[48:63]
    v_add_f32 v180, 1.0, v180
    v_add_f32 v181, 1.0, v181
    v_rcp_f32 v180, v180
    v_mfma_f32_32x32x16_bf16 v[32:47], a[84:87], v[220:223], v[32:47]
    s_add_u32 s39, s38, s34
    s_add_u32 s38, s38, 49152
    s_cmp_eq_u32 s38, 147456
    s_cselect_b32 s38, 0, s38
    v_add_u32 v202, s38, v204
    v_add_u32 v203, s38, v205
    v_mfma_f32_32x32x16_bf16 v[48:63], a[228:231], v[220:223], v[48:63]
    v_rcp_f32 v181, v181
    s_waitcnt lgkmcnt(0)
    v_mfma_f32_32x32x16_bf16 v[32:47], a[88:91], v[224:227], v[32:47]
    s_waitcnt vmcnt(1) lgkmcnt(0)
    s_barrier
    ds_read_b64_tr_b16 v[208:209], v202 offset:0
    ds_read_b64_tr_b16 v[210:211], v202 offset:512
    ds_read_b64_tr_b16 v[212:213], v202 offset:2048
    ds_read_b64_tr_b16 v[214:215], v202 offset:2560
    v_mfma_f32_32x32x16_bf16 v[48:63], a[232:235], v[224:227], v[48:63]
    v_mul_f32 v182, v182, v180
    v_mul_f32 v183, v183, v181
    v_cvt_pk_bf16_f32 v193, v182, v183
    v_mfma_f32_32x32x16_bf16 v[32:47], a[92:95], v[228:231], v[32:47]
    ds_read_b64_tr_b16 v[216:217], v202 offset:4096
    ds_read_b64_tr_b16 v[218:219], v202 offset:4608
    ds_read_b64_tr_b16 v[220:221], v202 offset:6144
    ds_read_b64_tr_b16 v[222:223], v202 offset:6656
    v_mul_f32 v184, v104, v104
    v_mfma_f32_32x32x16_bf16 v[48:63], a[236:239], v[228:231], v[48:63]
    v_mul_f32 v185, v105, v105
    v_fmaak_f32 v184, v184, v207, 0xc0135761
    v_fmaak_f32 v185, v185, v207, 0xc0135761
    s_waitcnt lgkmcnt(4)
    v_mfma_f32_32x32x16_bf16 v[0:15], a[96:99], v[208:211], v[0:15]
    ds_read_b64_tr_b16 v[224:225], v202 offset:8192
    ds_read_b64_tr_b16 v[226:227], v202 offset:8704
    v_mul_f32 v184, v184, v104
    v_mul_f32 v185, v185, v105
    v_mfma_f32_32x32x16_bf16 v[16:31], a[240:243], v[208:211], v[16:31]
    v_exp_f32 v184, v184
    v_mul_f32 v186, v104, v108
    v_mfma_f32_32x32x16_bf16 v[0:15], a[100:103], v[212:215], v[0:15]
    ds_read_b64_tr_b16 v[228:229], v202 offset:10240
    ds_read_b64_tr_b16 v[230:231], v202 offset:10752
    v_exp_f32 v185, v185
    v_mfma_f32_32x32x16_bf16 v[16:31], a[244:247], v[212:215], v[16:31]
    v_mul_f32 v187, v105, v109
    v_add_f32 v184, 1.0, v184
    v_add_f32 v185, 1.0, v185
    s_waitcnt lgkmcnt(4)
    v_mfma_f32_32x32x16_bf16 v[0:15], a[104:107], v[216:219], v[0:15]
    ds_read_b64_tr_b16 v[208:209], v202 offset:12288
    ds_read_b64_tr_b16 v[210:211], v202 offset:12800
    v_rcp_f32 v184, v184
    v_mfma_f32_32x32x16_bf16 v[16:31], a[248:251], v[216:219], v[16:31]
    v_rcp_f32 v185, v185
    v_mul_f32 v186, v186, v184
    v_mfma_f32_32x32x16_bf16 v[0:15], a[108:111], v[220:223], v[0:15]
    ds_read_b64_tr_b16 v[212:213], v202 offset:14336
    ds_read_b64_tr_b16 v[214:215], v202 offset:14848
    v_mul_f32 v187, v187, v185
    v_cvt_pk_bf16_f32 v194, v186, v187
    v_mfma_f32_32x32x16_bf16 v[16:31], a[252:255], v[220:223], v[16:31]
    v_mul_f32 v188, v106, v106
    v_mul_f32 v189, v107, v107
    v_fmaak_f32 v188, v188, v207, 0xc0135761
    s_waitcnt lgkmcnt(4)
    v_mfma_f32_32x32x16_bf16 v[0:15], a[112:115], v[224:227], v[0:15]
    ds_read_b64_tr_b16 v[216:217], v202 offset:16384
    ds_read_b64_tr_b16 v[218:219], v202 offset:16896
    v_fmaak_f32 v189, v189, v207, 0xc0135761
    v_mul_f32 v188, v188, v106
    v_mfma_f32_32x32x16_bf16 v[16:31], v[144:147], v[224:227], v[16:31]
    v_mul_f32 v189, v189, v107
    v_exp_f32 v188, v188
    v_mfma_f32_32x32x16_bf16 v[0:15], a[116:119], v[228:231], v[0:15]
    ds_read_b64_tr_b16 v[220:221], v202 offset:18432
    ds_read_b64_tr_b16 v[222:223], v202 offset:18944
    v_mul_f32 v190, v106, v110
    v_exp_f32 v189, v189
    v_mfma_f32_32x32x16_bf16 v[16:31], v[148:151], v[228:231], v[16:31]
    v_mul_f32 v191, v107, v111
    v_add_f32 v188, 1.0, v188
    s_waitcnt lgkmcnt(4)
    v_mfma_f32_32x32x16_bf16 v[0:15], a[120:123], v[208:211], v[0:15]
    ds_read_b64_tr_b16 v[224:225], v202 offset:20480
    ds_read_b64_tr_b16 v[226:227], v202 offset:20992
    v_add_f32 v189, 1.0, v189
    v_rcp_f32 v188, v188
    v_mfma_f32_32x32x16_bf16 v[16:31], v[152:155], v[208:211], v[16:31]
    v_rcp_f32 v189, v189
    v_mfma_f32_32x32x16_bf16 v[0:15], a[124:127], v[212:215], v[0:15]
    ds_read_b64_tr_b16 v[228:229], v202 offset:22528
    ds_read_b64_tr_b16 v[230:231], v202 offset:23040
    v_mul_f32 v190, v190, v188
    v_mul_f32 v191, v191, v189
    v_cvt_pk_bf16_f32 v195, v190, v191
    v_mfma_f32_32x32x16_bf16 v[16:31], v[156:159], v[212:215], v[16:31]
    buffer_store_dwordx4 v[192:195], v206, s[20:23], s36 offen offset:1024 sc1
    s_waitcnt lgkmcnt(4)
    v_mfma_f32_32x32x16_bf16 v[0:15], a[128:131], v[216:219], v[0:15]
    ds_read_b64_tr_b16 v[208:209], v203 offset:0
    ds_read_b64_tr_b16 v[210:211], v203 offset:512
    v_mul_f32 v176, v112, v112
    v_mul_f32 v177, v113, v113
    v_mfma_f32_32x32x16_bf16 v[16:31], v[160:163], v[216:219], v[16:31]
    v_fmaak_f32 v176, v176, v207, 0xc0135761
    v_fmaak_f32 v177, v177, v207, 0xc0135761
    v_mul_f32 v176, v176, v112
    v_mul_f32 v177, v177, v113
    v_mfma_f32_32x32x16_bf16 v[0:15], a[132:135], v[220:223], v[0:15]
    ds_read_b64_tr_b16 v[212:213], v203 offset:2048
    ds_read_b64_tr_b16 v[214:215], v203 offset:2560
    v_exp_f32 v176, v176
    v_mfma_f32_32x32x16_bf16 v[16:31], v[164:167], v[220:223], v[16:31]
    v_mul_f32 v178, v112, v116
    v_exp_f32 v177, v177
    s_waitcnt lgkmcnt(4)
    v_mfma_f32_32x32x16_bf16 v[0:15], a[136:139], v[224:227], v[0:15]
    ds_read_b64_tr_b16 v[216:217], v203 offset:4096
    ds_read_b64_tr_b16 v[218:219], v203 offset:4608
    v_mul_f32 v179, v113, v117
    v_add_f32 v176, 1.0, v176
    v_mfma_f32_32x32x16_bf16 v[16:31], v[168:171], v[224:227], v[16:31]
    v_add_f32 v177, 1.0, v177
    v_rcp_f32 v176, v176
    v_mfma_f32_32x32x16_bf16 v[0:15], a[140:143], v[228:231], v[0:15]
    ds_read_b64_tr_b16 v[220:221], v203 offset:6144
    ds_read_b64_tr_b16 v[222:223], v203 offset:6656
    v_rcp_f32 v177, v177
    v_mfma_f32_32x32x16_bf16 v[16:31], v[172:175], v[228:231], v[16:31]
    v_mul_f32 v178, v178, v176
    v_mul_f32 v179, v179, v177
    v_cvt_pk_bf16_f32 v196, v178, v179
    s_waitcnt lgkmcnt(4)
    v_mfma_f32_32x32x16_bf16 v[32:47], a[96:99], v[208:211], v[32:47]
    ds_read_b64_tr_b16 v[224:225], v203 offset:8192
    ds_read_b64_tr_b16 v[226:227], v203 offset:8704
    v_mul_f32 v180, v114, v114
    v_mul_f32 v181, v115, v115
    v_mfma_f32_32x32x16_bf16 v[48:63], a[240:243], v[208:211], v[48:63]
    v_fmaak_f32 v180, v180, v207, 0xc0135761
    v_fmaak_f32 v181, v181, v207, 0xc0135761
    v_mul_f32 v180, v180, v114
    v_mfma_f32_32x32x16_bf16 v[32:47], a[100:103], v[212:215], v[32:47]
    ds_read_b64_tr_b16 v[228:229], v203 offset:10240
    ds_read_b64_tr_b16 v[230:231], v203 offset:10752
    v_mul_f32 v181, v181, v115
    v_mfma_f32_32x32x16_bf16 v[48:63], a[244:247], v[212:215], v[48:63]
    v_exp_f32 v180, v180
    v_mul_f32 v182, v114, v118
    s_waitcnt lgkmcnt(4)
    v_mfma_f32_32x32x16_bf16 v[32:47], a[104:107], v[216:219], v[32:47]
    ds_read_b64_tr_b16 v[208:209], v203 offset:12288
    ds_read_b64_tr_b16 v[210:211], v203 offset:12800
    v_exp_f32 v181, v181
    v_mul_f32 v183, v115, v119
    v_mfma_f32_32x32x16_bf16 v[48:63], a[248:251], v[216:219], v[48:63]
    v_add_f32 v180, 1.0, v180
    v_add_f32 v181, 1.0, v181
    v_mfma_f32_32x32x16_bf16 v[32:47], a[108:111], v[220:223], v[32:47]
    ds_read_b64_tr_b16 v[212:213], v203 offset:14336
    ds_read_b64_tr_b16 v[214:215], v203 offset:14848
    v_rcp_f32 v180, v180
    v_rcp_f32 v181, v181
    v_mfma_f32_32x32x16_bf16 v[48:63], a[252:255], v[220:223], v[48:63]
    v_mul_f32 v182, v182, v180
    v_mul_f32 v183, v183, v181
    s_waitcnt lgkmcnt(4)
    v_mfma_f32_32x32x16_bf16 v[32:47], a[112:115], v[224:227], v[32:47]
    ds_read_b64_tr_b16 v[216:217], v203 offset:16384
    ds_read_b64_tr_b16 v[218:219], v203 offset:16896
    v_cvt_pk_bf16_f32 v197, v182, v183
    v_mul_f32 v184, v120, v120
    v_mfma_f32_32x32x16_bf16 v[48:63], v[144:147], v[224:227], v[48:63]
    v_mul_f32 v185, v121, v121
    v_fmaak_f32 v184, v184, v207, 0xc0135761
    v_fmaak_f32 v185, v185, v207, 0xc0135761
    v_mfma_f32_32x32x16_bf16 v[32:47], a[116:119], v[228:231], v[32:47]
    ds_read_b64_tr_b16 v[220:221], v203 offset:18432
    ds_read_b64_tr_b16 v[222:223], v203 offset:18944
    v_mul_f32 v184, v184, v120
    v_mul_f32 v185, v185, v121
    v_mfma_f32_32x32x16_bf16 v[48:63], v[148:151], v[228:231], v[48:63]
    v_exp_f32 v184, v184
    v_mul_f32 v186, v120, v124
    s_waitcnt lgkmcnt(4)
    v_mfma_f32_32x32x16_bf16 v[32:47], a[120:123], v[208:211], v[32:47]
    ds_read_b64_tr_b16 v[224:225], v203 offset:20480
    ds_read_b64_tr_b16 v[226:227], v203 offset:20992
    v_exp_f32 v185, v185
    v_mfma_f32_32x32x16_bf16 v[48:63], v[152:155], v[208:211], v[48:63]
    v_mul_f32 v187, v121, v125
    v_add_f32 v184, 1.0, v184
    v_add_f32 v185, 1.0, v185
    v_mfma_f32_32x32x16_bf16 v[32:47], a[124:127], v[212:215], v[32:47]
    ds_read_b64_tr_b16 v[228:229], v203 offset:22528
    ds_read_b64_tr_b16 v[230:231], v203 offset:23040
    v_rcp_f32 v184, v184
    v_mfma_f32_32x32x16_bf16 v[48:63], v[156:159], v[212:215], v[48:63]
    v_rcp_f32 v185, v185
    v_mul_f32 v186, v186, v184
    s_waitcnt lgkmcnt(4)
    v_mfma_f32_32x32x16_bf16 v[32:47], a[128:131], v[216:219], v[32:47]
    v_mul_f32 v187, v187, v185
    v_cvt_pk_bf16_f32 v198, v186, v187
    v_mul_f32 v188, v122, v122
    v_mfma_f32_32x32x16_bf16 v[48:63], v[160:163], v[216:219], v[48:63]
    v_mul_f32 v189, v123, v123
    v_fmaak_f32 v188, v188, v207, 0xc0135761
    v_fmaak_f32 v189, v189, v207, 0xc0135761
    v_mfma_f32_32x32x16_bf16 v[32:47], a[132:135], v[220:223], v[32:47]
    v_mul_f32 v188, v188, v122
    v_mul_f32 v189, v189, v123
    v_exp_f32 v188, v188
    v_mfma_f32_32x32x16_bf16 v[48:63], v[164:167], v[220:223], v[48:63]
    v_mul_f32 v190, v122, v126
    v_exp_f32 v189, v189
    s_waitcnt lgkmcnt(0)
    v_mfma_f32_32x32x16_bf16 v[32:47], a[136:139], v[224:227], v[32:47]
    v_mul_f32 v191, v123, v127
    v_add_f32 v188, 1.0, v188
    v_mfma_f32_32x32x16_bf16 v[48:63], v[168:171], v[224:227], v[48:63]
    v_add_f32 v189, 1.0, v189
    v_rcp_f32 v188, v188
    v_mfma_f32_32x32x16_bf16 v[32:47], a[140:143], v[228:231], v[32:47]
    v_rcp_f32 v189, v189
    v_mul_f32 v190, v190, v188
    v_mul_f32 v191, v191, v189
    v_mfma_f32_32x32x16_bf16 v[48:63], v[172:175], v[228:231], v[48:63]
    v_cvt_pk_bf16_f32 v199, v190, v191
    buffer_store_dwordx4 v[196:199], v206, s[20:23], s37 offen offset:1024 sc1
    v_and_b32 v132, 7, v241
    v_bfe_u32 v133, v241, 4, 1
    v_lshlrev_b32 v133, 3, v133
    v_add_u32 v132, v132, v133
    v_bfe_u32 v133, v241, 3, 1
    v_lshlrev_b32 v133, 6, v133
    v_add_u32 v132, v132, v133
    s_lshl_b32 s55, s5, 5
    v_add_u32 v132, s55, v132
    v_mul_u32_u24 v132, 272, v132
    v_lshrrev_b32 v133, 5, v241
    v_lshlrev_b32 v133, 3, v133
    v_add_u32 v132, v132, v133
    s_lshl_b32 s55, s4, 7
    v_add_u32 v132, s55, v132
    v_lshrrev_b32 v133, 4, v241
    s_lshl_b32 s55, s3, 5
    v_add_u32 v133, s55, v133
    v_and_b32 v135, 15, v241
    v_lshlrev_b32 v135, 4, v135
    v_mul_u32_u24 v134, 272, v133
    v_add_u32 v134, v134, v135
    v_lshlrev_b32 v133, 12, v133
    v_add_u32 v133, v133, v135
    s_lshl_b32 s54, s42, 19
    s_lshl_b32 s55, s6, 8
    s_add_u32 s54, s54, s55
    s_add_u32 s54, s54, 19660800
    v_cvt_pk_bf16_f32 v176, v0, v1
    v_cvt_pk_bf16_f32 v177, v2, v3
    ds_write_b64 v132, v[176:177] offset:0
    v_cvt_pk_bf16_f32 v178, v4, v5
    v_cvt_pk_bf16_f32 v179, v6, v7
    ds_write_b64 v132, v[178:179] offset:16
    v_cvt_pk_bf16_f32 v180, v8, v9
    v_cvt_pk_bf16_f32 v181, v10, v11
    ds_write_b64 v132, v[180:181] offset:32
    v_cvt_pk_bf16_f32 v182, v12, v13
    v_cvt_pk_bf16_f32 v183, v14, v15
    ds_write_b64 v132, v[182:183] offset:48
    v_cvt_pk_bf16_f32 v184, v16, v17
    v_cvt_pk_bf16_f32 v185, v18, v19
    ds_write_b64 v132, v[184:185] offset:64
    v_cvt_pk_bf16_f32 v186, v20, v21
    v_cvt_pk_bf16_f32 v187, v22, v23
    ds_write_b64 v132, v[186:187] offset:80
    v_cvt_pk_bf16_f32 v188, v24, v25
    v_cvt_pk_bf16_f32 v189, v26, v27
    ds_write_b64 v132, v[188:189] offset:96
    v_cvt_pk_bf16_f32 v190, v28, v29
    v_cvt_pk_bf16_f32 v191, v30, v31
    ds_write_b64 v132, v[190:191] offset:112
    v_cvt_pk_bf16_f32 v176, v32, v33
    v_cvt_pk_bf16_f32 v177, v34, v35
    ds_write_b64 v132, v[176:177] offset:4352
    v_cvt_pk_bf16_f32 v178, v36, v37
    v_cvt_pk_bf16_f32 v179, v38, v39
    ds_write_b64 v132, v[178:179] offset:4368
    v_cvt_pk_bf16_f32 v180, v40, v41
    v_cvt_pk_bf16_f32 v181, v42, v43
    ds_write_b64 v132, v[180:181] offset:4384
    v_cvt_pk_bf16_f32 v182, v44, v45
    v_cvt_pk_bf16_f32 v183, v46, v47
    ds_write_b64 v132, v[182:183] offset:4400
    v_cvt_pk_bf16_f32 v184, v48, v49
    v_cvt_pk_bf16_f32 v185, v50, v51
    ds_write_b64 v132, v[184:185] offset:4416
    v_cvt_pk_bf16_f32 v186, v52, v53
    v_cvt_pk_bf16_f32 v187, v54, v55
    ds_write_b64 v132, v[186:187] offset:4432
    v_cvt_pk_bf16_f32 v188, v56, v57
    v_cvt_pk_bf16_f32 v189, v58, v59
    ds_write_b64 v132, v[188:189] offset:4448
    v_cvt_pk_bf16_f32 v190, v60, v61
    v_cvt_pk_bf16_f32 v191, v62, v63
    ds_write_b64 v132, v[190:191] offset:4464
    s_waitcnt lgkmcnt(0)
    s_barrier
    ds_read_b128 v[64:67], v134 offset:0
    ds_read_b128 v[68:71], v134 offset:1088
    ds_read_b128 v[72:75], v134 offset:2176
    ds_read_b128 v[76:79], v134 offset:3264
    ds_read_b128 v[80:83], v134 offset:4352
    ds_read_b128 v[84:87], v134 offset:5440
    ds_read_b128 v[88:91], v134 offset:6528
    ds_read_b128 v[92:95], v134 offset:7616
    s_waitcnt lgkmcnt(7)
    buffer_store_dwordx4 v[64:67], v133, s[20:23], s54 offen sc1
    s_add_u32 s54, s54, 16384
    s_waitcnt lgkmcnt(6)
    buffer_store_dwordx4 v[68:71], v133, s[20:23], s54 offen sc1
    s_add_u32 s54, s54, 16384
    s_waitcnt lgkmcnt(5)
    buffer_store_dwordx4 v[72:75], v133, s[20:23], s54 offen sc1
    s_add_u32 s54, s54, 16384
    s_waitcnt lgkmcnt(4)
    buffer_store_dwordx4 v[76:79], v133, s[20:23], s54 offen sc1
    s_add_u32 s54, s54, 16384
    s_waitcnt lgkmcnt(3)
    buffer_store_dwordx4 v[80:83], v133, s[20:23], s54 offen sc1
    s_add_u32 s54, s54, 16384
    s_waitcnt lgkmcnt(2)
    buffer_store_dwordx4 v[84:87], v133, s[20:23], s54 offen sc1
    s_add_u32 s54, s54, 16384
    s_waitcnt lgkmcnt(1)
    buffer_store_dwordx4 v[88:91], v133, s[20:23], s54 offen sc1
    s_add_u32 s54, s54, 16384
    s_waitcnt lgkmcnt(0)
    buffer_store_dwordx4 v[92:95], v133, s[20:23], s54 offen sc1
    s_branch gated_mix__spectral_gfnet__glu_gated_geglu__prompt_kernel_fin
gated_mix__spectral_gfnet__glu_gated_geglu__prompt_kernel_spare:
    s_nop 3
    s_mul_i32 s63, s6, 3
    s_add_u32 s63, s63, s42
    s_sub_u32 s63, s63, 5
    s_waitcnt vmcnt(1) lgkmcnt(0)
    s_barrier
    s_cmp_ge_u32 s63, 32
    s_cselect_b32 s90, 0, s90
    s_cselect_b32 s94, 0, s94
    s_mul_i32 s54, s63, 36992
    s_lshl_b32 s55, s3, 10
    s_add_u32 s54, s54, s55
    v_mul_f32 v176, v64, v64
    v_mul_f32 v177, v65, v65
    v_fmaak_f32 v176, v176, v207, 0xc0135761
    v_fmaak_f32 v177, v177, v207, 0xc0135761
    v_mul_f32 v176, v176, v64
    v_mul_f32 v177, v177, v65
    v_exp_f32 v176, v176
    v_mul_f32 v178, v64, v68
    v_exp_f32 v177, v177
    v_mul_f32 v179, v65, v69
    v_add_f32 v176, 1.0, v176
    s_add_u32 m0, s55, 0
    s_nop 0
    buffer_load_dwordx4 v206, s[88:91], s54 offen lds
    v_add_f32 v177, 1.0, v177
    v_rcp_f32 v176, v176
    v_rcp_f32 v177, v177
    v_mul_f32 v178, v178, v176
    v_mul_f32 v179, v179, v177
    v_cvt_pk_bf16_f32 v192, v178, v179
    v_mul_f32 v180, v66, v66
    v_mul_f32 v181, v67, v67
    v_fmaak_f32 v180, v180, v207, 0xc0135761
    v_fmaak_f32 v181, v181, v207, 0xc0135761
    s_add_u32 m0, s55, 40960
    s_nop 0
    buffer_load_dwordx4 v206, s[92:95], s54 offen lds
    s_add_u32 s54, s54, 4096
    v_mul_f32 v180, v180, v66
    v_mul_f32 v181, v181, v67
    v_exp_f32 v180, v180
    v_mul_f32 v182, v66, v70
    v_exp_f32 v181, v181
    v_mul_f32 v183, v67, v71
    v_add_f32 v180, 1.0, v180
    v_add_f32 v181, 1.0, v181
    v_rcp_f32 v180, v180
    v_rcp_f32 v181, v181
    v_mul_f32 v182, v182, v180
    s_add_u32 m0, s55, 4096
    s_nop 0
    buffer_load_dwordx4 v206, s[88:91], s54 offen lds
    v_mul_f32 v183, v183, v181
    v_cvt_pk_bf16_f32 v193, v182, v183
    v_mul_f32 v184, v72, v72
    v_mul_f32 v185, v73, v73
    v_fmaak_f32 v184, v184, v207, 0xc0135761
    v_fmaak_f32 v185, v185, v207, 0xc0135761
    v_mul_f32 v184, v184, v72
    v_mul_f32 v185, v185, v73
    v_exp_f32 v184, v184
    v_mul_f32 v186, v72, v76
    s_add_u32 m0, s55, 45056
    s_nop 0
    buffer_load_dwordx4 v206, s[92:95], s54 offen lds
    s_add_u32 s54, s54, 4096
    v_exp_f32 v185, v185
    v_mul_f32 v187, v73, v77
    v_add_f32 v184, 1.0, v184
    v_add_f32 v185, 1.0, v185
    v_rcp_f32 v184, v184
    v_rcp_f32 v185, v185
    v_mul_f32 v186, v186, v184
    v_mul_f32 v187, v187, v185
    v_cvt_pk_bf16_f32 v194, v186, v187
    v_mul_f32 v188, v74, v74
    s_add_u32 m0, s55, 8192
    s_nop 0
    buffer_load_dwordx4 v206, s[88:91], s54 offen lds
    v_mul_f32 v189, v75, v75
    v_fmaak_f32 v188, v188, v207, 0xc0135761
    v_fmaak_f32 v189, v189, v207, 0xc0135761
    v_mul_f32 v188, v188, v74
    v_mul_f32 v189, v189, v75
    v_exp_f32 v188, v188
    v_mul_f32 v190, v74, v78
    v_exp_f32 v189, v189
    v_mul_f32 v191, v75, v79
    v_add_f32 v188, 1.0, v188
    v_add_f32 v189, 1.0, v189
    s_add_u32 m0, s55, 49152
    s_nop 0
    buffer_load_dwordx4 v206, s[92:95], s54 offen lds
    s_add_u32 s54, s54, 4096
    v_rcp_f32 v188, v188
    v_rcp_f32 v189, v189
    v_mul_f32 v190, v190, v188
    v_mul_f32 v191, v191, v189
    v_cvt_pk_bf16_f32 v195, v190, v191
    buffer_store_dwordx4 v[192:195], v206, s[20:23], s36 offen offset:0 sc1
    v_mul_f32 v176, v80, v80
    v_mul_f32 v177, v81, v81
    v_fmaak_f32 v176, v176, v207, 0xc0135761
    v_fmaak_f32 v177, v177, v207, 0xc0135761
    s_add_u32 m0, s55, 12288
    s_nop 0
    buffer_load_dwordx4 v206, s[88:91], s54 offen lds
    v_mul_f32 v176, v176, v80
    v_mul_f32 v177, v177, v81
    v_exp_f32 v176, v176
    v_mul_f32 v178, v80, v84
    v_exp_f32 v177, v177
    v_mul_f32 v179, v81, v85
    v_add_f32 v176, 1.0, v176
    v_add_f32 v177, 1.0, v177
    v_rcp_f32 v176, v176
    v_rcp_f32 v177, v177
    s_add_u32 m0, s55, 53248
    s_nop 0
    buffer_load_dwordx4 v206, s[92:95], s54 offen lds
    s_add_u32 s54, s54, 4096
    v_mul_f32 v178, v178, v176
    v_mul_f32 v179, v179, v177
    v_cvt_pk_bf16_f32 v196, v178, v179
    v_mul_f32 v180, v82, v82
    v_mul_f32 v181, v83, v83
    v_fmaak_f32 v180, v180, v207, 0xc0135761
    v_fmaak_f32 v181, v181, v207, 0xc0135761
    v_mul_f32 v180, v180, v82
    v_mul_f32 v181, v181, v83
    v_exp_f32 v180, v180
    v_mul_f32 v182, v82, v86
    s_add_u32 m0, s55, 16384
    s_nop 0
    buffer_load_dwordx4 v206, s[88:91], s54 offen lds
    v_exp_f32 v181, v181
    v_mul_f32 v183, v83, v87
    v_add_f32 v180, 1.0, v180
    v_add_f32 v181, 1.0, v181
    v_rcp_f32 v180, v180
    v_rcp_f32 v181, v181
    v_mul_f32 v182, v182, v180
    v_mul_f32 v183, v183, v181
    v_cvt_pk_bf16_f32 v197, v182, v183
    v_mul_f32 v184, v88, v88
    s_add_u32 m0, s55, 57344
    s_nop 0
    buffer_load_dwordx4 v206, s[92:95], s54 offen lds
    s_add_u32 s54, s54, 4096
    v_mul_f32 v185, v89, v89
    v_fmaak_f32 v184, v184, v207, 0xc0135761
    v_fmaak_f32 v185, v185, v207, 0xc0135761
    v_mul_f32 v184, v184, v88
    v_mul_f32 v185, v185, v89
    v_exp_f32 v184, v184
    v_mul_f32 v186, v88, v92
    v_exp_f32 v185, v185
    v_mul_f32 v187, v89, v93
    v_add_f32 v184, 1.0, v184
    s_add_u32 m0, s55, 20480
    s_nop 0
    buffer_load_dwordx4 v206, s[88:91], s54 offen lds
    v_add_f32 v185, 1.0, v185
    v_rcp_f32 v184, v184
    v_rcp_f32 v185, v185
    v_mul_f32 v186, v186, v184
    v_mul_f32 v187, v187, v185
    v_cvt_pk_bf16_f32 v198, v186, v187
    v_mul_f32 v188, v90, v90
    v_mul_f32 v189, v91, v91
    v_fmaak_f32 v188, v188, v207, 0xc0135761
    v_fmaak_f32 v189, v189, v207, 0xc0135761
    v_mul_f32 v188, v188, v90
    s_add_u32 m0, s55, 61440
    s_nop 0
    buffer_load_dwordx4 v206, s[92:95], s54 offen lds
    s_add_u32 s54, s54, 4096
    v_mul_f32 v189, v189, v91
    v_exp_f32 v188, v188
    v_mul_f32 v190, v90, v94
    v_exp_f32 v189, v189
    v_mul_f32 v191, v91, v95
    v_add_f32 v188, 1.0, v188
    v_add_f32 v189, 1.0, v189
    v_rcp_f32 v188, v188
    v_rcp_f32 v189, v189
    v_mul_f32 v190, v190, v188
    s_add_u32 m0, s55, 24576
    s_nop 0
    buffer_load_dwordx4 v206, s[88:91], s54 offen lds
    v_mul_f32 v191, v191, v189
    v_cvt_pk_bf16_f32 v199, v190, v191
    buffer_store_dwordx4 v[196:199], v206, s[20:23], s37 offen offset:0 sc1
    v_mul_f32 v176, v96, v96
    v_mul_f32 v177, v97, v97
    v_fmaak_f32 v176, v176, v207, 0xc0135761
    v_fmaak_f32 v177, v177, v207, 0xc0135761
    v_mul_f32 v176, v176, v96
    v_mul_f32 v177, v177, v97
    v_exp_f32 v176, v176
    s_add_u32 m0, s55, 65536
    s_nop 0
    buffer_load_dwordx4 v206, s[92:95], s54 offen lds
    s_add_u32 s54, s54, 4096
    v_mul_f32 v178, v96, v100
    v_exp_f32 v177, v177
    v_mul_f32 v179, v97, v101
    v_add_f32 v176, 1.0, v176
    v_add_f32 v177, 1.0, v177
    v_rcp_f32 v176, v176
    v_rcp_f32 v177, v177
    v_mul_f32 v178, v178, v176
    v_mul_f32 v179, v179, v177
    v_cvt_pk_bf16_f32 v192, v178, v179
    v_mul_f32 v180, v98, v98
    s_add_u32 m0, s55, 28672
    s_nop 0
    buffer_load_dwordx4 v206, s[88:91], s54 offen lds
    v_mul_f32 v181, v99, v99
    v_fmaak_f32 v180, v180, v207, 0xc0135761
    v_fmaak_f32 v181, v181, v207, 0xc0135761
    v_mul_f32 v180, v180, v98
    v_mul_f32 v181, v181, v99
    v_exp_f32 v180, v180
    v_mul_f32 v182, v98, v102
    v_exp_f32 v181, v181
    v_mul_f32 v183, v99, v103
    v_add_f32 v180, 1.0, v180
    s_add_u32 m0, s55, 69632
    s_nop 0
    buffer_load_dwordx4 v206, s[92:95], s54 offen lds
    s_add_u32 s54, s54, 4096
    v_add_f32 v181, 1.0, v181
    v_rcp_f32 v180, v180
    v_rcp_f32 v181, v181
    v_mul_f32 v182, v182, v180
    v_mul_f32 v183, v183, v181
    v_cvt_pk_bf16_f32 v193, v182, v183
    v_mul_f32 v184, v104, v104
    v_mul_f32 v185, v105, v105
    v_fmaak_f32 v184, v184, v207, 0xc0135761
    v_fmaak_f32 v185, v185, v207, 0xc0135761
    s_add_u32 m0, s55, 32768
    s_nop 0
    buffer_load_dwordx4 v206, s[88:91], s54 offen lds
    v_mul_f32 v184, v184, v104
    v_mul_f32 v185, v185, v105
    v_exp_f32 v184, v184
    v_mul_f32 v186, v104, v108
    v_exp_f32 v185, v185
    v_mul_f32 v187, v105, v109
    v_add_f32 v184, 1.0, v184
    v_add_f32 v185, 1.0, v185
    v_rcp_f32 v184, v184
    v_rcp_f32 v185, v185
    v_mul_f32 v186, v186, v184
    s_add_u32 m0, s55, 73728
    s_nop 0
    buffer_load_dwordx4 v206, s[92:95], s54 offen lds
    s_add_u32 s54, s54, 4096
    v_mul_f32 v187, v187, v185
    v_cvt_pk_bf16_f32 v194, v186, v187
    v_mul_f32 v188, v106, v106
    v_mul_f32 v189, v107, v107
    v_fmaak_f32 v188, v188, v207, 0xc0135761
    v_fmaak_f32 v189, v189, v207, 0xc0135761
    v_mul_f32 v188, v188, v106
    v_mul_f32 v189, v189, v107
    v_exp_f32 v188, v188
    v_mul_f32 v190, v106, v110
    s_add_u32 m0, s55, 36864
    s_nop 0
    buffer_load_dwordx4 v206, s[88:91], s54 offen lds
    v_exp_f32 v189, v189
    v_mul_f32 v191, v107, v111
    v_add_f32 v188, 1.0, v188
    v_add_f32 v189, 1.0, v189
    v_rcp_f32 v188, v188
    v_rcp_f32 v189, v189
    v_mul_f32 v190, v190, v188
    v_mul_f32 v191, v191, v189
    v_cvt_pk_bf16_f32 v195, v190, v191
    buffer_store_dwordx4 v[192:195], v206, s[20:23], s36 offen offset:1024 sc1
    s_add_u32 m0, s55, 77824
    s_nop 0
    buffer_load_dwordx4 v206, s[92:95], s54 offen lds
    s_add_u32 s54, s54, 4096
    v_mul_f32 v176, v112, v112
    v_mul_f32 v177, v113, v113
    v_fmaak_f32 v176, v176, v207, 0xc0135761
    v_fmaak_f32 v177, v177, v207, 0xc0135761
    v_mul_f32 v176, v176, v112
    v_mul_f32 v177, v177, v113
    v_exp_f32 v176, v176
    v_mul_f32 v178, v112, v116
    v_exp_f32 v177, v177
    v_mul_f32 v179, v113, v117
    v_add_f32 v176, 1.0, v176
    v_add_f32 v177, 1.0, v177
    v_rcp_f32 v176, v176
    v_rcp_f32 v177, v177
    v_mul_f32 v178, v178, v176
    v_mul_f32 v179, v179, v177
    v_cvt_pk_bf16_f32 v196, v178, v179
    v_mul_f32 v180, v114, v114
    v_mul_f32 v181, v115, v115
    v_fmaak_f32 v180, v180, v207, 0xc0135761
    v_fmaak_f32 v181, v181, v207, 0xc0135761
    v_mul_f32 v180, v180, v114
    v_mul_f32 v181, v181, v115
    v_exp_f32 v180, v180
    v_mul_f32 v182, v114, v118
    v_exp_f32 v181, v181
    v_mul_f32 v183, v115, v119
    v_add_f32 v180, 1.0, v180
    v_add_f32 v181, 1.0, v181
    v_rcp_f32 v180, v180
    v_rcp_f32 v181, v181
    v_mul_f32 v182, v182, v180
    v_mul_f32 v183, v183, v181
    v_cvt_pk_bf16_f32 v197, v182, v183
    v_mul_f32 v184, v120, v120
    v_mul_f32 v185, v121, v121
    v_fmaak_f32 v184, v184, v207, 0xc0135761
    v_fmaak_f32 v185, v185, v207, 0xc0135761
    v_mul_f32 v184, v184, v120
    v_mul_f32 v185, v185, v121
    v_exp_f32 v184, v184
    v_mul_f32 v186, v120, v124
    v_exp_f32 v185, v185
    v_mul_f32 v187, v121, v125
    v_add_f32 v184, 1.0, v184
    v_add_f32 v185, 1.0, v185
    v_rcp_f32 v184, v184
    v_rcp_f32 v185, v185
    v_mul_f32 v186, v186, v184
    v_mul_f32 v187, v187, v185
    v_cvt_pk_bf16_f32 v198, v186, v187
    v_mul_f32 v188, v122, v122
    v_mul_f32 v189, v123, v123
    v_fmaak_f32 v188, v188, v207, 0xc0135761
    v_fmaak_f32 v189, v189, v207, 0xc0135761
    v_mul_f32 v188, v188, v122
    v_mul_f32 v189, v189, v123
    v_exp_f32 v188, v188
    v_mul_f32 v190, v122, v126
    v_exp_f32 v189, v189
    v_mul_f32 v191, v123, v127
    v_add_f32 v188, 1.0, v188
    v_add_f32 v189, 1.0, v189
    v_rcp_f32 v188, v188
    v_rcp_f32 v189, v189
    v_mul_f32 v190, v190, v188
    v_mul_f32 v191, v191, v189
    v_cvt_pk_bf16_f32 v199, v190, v191
    buffer_store_dwordx4 v[196:199], v206, s[20:23], s37 offen offset:1024 sc1
    s_cmp_ge_u32 s63, 12
    s_cbranch_scc1 gated_mix__spectral_gfnet__glu_gated_geglu__prompt_kernel_j3
    v_and_b32 v3, 15, v241
    v_lshrrev_b32 v2, 4, v241
    s_lshl_b32 s54, s3, 4
    s_mul_i32 s56, s3, 12
    s_add_u32 s56, s56, s63
    s_lshl_b32 s56, s56, 10
    s_add_u32 s56, s56, 24707072
    s_and_b32 s57, s63, 1
    s_cmp_ge_u32 s63, 8
    s_cbranch_scc1 gated_mix__spectral_gfnet__glu_gated_geglu__prompt_kernel_j4tw
    s_cmp_ge_u32 s63, 4
    s_cbranch_scc1 gated_mix__spectral_gfnet__glu_gated_geglu__prompt_kernel_j4f32
    v_add_u32 v0, s54, v3
    s_lshl_b32 s55, s57, 5
    v_lshlrev_b32 v1, 3, v2
    v_add_u32 v1, s55, v1
    s_mov_b32 s58, 4
    s_mov_b32 s59, 0x3c800000
    s_branch gated_mix__spectral_gfnet__glu_gated_geglu__prompt_kernel_j4m
gated_mix__spectral_gfnet__glu_gated_geglu__prompt_kernel_j4f32:
    s_lshl_b32 s55, s57, 4
    v_add_u32 v0, s55, v3
    v_lshlrev_b32 v1, 2, v2
    s_mov_b32 s58, 16
    s_mov_b32 s59, 0x3d000000
gated_mix__spectral_gfnet__glu_gated_geglu__prompt_kernel_j4m:
    s_bitcmp1_b32 s63, 1
    s_cselect_b32 s55, 0xbe800000, 0
    v_mov_b32 v4, s55
    v_mov_b32 v5, s59
    v_mov_b32 v6, s58
    v_add_u32 v10, 0, v1
    v_mul_u32_u24 v10, v10, v0
    v_cvt_f32_u32 v10, v10
    v_fma_f32 v10, v10, v5, v4
    v_fract_f32 v10, v10
    v_cos_f32 v8, v10
    s_nop 0
    v_add_u32 v10, 1, v1
    v_mul_u32_u24 v10, v10, v0
    v_cvt_f32_u32 v10, v10
    v_fma_f32 v10, v10, v5, v4
    v_fract_f32 v10, v10
    v_cos_f32 v9, v10
    s_nop 0
    v_cvt_pk_bf16_f32 v16, v8, v9
    v_add_u32 v10, 2, v1
    v_mul_u32_u24 v10, v10, v0
    v_cvt_f32_u32 v10, v10
    v_fma_f32 v10, v10, v5, v4
    v_fract_f32 v10, v10
    v_cos_f32 v8, v10
    s_nop 0
    v_add_u32 v10, 3, v1
    v_mul_u32_u24 v10, v10, v0
    v_cvt_f32_u32 v10, v10
    v_fma_f32 v10, v10, v5, v4
    v_fract_f32 v10, v10
    v_cos_f32 v9, v10
    s_nop 0
    v_cvt_pk_bf16_f32 v17, v8, v9
    v_add_u32 v10, 0, v1
    v_add_u32 v10, v10, v6
    v_mul_u32_u24 v10, v10, v0
    v_cvt_f32_u32 v10, v10
    v_fma_f32 v10, v10, v5, v4
    v_fract_f32 v10, v10
    v_cos_f32 v8, v10
    s_nop 0
    v_add_u32 v10, 1, v1
    v_add_u32 v10, v10, v6
    v_mul_u32_u24 v10, v10, v0
    v_cvt_f32_u32 v10, v10
    v_fma_f32 v10, v10, v5, v4
    v_fract_f32 v10, v10
    v_cos_f32 v9, v10
    s_nop 0
    v_cvt_pk_bf16_f32 v18, v8, v9
    v_add_u32 v10, 2, v1
    v_add_u32 v10, v10, v6
    v_mul_u32_u24 v10, v10, v0
    v_cvt_f32_u32 v10, v10
    v_fma_f32 v10, v10, v5, v4
    v_fract_f32 v10, v10
    v_cos_f32 v8, v10
    s_nop 0
    v_add_u32 v10, 3, v1
    v_add_u32 v10, v10, v6
    v_mul_u32_u24 v10, v10, v0
    v_cvt_f32_u32 v10, v10
    v_fma_f32 v10, v10, v5, v4
    v_fract_f32 v10, v10
    v_cos_f32 v9, v10
    s_nop 0
    v_cvt_pk_bf16_f32 v19, v8, v9
    s_branch gated_mix__spectral_gfnet__glu_gated_geglu__prompt_kernel_j4st
gated_mix__spectral_gfnet__glu_gated_geglu__prompt_kernel_j4tw:
    s_lshl_b32 s55, s57, 4
    s_cmp_ge_u32 s63, 10
    s_cselect_b32 s58, s55, s54
    s_cselect_b32 s59, s54, s55
    v_add_u32 v0, s58, v3
    v_lshlrev_b32 v1, 2, v2
    v_add_u32 v1, s59, v1
    v_add_u32 v10, 0, v1
    v_mul_u32_u24 v10, v10, v0
    v_cvt_f32_u32 v10, v10
    v_mul_f32 v10, 0x3a000000, v10
    v_fract_f32 v10, v10
    v_cos_f32 v8, v10
    v_sin_f32 v9, v10
    s_nop 0
    v_cvt_pk_f16_f32 v16, v8, v9
    v_add_u32 v10, 1, v1
    v_mul_u32_u24 v10, v10, v0
    v_cvt_f32_u32 v10, v10
    v_mul_f32 v10, 0x3a000000, v10
    v_fract_f32 v10, v10
    v_cos_f32 v8, v10
    v_sin_f32 v9, v10
    s_nop 0
    v_cvt_pk_f16_f32 v17, v8, v9
    v_add_u32 v10, 2, v1
    v_mul_u32_u24 v10, v10, v0
    v_cvt_f32_u32 v10, v10
    v_mul_f32 v10, 0x3a000000, v10
    v_fract_f32 v10, v10
    v_cos_f32 v8, v10
    v_sin_f32 v9, v10
    s_nop 0
    v_cvt_pk_f16_f32 v18, v8, v9
    v_add_u32 v10, 3, v1
    v_mul_u32_u24 v10, v10, v0
    v_cvt_f32_u32 v10, v10
    v_mul_f32 v10, 0x3a000000, v10
    v_fract_f32 v10, v10
    v_cos_f32 v8, v10
    v_sin_f32 v9, v10
    s_nop 0
    v_cvt_pk_f16_f32 v19, v8, v9
gated_mix__spectral_gfnet__glu_gated_geglu__prompt_kernel_j4st:
    buffer_store_dwordx4 v[16:19], v206, s[20:23], s56 offen sc1
gated_mix__spectral_gfnet__glu_gated_geglu__prompt_kernel_j3:
    s_cmp_ge_u32 s63, 32
    s_cbranch_scc1 gated_mix__spectral_gfnet__glu_gated_geglu__prompt_kernel_j3e
    s_waitcnt vmcnt(2)
    s_barrier
    v_and_b32 v3, 15, v241
    v_mul_u32_u24 v0, 2312, v3
    v_lshrrev_b32 v4, 4, v241
    s_lshl_b32 s54, s3, 2
    v_add_u32 v4, s54, v4
    v_lshl_add_u32 v0, v4, 1, v0
    v_add_u32 v1, 40960, v0
    v_lshlrev_b32 v2, 4, v3
    v_lshl_add_u32 v2, v4, 13, v2
    s_lshl_b32 s55, s63, 8
    s_add_u32 s55, s55, 22282240
    s_mov_b32 s56, 0
    ds_read_u16 v8, v0 offset:0
    ds_read_u16 v9, v1 offset:0
    ds_read_u16 v10, v0 offset:578
    ds_read_u16 v11, v1 offset:578
    ds_read_u16 v12, v0 offset:1156
    ds_read_u16 v13, v1 offset:1156
    ds_read_u16 v14, v0 offset:1734
    ds_read_u16 v15, v1 offset:1734
    v_add_u32 v0, 32, v0
    v_add_u32 v1, 32, v1
gated_mix__spectral_gfnet__glu_gated_geglu__prompt_kernel_j3l:
    ds_read_u16 v16, v0 offset:0
    ds_read_u16 v17, v1 offset:0
    ds_read_u16 v18, v0 offset:578
    ds_read_u16 v19, v1 offset:578
    ds_read_u16 v20, v0 offset:1156
    ds_read_u16 v21, v1 offset:1156
    ds_read_u16 v22, v0 offset:1734
    ds_read_u16 v23, v1 offset:1734
    v_add_u32 v0, 32, v0
    v_add_u32 v1, 32, v1
    s_waitcnt lgkmcnt(8)
    v_lshl_or_b32 v40, v9, 16, v8
    v_lshl_or_b32 v41, v11, 16, v10
    v_lshl_or_b32 v42, v13, 16, v12
    v_lshl_or_b32 v43, v15, 16, v14
    buffer_store_dwordx4 v[40:43], v2, s[20:23], s55 offen sc1
    s_add_u32 s55, s55, 131072
    ds_read_u16 v8, v0 offset:0
    ds_read_u16 v9, v1 offset:0
    ds_read_u16 v10, v0 offset:578
    ds_read_u16 v11, v1 offset:578
    ds_read_u16 v12, v0 offset:1156
    ds_read_u16 v13, v1 offset:1156
    ds_read_u16 v14, v0 offset:1734
    ds_read_u16 v15, v1 offset:1734
    v_add_u32 v0, 32, v0
    v_add_u32 v1, 32, v1
    s_waitcnt lgkmcnt(8)
    v_lshl_or_b32 v44, v17, 16, v16
    v_lshl_or_b32 v45, v19, 16, v18
    v_lshl_or_b32 v46, v21, 16, v20
    v_lshl_or_b32 v47, v23, 16, v22
    buffer_store_dwordx4 v[44:47], v2, s[20:23], s55 offen sc1
    s_add_u32 s55, s55, 131072
    s_add_u32 s56, s56, 1
    s_cmp_lt_u32 s56, 9
    s_cbranch_scc1 gated_mix__spectral_gfnet__glu_gated_geglu__prompt_kernel_j3l
    v_mov_b32 v5, 0x40000000
    v_cmp_eq_u32 vcc, 0, v4
    s_waitcnt lgkmcnt(0)
    s_nop 0
    v_cndmask_b32 v5, v5, v2, vcc
    v_lshl_or_b32 v40, v9, 16, v8
    v_lshl_or_b32 v41, v11, 16, v10
    v_lshl_or_b32 v42, v13, 16, v12
    v_lshl_or_b32 v43, v15, 16, v14
    buffer_store_dwordx4 v[40:43], v5, s[20:23], s55 offen sc1
    s_add_u32 s55, s55, 131072
gated_mix__spectral_gfnet__glu_gated_geglu__prompt_kernel_j3e:
gated_mix__spectral_gfnet__glu_gated_geglu__prompt_kernel_fin:
    s_waitcnt vmcnt(0) lgkmcnt(0)
    s_mov_b32 s55, 0
gated_mix__spectral_gfnet__glu_gated_geglu__prompt_kernel_cspin:
    v_readfirstlane_b32 s54, v240
    s_add_u32 s55, s55, 1
    s_cmp_ge_u32 s54, 256
    s_cbranch_scc1 gated_mix__spectral_gfnet__glu_gated_geglu__prompt_kernel_cok
    s_cmp_ge_u32 s55, 0x40000
    s_cbranch_scc1 gated_mix__spectral_gfnet__glu_gated_geglu__prompt_kernel_cok
    buffer_load_dword v240, v243, s[24:27], 0 offen sc1
    s_waitcnt vmcnt(0)
    s_branch gated_mix__spectral_gfnet__glu_gated_geglu__prompt_kernel_cspin
gated_mix__spectral_gfnet__glu_gated_geglu__prompt_kernel_cok:
    s_barrier
    s_cmp_eq_u32 s3, 0
    s_cbranch_scc0 gated_mix__spectral_gfnet__glu_gated_geglu__prompt_kernel_fin2
    v_mov_b32 v1, 1
    s_mov_b64 s[60:61], exec
    s_mov_b64 exec, 0x3ff
    buffer_store_dword v1, v236, s[20:23], 0 offen sc1
    s_mov_b64 exec, s[60:61]
gated_mix__spectral_gfnet__glu_gated_geglu__prompt_kernel_fin2:
    v_mov_b32 v0, v242
    s_branch gm_l2_entry
gated_mix__spectral_gfnet__glu_gated_geglu__prompt_kernel_end:
    s_endpgm
gm_l2_entry:
    s_cmp_ge_u32 s2, 256
    s_cbranch_scc1 gm_l2_kernel_end
    s_lshr_b32 s4, s2, 3
    s_cmp_ge_u32 s4, 24
    s_cbranch_scc1 gm_l2_kernel_fft
gm_l2_kernel_gemm:
    s_load_dwordx2 s[64:65], s[0:1], 48
    s_load_dwordx2 s[66:67], s[0:1], 80
    s_load_dwordx2 s[68:69], s[0:1], 64
    v_and_b32 v192, 63, v0
    v_readfirstlane_b32 s3, v0
    v_lshlrev_b32 v184, 4, v192
    s_and_b32 s32, s2, 7
    s_mul_i32 s32, s32, 24
    s_lshr_b32 s33, s2, 3
    s_add_u32 s32, s32, s33
    s_lshr_b32 s3, s3, 6
    s_mul_hi_u32 s33, s32, 0x5555556
    s_mul_i32 s34, s33, 48
    s_sub_u32 s34, s32, s34
    s_mul_hi_u32 s35, s34, 0x55555556
    s_mul_i32 s36, s35, 3
    s_sub_u32 s36, s34, s36
    s_mov_b32 s5, s33
    s_mov_b32 s30, s35
    s_mov_b32 s31, s36
    s_mul_i32 s37, s33, 18
    s_lshl_b32 s4, s35, 2
    s_add_u32 s4, s4, s3
    s_mul_i32 s6, s4, 288
    s_lshl_b32 s38, s37, 2
    s_add_u32 s6, s6, s38
    s_lshl_b32 s6, s6, 10
    s_lshl_b32 s38, s33, 6
    s_add_u32 s38, s38, s4
    s_mul_i32 s38, s38, 18
    s_mul_i32 s39, s36, 6
    s_add_u32 s38, s38, s39
    s_lshl_b32 s42, s38, 11
    s_add_u32 s42, s42, 27852800
    s_lshl_b32 s38, s37, 6
    s_lshl_b32 s39, s3, 4
    s_add_u32 s38, s38, s39
    s_mul_i32 s38, s38, 1152
    s_mul_i32 s39, s36, 384
    s_add_u32 s32, s38, s39
    s_add_u32 s33, s32, 9216
    s_mul_i32 s43, s3, 6144
    v_add_u32 v196, 0, v192
    s_mov_b32 s40, 0xaaaaaab
    v_mul_hi_u32 v197, v196, s40
    v_mul_u32_u24 v198, 24, v197
    v_sub_u32 v198, v196, v198
    v_bfe_u32 v199, v197, 1, 1
    v_lshlrev_b32 v199, 2, v199
    v_xor_b32 v198, v198, v199
    v_lshlrev_b32 v198, 4, v198
    v_mul_u32_u24 v197, 1152, v197
    v_add_u32 v185, v197, v198
    v_add_u32 v196, 64, v192
    s_mov_b32 s40, 0xaaaaaab
    v_mul_hi_u32 v197, v196, s40
    v_mul_u32_u24 v198, 24, v197
    v_sub_u32 v198, v196, v198
    v_bfe_u32 v199, v197, 1, 1
    v_lshlrev_b32 v199, 2, v199
    v_xor_b32 v198, v198, v199
    v_lshlrev_b32 v198, 4, v198
    v_mul_u32_u24 v197, 1152, v197
    v_add_u32 v186, v197, v198
    v_add_u32 v196, 128, v192
    s_mov_b32 s40, 0xaaaaaab
    v_mul_hi_u32 v197, v196, s40
    v_mul_u32_u24 v198, 24, v197
    v_sub_u32 v198, v196, v198
    v_bfe_u32 v199, v197, 1, 1
    v_lshlrev_b32 v199, 2, v199
    v_xor_b32 v198, v198, v199
    v_lshlrev_b32 v198, 4, v198
    v_mul_u32_u24 v197, 1152, v197
    v_add_u32 v187, v197, v198
    s_waitcnt lgkmcnt(0)
    s_mov_b32 s12, s64
    s_mov_b32 s13, s65
    s_mov_b32 s14, 5308416
    s_mov_b32 s15, 0x20000
    s_mov_b32 s8, s66
    s_mov_b32 s9, s67
    s_mov_b32 s10, 268435456
    s_mov_b32 s11, 0x20000
    s_add_u32 m0, s43, 0
    s_nop 0
    buffer_load_dwordx4 v185, s[12:15], s32 offen lds
    s_add_u32 m0, s43, 1024
    s_nop 0
    buffer_load_dwordx4 v186, s[12:15], s32 offen lds
    s_add_u32 m0, s43, 2048
    s_nop 0
    buffer_load_dwordx4 v187, s[12:15], s32 offen lds
    s_add_u32 m0, s43, 3072
    s_nop 0
    buffer_load_dwordx4 v185, s[12:15], s33 offen lds
    s_add_u32 m0, s43, 4096
    s_nop 0
    buffer_load_dwordx4 v186, s[12:15], s33 offen lds
    s_add_u32 m0, s43, 5120
    s_nop 0
    buffer_load_dwordx4 v187, s[12:15], s33 offen lds
    s_add_u32 s32, s32, 73728
    s_add_u32 s33, s33, 73728
    s_add_u32 m0, s43, 24576
    s_nop 0
    buffer_load_dwordx4 v185, s[12:15], s32 offen lds
    s_add_u32 m0, s43, 25600
    s_nop 0
    buffer_load_dwordx4 v186, s[12:15], s32 offen lds
    s_add_u32 m0, s43, 26624
    s_nop 0
    buffer_load_dwordx4 v187, s[12:15], s32 offen lds
    s_add_u32 m0, s43, 27648
    s_nop 0
    buffer_load_dwordx4 v185, s[12:15], s33 offen lds
    s_add_u32 m0, s43, 28672
    s_nop 0
    buffer_load_dwordx4 v186, s[12:15], s33 offen lds
    s_add_u32 m0, s43, 29696
    s_nop 0
    buffer_load_dwordx4 v187, s[12:15], s33 offen lds
    s_add_u32 s32, s32, 73728
    s_add_u32 s33, s33, 73728
    s_lshl_b32 s38, s30, 2
    s_add_u32 s38, s38, s5
    s_lshl_b32 s38, s38, 7
    s_add_u32 s38, s38, 37765120
    s_mul_i32 s39, s30, 3
    s_add_u32 s39, s39, s31
    s_lshl_b32 s39, s39, 7
    s_add_u32 s39, s39, 37773296
    s_add_u32 s84, s39, 16
    v_min_u32 v196, 7, v192
    v_lshlrev_b32 v197, 2, v196
    v_mov_b32 v198, s38
    v_mov_b32 v199, s39
    v_cmp_gt_u32 vcc, 4, v196
    s_nop 1
    v_cndmask_b32 v198, v199, v198, vcc
    v_add_u32 v197, v197, v198
    v_mov_b32 v200, 0
    s_cmp_eq_u32 s3, 0
    s_cbranch_scc0 gm_l2_kernel_dw_ok
    s_mov_b32 s52, 0
gm_l2_kernel_dw:
    buffer_load_dword v206, v197, s[8:11], 0 offen sc1
    s_waitcnt vmcnt(0)
    s_mov_b64 s[54:55], 0
    v_cmp_eq_u32 vcc, 0, v206
    s_and_b64 vcc, vcc, 0xf
    s_or_b64 s[54:55], s[54:55], vcc
    s_add_u32 s52, s52, 1
    s_cmp_eq_u64 s[54:55], 0
    s_cbranch_scc1 gm_l2_kernel_dw_ok
    s_cmp_ge_u32 s52, 0x40000
    s_cbranch_scc1 gm_l2_kernel_dw_ok
    s_sleep 4
    s_branch gm_l2_kernel_dw
gm_l2_kernel_dw_ok:
    s_barrier
    buffer_load_dwordx4 a[144:147], v184, s[8:11], s6 offen offset:0
    buffer_load_dwordx4 a[148:151], v184, s[8:11], s6 offen offset:1024
    buffer_load_dwordx4 a[152:155], v184, s[8:11], s6 offen offset:2048
    buffer_load_dwordx4 a[156:159], v184, s[8:11], s6 offen offset:3072
    s_add_u32 s6, s6, 4096
    buffer_load_dwordx4 a[160:163], v184, s[8:11], s6 offen offset:0
    buffer_load_dwordx4 a[164:167], v184, s[8:11], s6 offen offset:1024
    buffer_load_dwordx4 a[168:171], v184, s[8:11], s6 offen offset:2048
    buffer_load_dwordx4 a[172:175], v184, s[8:11], s6 offen offset:3072
    s_add_u32 s6, s6, 4096
    v_lshrrev_b32 v196, 4, v192
    v_bfe_u32 v197, v192, 2, 2
    v_and_b32 v198, 3, v192
    v_lshrrev_b32 v199, 1, v196
    v_lshlrev_b32 v199, 2, v199
    v_add_u32 v199, v199, v197
    v_mul_u32_u24 v199, 384, v199
    v_and_b32 v196, 1, v196
    v_lshlrev_b32 v196, 5, v196
    v_add_u32 v199, v199, v196
    v_lshlrev_b32 v198, 3, v198
    v_add_u32 v199, v199, v198
    v_lshrrev_b32 v197, 1, v197
    v_lshlrev_b32 v197, 6, v197
    v_add_u32 v190, v199, v197
    v_sub_u32 v191, v199, v197
    v_mov_b32 v188, v190
    v_mov_b32 v189, v191
    s_mov_b32 s7, 0
    s_add_u32 s28, s43, 73728
    s_mov_b32 s29, 0
    s_lshr_b32 s45, s5, 1
    s_and_b32 s46, s5, 1
    s_lshl_b32 s48, s30, 2
    s_lshl_b32 s49, s45, 1
    s_add_u32 s48, s48, s49
    s_mul_i32 s49, s31, 6
    s_mul_i32 s50, s46, 3
    s_add_u32 s49, s49, s50
    s_add_u32 s49, s49, s3
    s_mul_i32 s50, s49, 36864
    s_add_u32 s50, s50, 24772608
    s_mov_b32 s20, s66
    s_mov_b32 s21, s67
    s_mov_b32 s22, 268435456
    s_mov_b32 s23, 0x20000
    s_cmp_eq_u32 s3, 3
    s_cselect_b32 s22, 0, s22
    s_mov_b32 s24, s66
    s_mov_b32 s25, s67
    s_mov_b32 s26, 0
    s_mov_b32 s27, 0x20000
    s_waitcnt vmcnt(14)
    s_barrier
    ds_read_b64_tr_b16 a[208:209], v188 offset:0
    ds_read_b64_tr_b16 a[210:211], v188 offset:3072
    ds_read_b64_tr_b16 a[212:213], v189 offset:64
    ds_read_b64_tr_b16 a[214:215], v189 offset:3136
    ds_read_b64_tr_b16 a[216:217], v188 offset:128
    ds_read_b64_tr_b16 a[218:219], v188 offset:3200
    ds_read_b64_tr_b16 a[220:221], v189 offset:192
    ds_read_b64_tr_b16 a[222:223], v189 offset:3264
gm_l2_kernel_st0:
    s_waitcnt vmcnt(4)
    s_waitcnt lgkmcnt(4)
    v_mfma_f32_32x32x16_bf16 v[0:15], a[208:211], a[144:147], 0
    ds_read_b64_tr_b16 a[224:225], v188 offset:256
    ds_read_b64_tr_b16 a[226:227], v188 offset:3328
    s_add_u32 m0, s43, 49152
    s_nop 0
    buffer_load_dwordx4 v185, s[12:15], s32 offen lds
    v_mfma_f32_32x32x16_bf16 v[16:31], a[212:215], a[144:147], 0
    ds_read_b64_tr_b16 a[228:229], v189 offset:320
    ds_read_b64_tr_b16 a[230:231], v189 offset:3392
    s_add_u32 m0, s43, 50176
    s_nop 0
    buffer_load_dwordx4 v186, s[12:15], s32 offen lds
    s_waitcnt lgkmcnt(4)
    v_mfma_f32_32x32x16_bf16 v[32:47], a[216:219], a[144:147], 0
    ds_read_b64_tr_b16 a[208:209], v188 offset:6144
    ds_read_b64_tr_b16 a[210:211], v188 offset:9216
    s_add_u32 m0, s43, 51200
    s_nop 0
    buffer_load_dwordx4 v187, s[12:15], s32 offen lds
    v_mfma_f32_32x32x16_bf16 v[48:63], a[220:223], a[144:147], 0
    ds_read_b64_tr_b16 a[212:213], v189 offset:6208
    ds_read_b64_tr_b16 a[214:215], v189 offset:9280
    s_add_u32 m0, s43, 52224
    s_nop 0
    buffer_load_dwordx4 v185, s[12:15], s33 offen lds
    s_waitcnt lgkmcnt(4)
    v_mfma_f32_32x32x16_bf16 v[64:79], a[224:227], a[144:147], 0
    ds_read_b64_tr_b16 a[216:217], v188 offset:6272
    ds_read_b64_tr_b16 a[218:219], v188 offset:9344
    s_add_u32 m0, s43, 53248
    s_nop 0
    buffer_load_dwordx4 v186, s[12:15], s33 offen lds
    v_mfma_f32_32x32x16_bf16 v[80:95], a[228:231], a[144:147], 0
    ds_read_b64_tr_b16 a[220:221], v189 offset:6336
    ds_read_b64_tr_b16 a[222:223], v189 offset:9408
    s_add_u32 m0, s43, 54272
    s_nop 0
    buffer_load_dwordx4 v187, s[12:15], s33 offen lds
    s_waitcnt lgkmcnt(4)
    v_mfma_f32_32x32x16_bf16 v[0:15], a[208:211], a[148:151], v[0:15]
    ds_read_b64_tr_b16 a[224:225], v188 offset:6400
    ds_read_b64_tr_b16 a[226:227], v188 offset:9472
    buffer_load_dwordx4 a[176:179], v184, s[8:11], s6 offen offset:0
    v_mfma_f32_32x32x16_bf16 v[16:31], a[212:215], a[148:151], v[16:31]
    ds_read_b64_tr_b16 a[228:229], v189 offset:6464
    ds_read_b64_tr_b16 a[230:231], v189 offset:9536
    buffer_load_dwordx4 a[180:183], v184, s[8:11], s6 offen offset:1024
    s_waitcnt lgkmcnt(4)
    v_mfma_f32_32x32x16_bf16 v[32:47], a[216:219], a[148:151], v[32:47]
    ds_read_b64_tr_b16 a[208:209], v188 offset:12288
    ds_read_b64_tr_b16 a[210:211], v188 offset:15360
    buffer_load_dwordx4 a[184:187], v184, s[8:11], s6 offen offset:2048
    v_mfma_f32_32x32x16_bf16 v[48:63], a[220:223], a[148:151], v[48:63]
    ds_read_b64_tr_b16 a[212:213], v189 offset:12352
    ds_read_b64_tr_b16 a[214:215], v189 offset:15424
    buffer_load_dwordx4 a[188:191], v184, s[8:11], s6 offen offset:3072
    s_add_u32 s6, s6, 4096
    s_add_u32 s32, s32, 73728
    s_add_u32 s33, s33, 73728
    s_waitcnt lgkmcnt(4)
    v_mfma_f32_32x32x16_bf16 v[64:79], a[224:227], a[148:151], v[64:79]
    ds_read_b64_tr_b16 a[216:217], v188 offset:12416
    ds_read_b64_tr_b16 a[218:219], v188 offset:15488
    s_add_u32 m0, s28, 0
    s_nop 0
    buffer_load_dwordx4 v185, s[12:15], s32 offen lds
    v_mfma_f32_32x32x16_bf16 v[80:95], a[228:231], a[148:151], v[80:95]
    ds_read_b64_tr_b16 a[220:221], v189 offset:12480
    ds_read_b64_tr_b16 a[222:223], v189 offset:15552
    s_add_u32 m0, s28, 1024
    s_nop 0
    buffer_load_dwordx4 v186, s[12:15], s32 offen lds
    s_waitcnt lgkmcnt(4)
    v_mfma_f32_32x32x16_bf16 v[0:15], a[208:211], a[152:155], v[0:15]
    ds_read_b64_tr_b16 a[224:225], v188 offset:12544
    ds_read_b64_tr_b16 a[226:227], v188 offset:15616
    s_add_u32 m0, s28, 2048
    s_nop 0
    buffer_load_dwordx4 v187, s[12:15], s32 offen lds
    v_mfma_f32_32x32x16_bf16 v[16:31], a[212:215], a[152:155], v[16:31]
    ds_read_b64_tr_b16 a[228:229], v189 offset:12608
    ds_read_b64_tr_b16 a[230:231], v189 offset:15680
    s_add_u32 s55, s50, 0
    buffer_load_dwordx4 a[0:3], v184, s[20:23], s55 offen
    s_add_u32 m0, s28, 3072
    s_nop 0
    buffer_load_dwordx4 v185, s[12:15], s33 offen lds
    s_waitcnt lgkmcnt(4)
    v_mfma_f32_32x32x16_bf16 v[32:47], a[216:219], a[152:155], v[32:47]
    ds_read_b64_tr_b16 a[208:209], v188 offset:18432
    ds_read_b64_tr_b16 a[210:211], v188 offset:21504
    s_add_u32 m0, s28, 4096
    s_nop 0
    buffer_load_dwordx4 v186, s[12:15], s33 offen lds
    v_mfma_f32_32x32x16_bf16 v[48:63], a[220:223], a[152:155], v[48:63]
    ds_read_b64_tr_b16 a[212:213], v189 offset:18496
    ds_read_b64_tr_b16 a[214:215], v189 offset:21568
    s_add_u32 s55, s50, 1024
    buffer_load_dwordx4 a[4:7], v184, s[20:23], s55 offen
    s_add_u32 m0, s28, 5120
    s_nop 0
    buffer_load_dwordx4 v187, s[12:15], s33 offen lds
    s_waitcnt lgkmcnt(4)
    v_mfma_f32_32x32x16_bf16 v[64:79], a[224:227], a[152:155], v[64:79]
    ds_read_b64_tr_b16 a[216:217], v188 offset:18560
    ds_read_b64_tr_b16 a[218:219], v188 offset:21632
    buffer_load_dwordx4 a[192:195], v184, s[8:11], s6 offen offset:0
    v_mfma_f32_32x32x16_bf16 v[80:95], a[228:231], a[152:155], v[80:95]
    ds_read_b64_tr_b16 a[220:221], v189 offset:18624
    ds_read_b64_tr_b16 a[222:223], v189 offset:21696
    buffer_load_dwordx4 a[196:199], v184, s[8:11], s6 offen offset:1024
    s_waitcnt lgkmcnt(4)
    v_mfma_f32_32x32x16_bf16 v[0:15], a[208:211], a[156:159], v[0:15]
    ds_read_b64_tr_b16 a[224:225], v188 offset:18688
    ds_read_b64_tr_b16 a[226:227], v188 offset:21760
    buffer_load_dwordx4 a[200:203], v184, s[8:11], s6 offen offset:2048
    v_mfma_f32_32x32x16_bf16 v[16:31], a[212:215], a[156:159], v[16:31]
    ds_read_b64_tr_b16 a[228:229], v189 offset:18752
    ds_read_b64_tr_b16 a[230:231], v189 offset:21824
    buffer_load_dwordx4 a[204:207], v184, s[8:11], s6 offen offset:3072
    s_waitcnt lgkmcnt(4)
    v_mfma_f32_32x32x16_bf16 v[32:47], a[216:219], a[156:159], v[32:47]
    s_add_u32 s6, s6, 4096
    s_add_u32 s32, s32, 73728
    s_add_u32 s33, s33, 73728
    v_mfma_f32_32x32x16_bf16 v[48:63], a[220:223], a[156:159], v[48:63]
    s_add_u32 s7, s7, 24576
    s_cmp_eq_u32 s7, 122880
    s_cselect_b32 s7, 0, s7
    v_add_u32 v188, s7, v190
    v_add_u32 v189, s7, v191
    s_waitcnt lgkmcnt(0)
    v_mfma_f32_32x32x16_bf16 v[64:79], a[224:227], a[156:159], v[64:79]
    s_waitcnt vmcnt(30) lgkmcnt(0)
    s_barrier
    ds_read_b64_tr_b16 a[208:209], v188 offset:0
    ds_read_b64_tr_b16 a[210:211], v188 offset:3072
    ds_read_b64_tr_b16 a[212:213], v189 offset:64
    ds_read_b64_tr_b16 a[214:215], v189 offset:3136
    v_mfma_f32_32x32x16_bf16 v[80:95], a[228:231], a[156:159], v[80:95]
    ds_read_b64_tr_b16 a[216:217], v188 offset:128
    ds_read_b64_tr_b16 a[218:219], v188 offset:3200
    ds_read_b64_tr_b16 a[220:221], v189 offset:192
    ds_read_b64_tr_b16 a[222:223], v189 offset:3264
    s_add_u32 s28, s28, 24576
    s_sub_u32 s44, s28, s43
    s_cmp_eq_u32 s44, 122880
    s_cselect_b32 s28, s43, s28
gm_l2_kernel_st1:
    s_waitcnt vmcnt(22)
    s_waitcnt lgkmcnt(4)
    v_mfma_f32_32x32x16_bf16 v[0:15], a[208:211], a[160:163], v[0:15]
    ds_read_b64_tr_b16 a[224:225], v188 offset:256
    ds_read_b64_tr_b16 a[226:227], v188 offset:3328
    s_add_u32 m0, s28, 0
    v_mfma_f32_32x32x16_bf16 v[16:31], a[212:215], a[160:163], v[16:31]
    ds_read_b64_tr_b16 a[228:229], v189 offset:320
    ds_read_b64_tr_b16 a[230:231], v189 offset:3392
    buffer_load_dwordx4 v185, s[12:15], s32 offen lds
    s_waitcnt lgkmcnt(4)
    v_mfma_f32_32x32x16_bf16 v[32:47], a[216:219], a[160:163], v[32:47]
    ds_read_b64_tr_b16 a[208:209], v188 offset:6144
    ds_read_b64_tr_b16 a[210:211], v188 offset:9216
    s_add_u32 m0, s28, 1024
    v_mfma_f32_32x32x16_bf16 v[48:63], a[220:223], a[160:163], v[48:63]
    ds_read_b64_tr_b16 a[212:213], v189 offset:6208
    ds_read_b64_tr_b16 a[214:215], v189 offset:9280
    buffer_load_dwordx4 v186, s[12:15], s32 offen lds
    s_waitcnt lgkmcnt(4)
    v_mfma_f32_32x32x16_bf16 v[64:79], a[224:227], a[160:163], v[64:79]
    ds_read_b64_tr_b16 a[216:217], v188 offset:6272
    ds_read_b64_tr_b16 a[218:219], v188 offset:9344
    s_add_u32 m0, s28, 2048
    v_mfma_f32_32x32x16_bf16 v[80:95], a[228:231], a[160:163], v[80:95]
    ds_read_b64_tr_b16 a[220:221], v189 offset:6336
    ds_read_b64_tr_b16 a[222:223], v189 offset:9408
    buffer_load_dwordx4 v187, s[12:15], s32 offen lds
    s_waitcnt lgkmcnt(4)
    v_mfma_f32_32x32x16_bf16 v[0:15], a[208:211], a[164:167], v[0:15]
    ds_read_b64_tr_b16 a[224:225], v188 offset:6400
    ds_read_b64_tr_b16 a[226:227], v188 offset:9472
    s_add_u32 m0, s28, 3072
    v_mfma_f32_32x32x16_bf16 v[16:31], a[212:215], a[164:167], v[16:31]
    ds_read_b64_tr_b16 a[228:229], v189 offset:6464
    ds_read_b64_tr_b16 a[230:231], v189 offset:9536
    buffer_load_dwordx4 v185, s[12:15], s33 offen lds
    s_waitcnt lgkmcnt(4)
    v_mfma_f32_32x32x16_bf16 v[32:47], a[216:219], a[164:167], v[32:47]
    ds_read_b64_tr_b16 a[208:209], v188 offset:12288
    ds_read_b64_tr_b16 a[210:211], v188 offset:15360
    s_add_u32 m0, s28, 4096
    v_mfma_f32_32x32x16_bf16 v[48:63], a[220:223], a[164:167], v[48:63]
    ds_read_b64_tr_b16 a[212:213], v189 offset:12352
    ds_read_b64_tr_b16 a[214:215], v189 offset:15424
    buffer_load_dwordx4 v186, s[12:15], s33 offen lds
    s_waitcnt lgkmcnt(4)
    v_mfma_f32_32x32x16_bf16 v[64:79], a[224:227], a[164:167], v[64:79]
    ds_read_b64_tr_b16 a[216:217], v188 offset:12416
    ds_read_b64_tr_b16 a[218:219], v188 offset:15488
    s_add_u32 m0, s28, 5120
    v_mfma_f32_32x32x16_bf16 v[80:95], a[228:231], a[164:167], v[80:95]
    ds_read_b64_tr_b16 a[220:221], v189 offset:12480
    ds_read_b64_tr_b16 a[222:223], v189 offset:15552
    buffer_load_dwordx4 v187, s[12:15], s33 offen lds
    s_waitcnt lgkmcnt(4)
    v_mfma_f32_32x32x16_bf16 v[0:15], a[208:211], a[168:171], v[0:15]
    ds_read_b64_tr_b16 a[224:225], v188 offset:12544
    ds_read_b64_tr_b16 a[226:227], v188 offset:15616
    buffer_load_dwordx4 a[144:147], v184, s[8:11], s6 offen offset:0
    v_mfma_f32_32x32x16_bf16 v[16:31], a[212:215], a[168:171], v[16:31]
    ds_read_b64_tr_b16 a[228:229], v189 offset:12608
    ds_read_b64_tr_b16 a[230:231], v189 offset:15680
    s_add_u32 s55, s50, 2048
    buffer_load_dwordx4 a[8:11], v184, s[20:23], s55 offen
    s_waitcnt lgkmcnt(4)
    v_mfma_f32_32x32x16_bf16 v[32:47], a[216:219], a[168:171], v[32:47]
    ds_read_b64_tr_b16 a[208:209], v188 offset:18432
    ds_read_b64_tr_b16 a[210:211], v188 offset:21504
    buffer_load_dwordx4 a[148:151], v184, s[8:11], s6 offen offset:1024
    v_mfma_f32_32x32x16_bf16 v[48:63], a[220:223], a[168:171], v[48:63]
    ds_read_b64_tr_b16 a[212:213], v189 offset:18496
    ds_read_b64_tr_b16 a[214:215], v189 offset:21568
    s_add_u32 s55, s50, 3072
    buffer_load_dwordx4 a[12:15], v184, s[20:23], s55 offen
    s_waitcnt lgkmcnt(4)
    v_mfma_f32_32x32x16_bf16 v[64:79], a[224:227], a[168:171], v[64:79]
    ds_read_b64_tr_b16 a[216:217], v188 offset:18560
    ds_read_b64_tr_b16 a[218:219], v188 offset:21632
    buffer_load_dwordx4 a[152:155], v184, s[8:11], s6 offen offset:2048
    v_mfma_f32_32x32x16_bf16 v[80:95], a[228:231], a[168:171], v[80:95]
    ds_read_b64_tr_b16 a[220:221], v189 offset:18624
    ds_read_b64_tr_b16 a[222:223], v189 offset:21696
    s_waitcnt lgkmcnt(4)
    v_mfma_f32_32x32x16_bf16 v[0:15], a[208:211], a[172:175], v[0:15]
    ds_read_b64_tr_b16 a[224:225], v188 offset:18688
    ds_read_b64_tr_b16 a[226:227], v188 offset:21760
    buffer_load_dwordx4 a[156:159], v184, s[8:11], s6 offen offset:3072
    v_mfma_f32_32x32x16_bf16 v[16:31], a[212:215], a[172:175], v[16:31]
    ds_read_b64_tr_b16 a[228:229], v189 offset:18752
    ds_read_b64_tr_b16 a[230:231], v189 offset:21824
    s_waitcnt lgkmcnt(4)
    v_mfma_f32_32x32x16_bf16 v[32:47], a[216:219], a[172:175], v[32:47]
    s_add_u32 s6, s6, 4096
    s_add_u32 s32, s32, 73728
    s_add_u32 s33, s33, 73728
    v_mfma_f32_32x32x16_bf16 v[48:63], a[220:223], a[172:175], v[48:63]
    s_add_u32 s7, s7, 24576
    s_cmp_eq_u32 s7, 122880
    s_cselect_b32 s7, 0, s7
    v_add_u32 v188, s7, v190
    v_add_u32 v189, s7, v191
    s_waitcnt lgkmcnt(0)
    v_mfma_f32_32x32x16_bf16 v[64:79], a[224:227], a[172:175], v[64:79]
    s_waitcnt vmcnt(28) lgkmcnt(0)
    s_barrier
    ds_read_b64_tr_b16 a[208:209], v188 offset:0
    ds_read_b64_tr_b16 a[210:211], v188 offset:3072
    ds_read_b64_tr_b16 a[212:213], v189 offset:64
    ds_read_b64_tr_b16 a[214:215], v189 offset:3136
    v_mfma_f32_32x32x16_bf16 v[80:95], a[228:231], a[172:175], v[80:95]
    ds_read_b64_tr_b16 a[216:217], v188 offset:128
    ds_read_b64_tr_b16 a[218:219], v188 offset:3200
    ds_read_b64_tr_b16 a[220:221], v189 offset:192
    ds_read_b64_tr_b16 a[222:223], v189 offset:3264
    s_add_u32 s28, s28, 24576
    s_sub_u32 s44, s28, s43
    s_cmp_eq_u32 s44, 122880
    s_cselect_b32 s28, s43, s28
gm_l2_kernel_st2:
    s_waitcnt vmcnt(24)
    s_waitcnt lgkmcnt(4)
    v_mfma_f32_32x32x16_bf16 v[0:15], a[208:211], a[176:179], v[0:15]
    ds_read_b64_tr_b16 a[224:225], v188 offset:256
    ds_read_b64_tr_b16 a[226:227], v188 offset:3328
    s_add_u32 m0, s28, 0
    v_mfma_f32_32x32x16_bf16 v[16:31], a[212:215], a[176:179], v[16:31]
    ds_read_b64_tr_b16 a[228:229], v189 offset:320
    ds_read_b64_tr_b16 a[230:231], v189 offset:3392
    buffer_load_dwordx4 v185, s[12:15], s32 offen lds
    s_waitcnt lgkmcnt(4)
    v_mfma_f32_32x32x16_bf16 v[32:47], a[216:219], a[176:179], v[32:47]
    ds_read_b64_tr_b16 a[208:209], v188 offset:6144
    ds_read_b64_tr_b16 a[210:211], v188 offset:9216
    s_add_u32 m0, s28, 1024
    v_mfma_f32_32x32x16_bf16 v[48:63], a[220:223], a[176:179], v[48:63]
    ds_read_b64_tr_b16 a[212:213], v189 offset:6208
    ds_read_b64_tr_b16 a[214:215], v189 offset:9280
    buffer_load_dwordx4 v186, s[12:15], s32 offen lds
    s_waitcnt lgkmcnt(4)
    v_mfma_f32_32x32x16_bf16 v[64:79], a[224:227], a[176:179], v[64:79]
    ds_read_b64_tr_b16 a[216:217], v188 offset:6272
    ds_read_b64_tr_b16 a[218:219], v188 offset:9344
    s_add_u32 m0, s28, 2048
    v_mfma_f32_32x32x16_bf16 v[80:95], a[228:231], a[176:179], v[80:95]
    ds_read_b64_tr_b16 a[220:221], v189 offset:6336
    ds_read_b64_tr_b16 a[222:223], v189 offset:9408
    buffer_load_dwordx4 v187, s[12:15], s32 offen lds
    s_waitcnt lgkmcnt(4)
    v_mfma_f32_32x32x16_bf16 v[0:15], a[208:211], a[180:183], v[0:15]
    ds_read_b64_tr_b16 a[224:225], v188 offset:6400
    ds_read_b64_tr_b16 a[226:227], v188 offset:9472
    s_add_u32 m0, s28, 3072
    v_mfma_f32_32x32x16_bf16 v[16:31], a[212:215], a[180:183], v[16:31]
    ds_read_b64_tr_b16 a[228:229], v189 offset:6464
    ds_read_b64_tr_b16 a[230:231], v189 offset:9536
    buffer_load_dwordx4 v185, s[12:15], s33 offen lds
    s_waitcnt lgkmcnt(4)
    v_mfma_f32_32x32x16_bf16 v[32:47], a[216:219], a[180:183], v[32:47]
    ds_read_b64_tr_b16 a[208:209], v188 offset:12288
    ds_read_b64_tr_b16 a[210:211], v188 offset:15360
    s_add_u32 m0, s28, 4096
    v_mfma_f32_32x32x16_bf16 v[48:63], a[220:223], a[180:183], v[48:63]
    ds_read_b64_tr_b16 a[212:213], v189 offset:12352
    ds_read_b64_tr_b16 a[214:215], v189 offset:15424
    buffer_load_dwordx4 v186, s[12:15], s33 offen lds
    s_waitcnt lgkmcnt(4)
    v_mfma_f32_32x32x16_bf16 v[64:79], a[224:227], a[180:183], v[64:79]
    ds_read_b64_tr_b16 a[216:217], v188 offset:12416
    ds_read_b64_tr_b16 a[218:219], v188 offset:15488
    s_add_u32 m0, s28, 5120
    v_mfma_f32_32x32x16_bf16 v[80:95], a[228:231], a[180:183], v[80:95]
    ds_read_b64_tr_b16 a[220:221], v189 offset:12480
    ds_read_b64_tr_b16 a[222:223], v189 offset:15552
    buffer_load_dwordx4 v187, s[12:15], s33 offen lds
    s_waitcnt lgkmcnt(4)
    v_mfma_f32_32x32x16_bf16 v[0:15], a[208:211], a[184:187], v[0:15]
    ds_read_b64_tr_b16 a[224:225], v188 offset:12544
    ds_read_b64_tr_b16 a[226:227], v188 offset:15616
    buffer_load_dwordx4 a[160:163], v184, s[8:11], s6 offen offset:0
    v_mfma_f32_32x32x16_bf16 v[16:31], a[212:215], a[184:187], v[16:31]
    ds_read_b64_tr_b16 a[228:229], v189 offset:12608
    ds_read_b64_tr_b16 a[230:231], v189 offset:15680
    s_add_u32 s55, s50, 4096
    buffer_load_dwordx4 a[16:19], v184, s[20:23], s55 offen
    s_waitcnt lgkmcnt(4)
    v_mfma_f32_32x32x16_bf16 v[32:47], a[216:219], a[184:187], v[32:47]
    ds_read_b64_tr_b16 a[208:209], v188 offset:18432
    ds_read_b64_tr_b16 a[210:211], v188 offset:21504
    buffer_load_dwordx4 a[164:167], v184, s[8:11], s6 offen offset:1024
    v_mfma_f32_32x32x16_bf16 v[48:63], a[220:223], a[184:187], v[48:63]
    ds_read_b64_tr_b16 a[212:213], v189 offset:18496
    ds_read_b64_tr_b16 a[214:215], v189 offset:21568
    s_add_u32 s55, s50, 5120
    buffer_load_dwordx4 a[20:23], v184, s[20:23], s55 offen
    s_waitcnt lgkmcnt(4)
    v_mfma_f32_32x32x16_bf16 v[64:79], a[224:227], a[184:187], v[64:79]
    ds_read_b64_tr_b16 a[216:217], v188 offset:18560
    ds_read_b64_tr_b16 a[218:219], v188 offset:21632
    buffer_load_dwordx4 a[168:171], v184, s[8:11], s6 offen offset:2048
    v_mfma_f32_32x32x16_bf16 v[80:95], a[228:231], a[184:187], v[80:95]
    ds_read_b64_tr_b16 a[220:221], v189 offset:18624
    ds_read_b64_tr_b16 a[222:223], v189 offset:21696
    s_waitcnt lgkmcnt(4)
    v_mfma_f32_32x32x16_bf16 v[0:15], a[208:211], a[188:191], v[0:15]
    ds_read_b64_tr_b16 a[224:225], v188 offset:18688
    ds_read_b64_tr_b16 a[226:227], v188 offset:21760
    buffer_load_dwordx4 a[172:175], v184, s[8:11], s6 offen offset:3072
    v_mfma_f32_32x32x16_bf16 v[16:31], a[212:215], a[188:191], v[16:31]
    ds_read_b64_tr_b16 a[228:229], v189 offset:18752
    ds_read_b64_tr_b16 a[230:231], v189 offset:21824
    s_waitcnt lgkmcnt(4)
    v_mfma_f32_32x32x16_bf16 v[32:47], a[216:219], a[188:191], v[32:47]
    s_add_u32 s6, s6, 4096
    s_add_u32 s32, s32, 73728
    s_add_u32 s33, s33, 73728
    v_mfma_f32_32x32x16_bf16 v[48:63], a[220:223], a[188:191], v[48:63]
    s_add_u32 s7, s7, 24576
    s_cmp_eq_u32 s7, 122880
    s_cselect_b32 s7, 0, s7
    v_add_u32 v188, s7, v190
    v_add_u32 v189, s7, v191
    s_waitcnt lgkmcnt(0)
    v_mfma_f32_32x32x16_bf16 v[64:79], a[224:227], a[188:191], v[64:79]
    s_waitcnt vmcnt(28) lgkmcnt(0)
    s_barrier
    ds_read_b64_tr_b16 a[208:209], v188 offset:0
    ds_read_b64_tr_b16 a[210:211], v188 offset:3072
    ds_read_b64_tr_b16 a[212:213], v189 offset:64
    ds_read_b64_tr_b16 a[214:215], v189 offset:3136
    v_mfma_f32_32x32x16_bf16 v[80:95], a[228:231], a[188:191], v[80:95]
    ds_read_b64_tr_b16 a[216:217], v188 offset:128
    ds_read_b64_tr_b16 a[218:219], v188 offset:3200
    ds_read_b64_tr_b16 a[220:221], v189 offset:192
    ds_read_b64_tr_b16 a[222:223], v189 offset:3264
    s_add_u32 s28, s28, 24576
    s_sub_u32 s44, s28, s43
    s_cmp_eq_u32 s44, 122880
    s_cselect_b32 s28, s43, s28
gm_l2_kernel_st3:
    s_waitcnt vmcnt(24)
    s_waitcnt lgkmcnt(4)
    v_mfma_f32_32x32x16_bf16 v[0:15], a[208:211], a[192:195], v[0:15]
    ds_read_b64_tr_b16 a[224:225], v188 offset:256
    ds_read_b64_tr_b16 a[226:227], v188 offset:3328
    s_add_u32 m0, s28, 0
    v_mfma_f32_32x32x16_bf16 v[16:31], a[212:215], a[192:195], v[16:31]
    ds_read_b64_tr_b16 a[228:229], v189 offset:320
    ds_read_b64_tr_b16 a[230:231], v189 offset:3392
    buffer_load_dwordx4 v185, s[12:15], s32 offen lds
    s_waitcnt lgkmcnt(4)
    v_mfma_f32_32x32x16_bf16 v[32:47], a[216:219], a[192:195], v[32:47]
    ds_read_b64_tr_b16 a[208:209], v188 offset:6144
    ds_read_b64_tr_b16 a[210:211], v188 offset:9216
    s_add_u32 m0, s28, 1024
    v_mfma_f32_32x32x16_bf16 v[48:63], a[220:223], a[192:195], v[48:63]
    ds_read_b64_tr_b16 a[212:213], v189 offset:6208
    ds_read_b64_tr_b16 a[214:215], v189 offset:9280
    buffer_load_dwordx4 v186, s[12:15], s32 offen lds
    s_waitcnt lgkmcnt(4)
    v_mfma_f32_32x32x16_bf16 v[64:79], a[224:227], a[192:195], v[64:79]
    ds_read_b64_tr_b16 a[216:217], v188 offset:6272
    ds_read_b64_tr_b16 a[218:219], v188 offset:9344
    s_add_u32 m0, s28, 2048
    v_mfma_f32_32x32x16_bf16 v[80:95], a[228:231], a[192:195], v[80:95]
    ds_read_b64_tr_b16 a[220:221], v189 offset:6336
    ds_read_b64_tr_b16 a[222:223], v189 offset:9408
    buffer_load_dwordx4 v187, s[12:15], s32 offen lds
    s_waitcnt lgkmcnt(4)
    v_mfma_f32_32x32x16_bf16 v[0:15], a[208:211], a[196:199], v[0:15]
    ds_read_b64_tr_b16 a[224:225], v188 offset:6400
    ds_read_b64_tr_b16 a[226:227], v188 offset:9472
    s_add_u32 m0, s28, 3072
    v_mfma_f32_32x32x16_bf16 v[16:31], a[212:215], a[196:199], v[16:31]
    ds_read_b64_tr_b16 a[228:229], v189 offset:6464
    ds_read_b64_tr_b16 a[230:231], v189 offset:9536
    buffer_load_dwordx4 v185, s[12:15], s33 offen lds
    s_waitcnt lgkmcnt(4)
    v_mfma_f32_32x32x16_bf16 v[32:47], a[216:219], a[196:199], v[32:47]
    ds_read_b64_tr_b16 a[208:209], v188 offset:12288
    ds_read_b64_tr_b16 a[210:211], v188 offset:15360
    s_add_u32 m0, s28, 4096
    v_mfma_f32_32x32x16_bf16 v[48:63], a[220:223], a[196:199], v[48:63]
    ds_read_b64_tr_b16 a[212:213], v189 offset:12352
    ds_read_b64_tr_b16 a[214:215], v189 offset:15424
    buffer_load_dwordx4 v186, s[12:15], s33 offen lds
    s_waitcnt lgkmcnt(4)
    v_mfma_f32_32x32x16_bf16 v[64:79], a[224:227], a[196:199], v[64:79]
    ds_read_b64_tr_b16 a[216:217], v188 offset:12416
    ds_read_b64_tr_b16 a[218:219], v188 offset:15488
    s_add_u32 m0, s28, 5120
    v_mfma_f32_32x32x16_bf16 v[80:95], a[228:231], a[196:199], v[80:95]
    ds_read_b64_tr_b16 a[220:221], v189 offset:12480
    ds_read_b64_tr_b16 a[222:223], v189 offset:15552
    buffer_load_dwordx4 v187, s[12:15], s33 offen lds
    s_waitcnt lgkmcnt(4)
    v_mfma_f32_32x32x16_bf16 v[0:15], a[208:211], a[200:203], v[0:15]
    ds_read_b64_tr_b16 a[224:225], v188 offset:12544
    ds_read_b64_tr_b16 a[226:227], v188 offset:15616
    buffer_load_dwordx4 a[176:179], v184, s[8:11], s6 offen offset:0
    v_mfma_f32_32x32x16_bf16 v[16:31], a[212:215], a[200:203], v[16:31]
    ds_read_b64_tr_b16 a[228:229], v189 offset:12608
    ds_read_b64_tr_b16 a[230:231], v189 offset:15680
    s_add_u32 s55, s50, 6144
    buffer_load_dwordx4 a[24:27], v184, s[20:23], s55 offen
    s_waitcnt lgkmcnt(4)
    v_mfma_f32_32x32x16_bf16 v[32:47], a[216:219], a[200:203], v[32:47]
    ds_read_b64_tr_b16 a[208:209], v188 offset:18432
    ds_read_b64_tr_b16 a[210:211], v188 offset:21504
    buffer_load_dwordx4 a[180:183], v184, s[8:11], s6 offen offset:1024
    v_mfma_f32_32x32x16_bf16 v[48:63], a[220:223], a[200:203], v[48:63]
    ds_read_b64_tr_b16 a[212:213], v189 offset:18496
    ds_read_b64_tr_b16 a[214:215], v189 offset:21568
    s_add_u32 s55, s50, 7168
    buffer_load_dwordx4 a[28:31], v184, s[20:23], s55 offen
    s_waitcnt lgkmcnt(4)
    v_mfma_f32_32x32x16_bf16 v[64:79], a[224:227], a[200:203], v[64:79]
    ds_read_b64_tr_b16 a[216:217], v188 offset:18560
    ds_read_b64_tr_b16 a[218:219], v188 offset:21632
    buffer_load_dwordx4 a[184:187], v184, s[8:11], s6 offen offset:2048
    v_mfma_f32_32x32x16_bf16 v[80:95], a[228:231], a[200:203], v[80:95]
    ds_read_b64_tr_b16 a[220:221], v189 offset:18624
    ds_read_b64_tr_b16 a[222:223], v189 offset:21696
    s_waitcnt lgkmcnt(4)
    v_mfma_f32_32x32x16_bf16 v[0:15], a[208:211], a[204:207], v[0:15]
    ds_read_b64_tr_b16 a[224:225], v188 offset:18688
    ds_read_b64_tr_b16 a[226:227], v188 offset:21760
    buffer_load_dwordx4 a[188:191], v184, s[8:11], s6 offen offset:3072
    v_mfma_f32_32x32x16_bf16 v[16:31], a[212:215], a[204:207], v[16:31]
    ds_read_b64_tr_b16 a[228:229], v189 offset:18752
    ds_read_b64_tr_b16 a[230:231], v189 offset:21824
    s_waitcnt lgkmcnt(4)
    v_mfma_f32_32x32x16_bf16 v[32:47], a[216:219], a[204:207], v[32:47]
    s_add_u32 s6, s6, 4096
    s_add_u32 s32, s32, 73728
    s_add_u32 s33, s33, 73728
    v_mfma_f32_32x32x16_bf16 v[48:63], a[220:223], a[204:207], v[48:63]
    s_add_u32 s7, s7, 24576
    s_cmp_eq_u32 s7, 122880
    s_cselect_b32 s7, 0, s7
    v_add_u32 v188, s7, v190
    v_add_u32 v189, s7, v191
    s_waitcnt lgkmcnt(0)
    v_mfma_f32_32x32x16_bf16 v[64:79], a[224:227], a[204:207], v[64:79]
    s_waitcnt vmcnt(30) lgkmcnt(0)
    s_barrier
    ds_read_b64_tr_b16 a[208:209], v188 offset:0
    ds_read_b64_tr_b16 a[210:211], v188 offset:3072
    ds_read_b64_tr_b16 a[212:213], v189 offset:64
    ds_read_b64_tr_b16 a[214:215], v189 offset:3136
    v_mfma_f32_32x32x16_bf16 v[80:95], a[228:231], a[204:207], v[80:95]
    ds_read_b64_tr_b16 a[216:217], v188 offset:128
    ds_read_b64_tr_b16 a[218:219], v188 offset:3200
    ds_read_b64_tr_b16 a[220:221], v189 offset:192
    ds_read_b64_tr_b16 a[222:223], v189 offset:3264
    s_add_u32 s28, s28, 24576
    s_sub_u32 s44, s28, s43
    s_cmp_eq_u32 s44, 122880
    s_cselect_b32 s28, s43, s28
gm_l2_kernel_st4:
    s_waitcnt vmcnt(24)
    s_waitcnt lgkmcnt(4)
    v_mfma_f32_32x32x16_bf16 v[0:15], a[208:211], a[144:147], v[0:15]
    ds_read_b64_tr_b16 a[224:225], v188 offset:256
    ds_read_b64_tr_b16 a[226:227], v188 offset:3328
    s_add_u32 m0, s28, 0
    v_mfma_f32_32x32x16_bf16 v[16:31], a[212:215], a[144:147], v[16:31]
    ds_read_b64_tr_b16 a[228:229], v189 offset:320
    ds_read_b64_tr_b16 a[230:231], v189 offset:3392
    buffer_load_dwordx4 v185, s[12:15], s32 offen lds
    s_waitcnt lgkmcnt(4)
    v_mfma_f32_32x32x16_bf16 v[32:47], a[216:219], a[144:147], v[32:47]
    ds_read_b64_tr_b16 a[208:209], v188 offset:6144
    ds_read_b64_tr_b16 a[210:211], v188 offset:9216
    s_add_u32 m0, s28, 1024
    v_mfma_f32_32x32x16_bf16 v[48:63], a[220:223], a[144:147], v[48:63]
    ds_read_b64_tr_b16 a[212:213], v189 offset:6208
    ds_read_b64_tr_b16 a[214:215], v189 offset:9280
    buffer_load_dwordx4 v186, s[12:15], s32 offen lds
    s_waitcnt lgkmcnt(4)
    v_mfma_f32_32x32x16_bf16 v[64:79], a[224:227], a[144:147], v[64:79]
    ds_read_b64_tr_b16 a[216:217], v188 offset:6272
    ds_read_b64_tr_b16 a[218:219], v188 offset:9344
    s_add_u32 m0, s28, 2048
    v_mfma_f32_32x32x16_bf16 v[80:95], a[228:231], a[144:147], v[80:95]
    ds_read_b64_tr_b16 a[220:221], v189 offset:6336
    ds_read_b64_tr_b16 a[222:223], v189 offset:9408
    buffer_load_dwordx4 v187, s[12:15], s32 offen lds
    s_waitcnt lgkmcnt(4)
    v_mfma_f32_32x32x16_bf16 v[0:15], a[208:211], a[148:151], v[0:15]
    ds_read_b64_tr_b16 a[224:225], v188 offset:6400
    ds_read_b64_tr_b16 a[226:227], v188 offset:9472
    s_add_u32 m0, s28, 3072
    v_mfma_f32_32x32x16_bf16 v[16:31], a[212:215], a[148:151], v[16:31]
    ds_read_b64_tr_b16 a[228:229], v189 offset:6464
    ds_read_b64_tr_b16 a[230:231], v189 offset:9536
    buffer_load_dwordx4 v185, s[12:15], s33 offen lds
    s_waitcnt lgkmcnt(4)
    v_mfma_f32_32x32x16_bf16 v[32:47], a[216:219], a[148:151], v[32:47]
    ds_read_b64_tr_b16 a[208:209], v188 offset:12288
    ds_read_b64_tr_b16 a[210:211], v188 offset:15360
    s_add_u32 m0, s28, 4096
    v_mfma_f32_32x32x16_bf16 v[48:63], a[220:223], a[148:151], v[48:63]
    ds_read_b64_tr_b16 a[212:213], v189 offset:12352
    ds_read_b64_tr_b16 a[214:215], v189 offset:15424
    buffer_load_dwordx4 v186, s[12:15], s33 offen lds
    s_waitcnt lgkmcnt(4)
    v_mfma_f32_32x32x16_bf16 v[64:79], a[224:227], a[148:151], v[64:79]
    ds_read_b64_tr_b16 a[216:217], v188 offset:12416
    ds_read_b64_tr_b16 a[218:219], v188 offset:15488
    s_add_u32 m0, s28, 5120
    v_mfma_f32_32x32x16_bf16 v[80:95], a[228:231], a[148:151], v[80:95]
    ds_read_b64_tr_b16 a[220:221], v189 offset:12480
    ds_read_b64_tr_b16 a[222:223], v189 offset:15552
    buffer_load_dwordx4 v187, s[12:15], s33 offen lds
    s_waitcnt lgkmcnt(4)
    v_mfma_f32_32x32x16_bf16 v[0:15], a[208:211], a[152:155], v[0:15]
    ds_read_b64_tr_b16 a[224:225], v188 offset:12544
    ds_read_b64_tr_b16 a[226:227], v188 offset:15616
    buffer_load_dwordx4 a[192:195], v184, s[8:11], s6 offen offset:0
    v_mfma_f32_32x32x16_bf16 v[16:31], a[212:215], a[152:155], v[16:31]
    ds_read_b64_tr_b16 a[228:229], v189 offset:12608
    ds_read_b64_tr_b16 a[230:231], v189 offset:15680
    s_add_u32 s55, s50, 8192
    buffer_load_dwordx4 a[32:35], v184, s[20:23], s55 offen
    s_waitcnt lgkmcnt(4)
    v_mfma_f32_32x32x16_bf16 v[32:47], a[216:219], a[152:155], v[32:47]
    ds_read_b64_tr_b16 a[208:209], v188 offset:18432
    ds_read_b64_tr_b16 a[210:211], v188 offset:21504
    buffer_load_dwordx4 a[196:199], v184, s[8:11], s6 offen offset:1024
    v_mfma_f32_32x32x16_bf16 v[48:63], a[220:223], a[152:155], v[48:63]
    ds_read_b64_tr_b16 a[212:213], v189 offset:18496
    ds_read_b64_tr_b16 a[214:215], v189 offset:21568
    s_add_u32 s55, s50, 9216
    buffer_load_dwordx4 a[36:39], v184, s[20:23], s55 offen
    s_waitcnt lgkmcnt(4)
    v_mfma_f32_32x32x16_bf16 v[64:79], a[224:227], a[152:155], v[64:79]
    ds_read_b64_tr_b16 a[216:217], v188 offset:18560
    ds_read_b64_tr_b16 a[218:219], v188 offset:21632
    buffer_load_dwordx4 a[200:203], v184, s[8:11], s6 offen offset:2048
    v_mfma_f32_32x32x16_bf16 v[80:95], a[228:231], a[152:155], v[80:95]
    ds_read_b64_tr_b16 a[220:221], v189 offset:18624
    ds_read_b64_tr_b16 a[222:223], v189 offset:21696
    s_waitcnt lgkmcnt(4)
    v_mfma_f32_32x32x16_bf16 v[0:15], a[208:211], a[156:159], v[0:15]
    ds_read_b64_tr_b16 a[224:225], v188 offset:18688
    ds_read_b64_tr_b16 a[226:227], v188 offset:21760
    buffer_load_dwordx4 a[204:207], v184, s[8:11], s6 offen offset:3072
    v_mfma_f32_32x32x16_bf16 v[16:31], a[212:215], a[156:159], v[16:31]
    ds_read_b64_tr_b16 a[228:229], v189 offset:18752
    ds_read_b64_tr_b16 a[230:231], v189 offset:21824
    s_waitcnt lgkmcnt(4)
    v_mfma_f32_32x32x16_bf16 v[32:47], a[216:219], a[156:159], v[32:47]
    s_add_u32 s6, s6, 4096
    s_add_u32 s32, s32, 73728
    s_add_u32 s33, s33, 73728
    v_mfma_f32_32x32x16_bf16 v[48:63], a[220:223], a[156:159], v[48:63]
    s_add_u32 s7, s7, 24576
    s_cmp_eq_u32 s7, 122880
    s_cselect_b32 s7, 0, s7
    v_add_u32 v188, s7, v190
    v_add_u32 v189, s7, v191
    s_waitcnt lgkmcnt(0)
    v_mfma_f32_32x32x16_bf16 v[64:79], a[224:227], a[156:159], v[64:79]
    s_waitcnt vmcnt(30) lgkmcnt(0)
    s_barrier
    ds_read_b64_tr_b16 a[208:209], v188 offset:0
    ds_read_b64_tr_b16 a[210:211], v188 offset:3072
    ds_read_b64_tr_b16 a[212:213], v189 offset:64
    ds_read_b64_tr_b16 a[214:215], v189 offset:3136
    v_mfma_f32_32x32x16_bf16 v[80:95], a[228:231], a[156:159], v[80:95]
    ds_read_b64_tr_b16 a[216:217], v188 offset:128
    ds_read_b64_tr_b16 a[218:219], v188 offset:3200
    ds_read_b64_tr_b16 a[220:221], v189 offset:192
    ds_read_b64_tr_b16 a[222:223], v189 offset:3264
    s_add_u32 s28, s28, 24576
    s_sub_u32 s44, s28, s43
    s_cmp_eq_u32 s44, 122880
    s_cselect_b32 s28, s43, s28
gm_l2_kernel_st5:
    s_waitcnt vmcnt(24)
    s_waitcnt lgkmcnt(4)
    v_mfma_f32_32x32x16_bf16 v[0:15], a[208:211], a[160:163], v[0:15]
    ds_read_b64_tr_b16 a[224:225], v188 offset:256
    ds_read_b64_tr_b16 a[226:227], v188 offset:3328
    s_add_u32 m0, s28, 0
    v_mfma_f32_32x32x16_bf16 v[16:31], a[212:215], a[160:163], v[16:31]
    ds_read_b64_tr_b16 a[228:229], v189 offset:320
    ds_read_b64_tr_b16 a[230:231], v189 offset:3392
    buffer_load_dwordx4 v185, s[12:15], s32 offen lds
    s_waitcnt lgkmcnt(4)
    v_mfma_f32_32x32x16_bf16 v[32:47], a[216:219], a[160:163], v[32:47]
    ds_read_b64_tr_b16 a[208:209], v188 offset:6144
    ds_read_b64_tr_b16 a[210:211], v188 offset:9216
    s_add_u32 m0, s28, 1024
    v_mfma_f32_32x32x16_bf16 v[48:63], a[220:223], a[160:163], v[48:63]
    ds_read_b64_tr_b16 a[212:213], v189 offset:6208
    ds_read_b64_tr_b16 a[214:215], v189 offset:9280
    buffer_load_dwordx4 v186, s[12:15], s32 offen lds
    s_waitcnt lgkmcnt(4)
    v_mfma_f32_32x32x16_bf16 v[64:79], a[224:227], a[160:163], v[64:79]
    ds_read_b64_tr_b16 a[216:217], v188 offset:6272
    ds_read_b64_tr_b16 a[218:219], v188 offset:9344
    s_add_u32 m0, s28, 2048
    v_mfma_f32_32x32x16_bf16 v[80:95], a[228:231], a[160:163], v[80:95]
    ds_read_b64_tr_b16 a[220:221], v189 offset:6336
    ds_read_b64_tr_b16 a[222:223], v189 offset:9408
    buffer_load_dwordx4 v187, s[12:15], s32 offen lds
    s_waitcnt lgkmcnt(4)
    v_mfma_f32_32x32x16_bf16 v[0:15], a[208:211], a[164:167], v[0:15]
    ds_read_b64_tr_b16 a[224:225], v188 offset:6400
    ds_read_b64_tr_b16 a[226:227], v188 offset:9472
    s_add_u32 m0, s28, 3072
    v_mfma_f32_32x32x16_bf16 v[16:31], a[212:215], a[164:167], v[16:31]
    ds_read_b64_tr_b16 a[228:229], v189 offset:6464
    ds_read_b64_tr_b16 a[230:231], v189 offset:9536
    buffer_load_dwordx4 v185, s[12:15], s33 offen lds
    s_waitcnt lgkmcnt(4)
    v_mfma_f32_32x32x16_bf16 v[32:47], a[216:219], a[164:167], v[32:47]
    ds_read_b64_tr_b16 a[208:209], v188 offset:12288
    ds_read_b64_tr_b16 a[210:211], v188 offset:15360
    s_add_u32 m0, s28, 4096
    v_mfma_f32_32x32x16_bf16 v[48:63], a[220:223], a[164:167], v[48:63]
    ds_read_b64_tr_b16 a[212:213], v189 offset:12352
    ds_read_b64_tr_b16 a[214:215], v189 offset:15424
    buffer_load_dwordx4 v186, s[12:15], s33 offen lds
    s_waitcnt lgkmcnt(4)
    v_mfma_f32_32x32x16_bf16 v[64:79], a[224:227], a[164:167], v[64:79]
    ds_read_b64_tr_b16 a[216:217], v188 offset:12416
    ds_read_b64_tr_b16 a[218:219], v188 offset:15488
    s_add_u32 m0, s28, 5120
    v_mfma_f32_32x32x16_bf16 v[80:95], a[228:231], a[164:167], v[80:95]
    ds_read_b64_tr_b16 a[220:221], v189 offset:12480
    ds_read_b64_tr_b16 a[222:223], v189 offset:15552
    buffer_load_dwordx4 v187, s[12:15], s33 offen lds
    s_waitcnt lgkmcnt(4)
    v_mfma_f32_32x32x16_bf16 v[0:15], a[208:211], a[168:171], v[0:15]
    ds_read_b64_tr_b16 a[224:225], v188 offset:12544
    ds_read_b64_tr_b16 a[226:227], v188 offset:15616
    buffer_load_dwordx4 a[144:147], v184, s[8:11], s6 offen offset:0
    v_mfma_f32_32x32x16_bf16 v[16:31], a[212:215], a[168:171], v[16:31]
    ds_read_b64_tr_b16 a[228:229], v189 offset:12608
    ds_read_b64_tr_b16 a[230:231], v189 offset:15680
    s_add_u32 s55, s50, 10240
    buffer_load_dwordx4 a[40:43], v184, s[20:23], s55 offen
    s_waitcnt lgkmcnt(4)
    v_mfma_f32_32x32x16_bf16 v[32:47], a[216:219], a[168:171], v[32:47]
    ds_read_b64_tr_b16 a[208:209], v188 offset:18432
    ds_read_b64_tr_b16 a[210:211], v188 offset:21504
    buffer_load_dwordx4 a[148:151], v184, s[8:11], s6 offen offset:1024
    v_mfma_f32_32x32x16_bf16 v[48:63], a[220:223], a[168:171], v[48:63]
    ds_read_b64_tr_b16 a[212:213], v189 offset:18496
    ds_read_b64_tr_b16 a[214:215], v189 offset:21568
    s_add_u32 s55, s50, 11264
    buffer_load_dwordx4 a[44:47], v184, s[20:23], s55 offen
    s_waitcnt lgkmcnt(4)
    v_mfma_f32_32x32x16_bf16 v[64:79], a[224:227], a[168:171], v[64:79]
    ds_read_b64_tr_b16 a[216:217], v188 offset:18560
    ds_read_b64_tr_b16 a[218:219], v188 offset:21632
    buffer_load_dwordx4 a[152:155], v184, s[8:11], s6 offen offset:2048
    v_mfma_f32_32x32x16_bf16 v[80:95], a[228:231], a[168:171], v[80:95]
    ds_read_b64_tr_b16 a[220:221], v189 offset:18624
    ds_read_b64_tr_b16 a[222:223], v189 offset:21696
    s_waitcnt lgkmcnt(4)
    v_mfma_f32_32x32x16_bf16 v[0:15], a[208:211], a[172:175], v[0:15]
    ds_read_b64_tr_b16 a[224:225], v188 offset:18688
    ds_read_b64_tr_b16 a[226:227], v188 offset:21760
    buffer_load_dwordx4 a[156:159], v184, s[8:11], s6 offen offset:3072
    v_mfma_f32_32x32x16_bf16 v[16:31], a[212:215], a[172:175], v[16:31]
    ds_read_b64_tr_b16 a[228:229], v189 offset:18752
    ds_read_b64_tr_b16 a[230:231], v189 offset:21824
    s_waitcnt lgkmcnt(4)
    v_mfma_f32_32x32x16_bf16 v[32:47], a[216:219], a[172:175], v[32:47]
    s_add_u32 s6, s6, 4096
    s_add_u32 s32, s32, 73728
    s_add_u32 s33, s33, 73728
    v_mfma_f32_32x32x16_bf16 v[48:63], a[220:223], a[172:175], v[48:63]
    s_add_u32 s7, s7, 24576
    s_cmp_eq_u32 s7, 122880
    s_cselect_b32 s7, 0, s7
    v_add_u32 v188, s7, v190
    v_add_u32 v189, s7, v191
    s_waitcnt lgkmcnt(0)
    v_mfma_f32_32x32x16_bf16 v[64:79], a[224:227], a[172:175], v[64:79]
    s_waitcnt vmcnt(30) lgkmcnt(0)
    s_barrier
    ds_read_b64_tr_b16 a[208:209], v188 offset:0
    ds_read_b64_tr_b16 a[210:211], v188 offset:3072
    ds_read_b64_tr_b16 a[212:213], v189 offset:64
    ds_read_b64_tr_b16 a[214:215], v189 offset:3136
    v_mfma_f32_32x32x16_bf16 v[80:95], a[228:231], a[172:175], v[80:95]
    ds_read_b64_tr_b16 a[216:217], v188 offset:128
    ds_read_b64_tr_b16 a[218:219], v188 offset:3200
    ds_read_b64_tr_b16 a[220:221], v189 offset:192
    ds_read_b64_tr_b16 a[222:223], v189 offset:3264
    s_add_u32 s28, s28, 24576
    s_sub_u32 s44, s28, s43
    s_cmp_eq_u32 s44, 122880
    s_cselect_b32 s28, s43, s28
gm_l2_kernel_st6:
    s_waitcnt vmcnt(24)
    s_waitcnt lgkmcnt(4)
    v_mfma_f32_32x32x16_bf16 v[0:15], a[208:211], a[176:179], v[0:15]
    ds_read_b64_tr_b16 a[224:225], v188 offset:256
    ds_read_b64_tr_b16 a[226:227], v188 offset:3328
    s_add_u32 m0, s28, 0
    v_mfma_f32_32x32x16_bf16 v[16:31], a[212:215], a[176:179], v[16:31]
    ds_read_b64_tr_b16 a[228:229], v189 offset:320
    ds_read_b64_tr_b16 a[230:231], v189 offset:3392
    buffer_load_dwordx4 v185, s[12:15], s32 offen lds
    s_waitcnt lgkmcnt(4)
    v_mfma_f32_32x32x16_bf16 v[32:47], a[216:219], a[176:179], v[32:47]
    ds_read_b64_tr_b16 a[208:209], v188 offset:6144
    ds_read_b64_tr_b16 a[210:211], v188 offset:9216
    s_add_u32 m0, s28, 1024
    v_mfma_f32_32x32x16_bf16 v[48:63], a[220:223], a[176:179], v[48:63]
    ds_read_b64_tr_b16 a[212:213], v189 offset:6208
    ds_read_b64_tr_b16 a[214:215], v189 offset:9280
    buffer_load_dwordx4 v186, s[12:15], s32 offen lds
    s_waitcnt lgkmcnt(4)
    v_mfma_f32_32x32x16_bf16 v[64:79], a[224:227], a[176:179], v[64:79]
    ds_read_b64_tr_b16 a[216:217], v188 offset:6272
    ds_read_b64_tr_b16 a[218:219], v188 offset:9344
    s_add_u32 m0, s28, 2048
    v_mfma_f32_32x32x16_bf16 v[80:95], a[228:231], a[176:179], v[80:95]
    ds_read_b64_tr_b16 a[220:221], v189 offset:6336
    ds_read_b64_tr_b16 a[222:223], v189 offset:9408
    buffer_load_dwordx4 v187, s[12:15], s32 offen lds
    s_waitcnt lgkmcnt(4)
    v_mfma_f32_32x32x16_bf16 v[0:15], a[208:211], a[180:183], v[0:15]
    ds_read_b64_tr_b16 a[224:225], v188 offset:6400
    ds_read_b64_tr_b16 a[226:227], v188 offset:9472
    s_add_u32 m0, s28, 3072
    v_mfma_f32_32x32x16_bf16 v[16:31], a[212:215], a[180:183], v[16:31]
    ds_read_b64_tr_b16 a[228:229], v189 offset:6464
    ds_read_b64_tr_b16 a[230:231], v189 offset:9536
    buffer_load_dwordx4 v185, s[12:15], s33 offen lds
    s_waitcnt lgkmcnt(4)
    v_mfma_f32_32x32x16_bf16 v[32:47], a[216:219], a[180:183], v[32:47]
    ds_read_b64_tr_b16 a[208:209], v188 offset:12288
    ds_read_b64_tr_b16 a[210:211], v188 offset:15360
    s_add_u32 m0, s28, 4096
    v_mfma_f32_32x32x16_bf16 v[48:63], a[220:223], a[180:183], v[48:63]
    ds_read_b64_tr_b16 a[212:213], v189 offset:12352
    ds_read_b64_tr_b16 a[214:215], v189 offset:15424
    buffer_load_dwordx4 v186, s[12:15], s33 offen lds
    s_waitcnt lgkmcnt(4)
    v_mfma_f32_32x32x16_bf16 v[64:79], a[224:227], a[180:183], v[64:79]
    ds_read_b64_tr_b16 a[216:217], v188 offset:12416
    ds_read_b64_tr_b16 a[218:219], v188 offset:15488
    s_add_u32 m0, s28, 5120
    v_mfma_f32_32x32x16_bf16 v[80:95], a[228:231], a[180:183], v[80:95]
    ds_read_b64_tr_b16 a[220:221], v189 offset:12480
    ds_read_b64_tr_b16 a[222:223], v189 offset:15552
    buffer_load_dwordx4 v187, s[12:15], s33 offen lds
    s_waitcnt lgkmcnt(4)
    v_mfma_f32_32x32x16_bf16 v[0:15], a[208:211], a[184:187], v[0:15]
    ds_read_b64_tr_b16 a[224:225], v188 offset:12544
    ds_read_b64_tr_b16 a[226:227], v188 offset:15616
    buffer_load_dwordx4 a[160:163], v184, s[8:11], s6 offen offset:0
    v_mfma_f32_32x32x16_bf16 v[16:31], a[212:215], a[184:187], v[16:31]
    ds_read_b64_tr_b16 a[228:229], v189 offset:12608
    ds_read_b64_tr_b16 a[230:231], v189 offset:15680
    s_add_u32 s55, s50, 12288
    buffer_load_dwordx4 a[48:51], v184, s[20:23], s55 offen
    s_waitcnt lgkmcnt(4)
    v_mfma_f32_32x32x16_bf16 v[32:47], a[216:219], a[184:187], v[32:47]
    ds_read_b64_tr_b16 a[208:209], v188 offset:18432
    ds_read_b64_tr_b16 a[210:211], v188 offset:21504
    buffer_load_dwordx4 a[164:167], v184, s[8:11], s6 offen offset:1024
    v_mfma_f32_32x32x16_bf16 v[48:63], a[220:223], a[184:187], v[48:63]
    ds_read_b64_tr_b16 a[212:213], v189 offset:18496
    ds_read_b64_tr_b16 a[214:215], v189 offset:21568
    s_add_u32 s55, s50, 13312
    buffer_load_dwordx4 a[52:55], v184, s[20:23], s55 offen
    s_waitcnt lgkmcnt(4)
    v_mfma_f32_32x32x16_bf16 v[64:79], a[224:227], a[184:187], v[64:79]
    ds_read_b64_tr_b16 a[216:217], v188 offset:18560
    ds_read_b64_tr_b16 a[218:219], v188 offset:21632
    buffer_load_dwordx4 a[168:171], v184, s[8:11], s6 offen offset:2048
    v_mfma_f32_32x32x16_bf16 v[80:95], a[228:231], a[184:187], v[80:95]
    ds_read_b64_tr_b16 a[220:221], v189 offset:18624
    ds_read_b64_tr_b16 a[222:223], v189 offset:21696
    s_waitcnt lgkmcnt(4)
    v_mfma_f32_32x32x16_bf16 v[0:15], a[208:211], a[188:191], v[0:15]
    ds_read_b64_tr_b16 a[224:225], v188 offset:18688
    ds_read_b64_tr_b16 a[226:227], v188 offset:21760
    buffer_load_dwordx4 a[172:175], v184, s[8:11], s6 offen offset:3072
    v_mfma_f32_32x32x16_bf16 v[16:31], a[212:215], a[188:191], v[16:31]
    ds_read_b64_tr_b16 a[228:229], v189 offset:18752
    ds_read_b64_tr_b16 a[230:231], v189 offset:21824
    s_waitcnt lgkmcnt(4)
    v_mfma_f32_32x32x16_bf16 v[32:47], a[216:219], a[188:191], v[32:47]
    s_add_u32 s6, s6, 4096
    s_add_u32 s32, s32, 73728
    s_add_u32 s33, s33, 73728
    v_mfma_f32_32x32x16_bf16 v[48:63], a[220:223], a[188:191], v[48:63]
    s_add_u32 s7, s7, 24576
    s_cmp_eq_u32 s7, 122880
    s_cselect_b32 s7, 0, s7
    v_add_u32 v188, s7, v190
    v_add_u32 v189, s7, v191
    s_waitcnt lgkmcnt(0)
    v_mfma_f32_32x32x16_bf16 v[64:79], a[224:227], a[188:191], v[64:79]
    s_waitcnt vmcnt(30) lgkmcnt(0)
    s_barrier
    ds_read_b64_tr_b16 a[208:209], v188 offset:0
    ds_read_b64_tr_b16 a[210:211], v188 offset:3072
    ds_read_b64_tr_b16 a[212:213], v189 offset:64
    ds_read_b64_tr_b16 a[214:215], v189 offset:3136
    v_mfma_f32_32x32x16_bf16 v[80:95], a[228:231], a[188:191], v[80:95]
    ds_read_b64_tr_b16 a[216:217], v188 offset:128
    ds_read_b64_tr_b16 a[218:219], v188 offset:3200
    ds_read_b64_tr_b16 a[220:221], v189 offset:192
    ds_read_b64_tr_b16 a[222:223], v189 offset:3264
    s_add_u32 s28, s28, 24576
    s_sub_u32 s44, s28, s43
    s_cmp_eq_u32 s44, 122880
    s_cselect_b32 s28, s43, s28
gm_l2_kernel_st7:
    s_waitcnt vmcnt(24)
    s_waitcnt lgkmcnt(4)
    v_mfma_f32_32x32x16_bf16 v[0:15], a[208:211], a[192:195], v[0:15]
    ds_read_b64_tr_b16 a[224:225], v188 offset:256
    ds_read_b64_tr_b16 a[226:227], v188 offset:3328
    s_add_u32 m0, s28, 0
    v_mfma_f32_32x32x16_bf16 v[16:31], a[212:215], a[192:195], v[16:31]
    ds_read_b64_tr_b16 a[228:229], v189 offset:320
    ds_read_b64_tr_b16 a[230:231], v189 offset:3392
    buffer_load_dwordx4 v185, s[12:15], s32 offen lds
    s_waitcnt lgkmcnt(4)
    v_mfma_f32_32x32x16_bf16 v[32:47], a[216:219], a[192:195], v[32:47]
    ds_read_b64_tr_b16 a[208:209], v188 offset:6144
    ds_read_b64_tr_b16 a[210:211], v188 offset:9216
    s_add_u32 m0, s28, 1024
    v_mfma_f32_32x32x16_bf16 v[48:63], a[220:223], a[192:195], v[48:63]
    ds_read_b64_tr_b16 a[212:213], v189 offset:6208
    ds_read_b64_tr_b16 a[214:215], v189 offset:9280
    buffer_load_dwordx4 v186, s[12:15], s32 offen lds
    s_waitcnt lgkmcnt(4)
    v_mfma_f32_32x32x16_bf16 v[64:79], a[224:227], a[192:195], v[64:79]
    ds_read_b64_tr_b16 a[216:217], v188 offset:6272
    ds_read_b64_tr_b16 a[218:219], v188 offset:9344
    s_add_u32 m0, s28, 2048
    v_mfma_f32_32x32x16_bf16 v[80:95], a[228:231], a[192:195], v[80:95]
    ds_read_b64_tr_b16 a[220:221], v189 offset:6336
    ds_read_b64_tr_b16 a[222:223], v189 offset:9408
    buffer_load_dwordx4 v187, s[12:15], s32 offen lds
    s_waitcnt lgkmcnt(4)
    v_mfma_f32_32x32x16_bf16 v[0:15], a[208:211], a[196:199], v[0:15]
    ds_read_b64_tr_b16 a[224:225], v188 offset:6400
    ds_read_b64_tr_b16 a[226:227], v188 offset:9472
    s_add_u32 m0, s28, 3072
    v_mfma_f32_32x32x16_bf16 v[16:31], a[212:215], a[196:199], v[16:31]
    ds_read_b64_tr_b16 a[228:229], v189 offset:6464
    ds_read_b64_tr_b16 a[230:231], v189 offset:9536
    buffer_load_dwordx4 v185, s[12:15], s33 offen lds
    s_waitcnt lgkmcnt(4)
    v_mfma_f32_32x32x16_bf16 v[32:47], a[216:219], a[196:199], v[32:47]
    ds_read_b64_tr_b16 a[208:209], v188 offset:12288
    ds_read_b64_tr_b16 a[210:211], v188 offset:15360
    s_add_u32 m0, s28, 4096
    v_mfma_f32_32x32x16_bf16 v[48:63], a[220:223], a[196:199], v[48:63]
    ds_read_b64_tr_b16 a[212:213], v189 offset:12352
    ds_read_b64_tr_b16 a[214:215], v189 offset:15424
    buffer_load_dwordx4 v186, s[12:15], s33 offen lds
    s_waitcnt lgkmcnt(4)
    v_mfma_f32_32x32x16_bf16 v[64:79], a[224:227], a[196:199], v[64:79]
    ds_read_b64_tr_b16 a[216:217], v188 offset:12416
    ds_read_b64_tr_b16 a[218:219], v188 offset:15488
    s_add_u32 m0, s28, 5120
    v_mfma_f32_32x32x16_bf16 v[80:95], a[228:231], a[196:199], v[80:95]
    ds_read_b64_tr_b16 a[220:221], v189 offset:12480
    ds_read_b64_tr_b16 a[222:223], v189 offset:15552
    buffer_load_dwordx4 v187, s[12:15], s33 offen lds
    s_waitcnt lgkmcnt(4)
    v_mfma_f32_32x32x16_bf16 v[0:15], a[208:211], a[200:203], v[0:15]
    ds_read_b64_tr_b16 a[224:225], v188 offset:12544
    ds_read_b64_tr_b16 a[226:227], v188 offset:15616
    buffer_load_dwordx4 a[176:179], v184, s[8:11], s6 offen offset:0
    v_mfma_f32_32x32x16_bf16 v[16:31], a[212:215], a[200:203], v[16:31]
    ds_read_b64_tr_b16 a[228:229], v189 offset:12608
    ds_read_b64_tr_b16 a[230:231], v189 offset:15680
    s_add_u32 s55, s50, 14336
    buffer_load_dwordx4 a[56:59], v184, s[20:23], s55 offen
    s_waitcnt lgkmcnt(4)
    v_mfma_f32_32x32x16_bf16 v[32:47], a[216:219], a[200:203], v[32:47]
    ds_read_b64_tr_b16 a[208:209], v188 offset:18432
    ds_read_b64_tr_b16 a[210:211], v188 offset:21504
    buffer_load_dwordx4 a[180:183], v184, s[8:11], s6 offen offset:1024
    v_mfma_f32_32x32x16_bf16 v[48:63], a[220:223], a[200:203], v[48:63]
    ds_read_b64_tr_b16 a[212:213], v189 offset:18496
    ds_read_b64_tr_b16 a[214:215], v189 offset:21568
    s_add_u32 s55, s50, 15360
    buffer_load_dwordx4 a[60:63], v184, s[20:23], s55 offen
    s_waitcnt lgkmcnt(4)
    v_mfma_f32_32x32x16_bf16 v[64:79], a[224:227], a[200:203], v[64:79]
    ds_read_b64_tr_b16 a[216:217], v188 offset:18560
    ds_read_b64_tr_b16 a[218:219], v188 offset:21632
    buffer_load_dwordx4 a[184:187], v184, s[8:11], s6 offen offset:2048
    v_mfma_f32_32x32x16_bf16 v[80:95], a[228:231], a[200:203], v[80:95]
    ds_read_b64_tr_b16 a[220:221], v189 offset:18624
    ds_read_b64_tr_b16 a[222:223], v189 offset:21696
    s_waitcnt lgkmcnt(4)
    v_mfma_f32_32x32x16_bf16 v[0:15], a[208:211], a[204:207], v[0:15]
    ds_read_b64_tr_b16 a[224:225], v188 offset:18688
    ds_read_b64_tr_b16 a[226:227], v188 offset:21760
    buffer_load_dwordx4 a[188:191], v184, s[8:11], s6 offen offset:3072
    v_mfma_f32_32x32x16_bf16 v[16:31], a[212:215], a[204:207], v[16:31]
    ds_read_b64_tr_b16 a[228:229], v189 offset:18752
    ds_read_b64_tr_b16 a[230:231], v189 offset:21824
    s_waitcnt lgkmcnt(4)
    v_mfma_f32_32x32x16_bf16 v[32:47], a[216:219], a[204:207], v[32:47]
    s_add_u32 s6, s6, 4096
    s_add_u32 s32, s32, 73728
    s_add_u32 s33, s33, 73728
    v_mfma_f32_32x32x16_bf16 v[48:63], a[220:223], a[204:207], v[48:63]
    s_add_u32 s7, s7, 24576
    s_cmp_eq_u32 s7, 122880
    s_cselect_b32 s7, 0, s7
    v_add_u32 v188, s7, v190
    v_add_u32 v189, s7, v191
    s_waitcnt lgkmcnt(0)
    v_mfma_f32_32x32x16_bf16 v[64:79], a[224:227], a[204:207], v[64:79]
    s_waitcnt vmcnt(30) lgkmcnt(0)
    s_barrier
    ds_read_b64_tr_b16 a[208:209], v188 offset:0
    ds_read_b64_tr_b16 a[210:211], v188 offset:3072
    ds_read_b64_tr_b16 a[212:213], v189 offset:64
    ds_read_b64_tr_b16 a[214:215], v189 offset:3136
    v_mfma_f32_32x32x16_bf16 v[80:95], a[228:231], a[204:207], v[80:95]
    ds_read_b64_tr_b16 a[216:217], v188 offset:128
    ds_read_b64_tr_b16 a[218:219], v188 offset:3200
    ds_read_b64_tr_b16 a[220:221], v189 offset:192
    ds_read_b64_tr_b16 a[222:223], v189 offset:3264
    s_add_u32 s28, s28, 24576
    s_sub_u32 s44, s28, s43
    s_cmp_eq_u32 s44, 122880
    s_cselect_b32 s28, s43, s28
gm_l2_kernel_st8:
    s_waitcnt vmcnt(24)
    s_waitcnt lgkmcnt(4)
    v_mfma_f32_32x32x16_bf16 v[0:15], a[208:211], a[144:147], v[0:15]
    ds_read_b64_tr_b16 a[224:225], v188 offset:256
    ds_read_b64_tr_b16 a[226:227], v188 offset:3328
    s_add_u32 m0, s28, 0
    v_mfma_f32_32x32x16_bf16 v[16:31], a[212:215], a[144:147], v[16:31]
    ds_read_b64_tr_b16 a[228:229], v189 offset:320
    ds_read_b64_tr_b16 a[230:231], v189 offset:3392
    buffer_load_dwordx4 v185, s[12:15], s32 offen lds
    s_waitcnt lgkmcnt(4)
    v_mfma_f32_32x32x16_bf16 v[32:47], a[216:219], a[144:147], v[32:47]
    ds_read_b64_tr_b16 a[208:209], v188 offset:6144
    ds_read_b64_tr_b16 a[210:211], v188 offset:9216
    s_add_u32 m0, s28, 1024
    v_mfma_f32_32x32x16_bf16 v[48:63], a[220:223], a[144:147], v[48:63]
    ds_read_b64_tr_b16 a[212:213], v189 offset:6208
    ds_read_b64_tr_b16 a[214:215], v189 offset:9280
    buffer_load_dwordx4 v186, s[12:15], s32 offen lds
    s_waitcnt lgkmcnt(4)
    v_mfma_f32_32x32x16_bf16 v[64:79], a[224:227], a[144:147], v[64:79]
    ds_read_b64_tr_b16 a[216:217], v188 offset:6272
    ds_read_b64_tr_b16 a[218:219], v188 offset:9344
    s_add_u32 m0, s28, 2048
    v_mfma_f32_32x32x16_bf16 v[80:95], a[228:231], a[144:147], v[80:95]
    ds_read_b64_tr_b16 a[220:221], v189 offset:6336
    ds_read_b64_tr_b16 a[222:223], v189 offset:9408
    buffer_load_dwordx4 v187, s[12:15], s32 offen lds
    s_waitcnt lgkmcnt(4)
    v_mfma_f32_32x32x16_bf16 v[0:15], a[208:211], a[148:151], v[0:15]
    ds_read_b64_tr_b16 a[224:225], v188 offset:6400
    ds_read_b64_tr_b16 a[226:227], v188 offset:9472
    s_add_u32 m0, s28, 3072
    v_mfma_f32_32x32x16_bf16 v[16:31], a[212:215], a[148:151], v[16:31]
    ds_read_b64_tr_b16 a[228:229], v189 offset:6464
    ds_read_b64_tr_b16 a[230:231], v189 offset:9536
    buffer_load_dwordx4 v185, s[12:15], s33 offen lds
    s_waitcnt lgkmcnt(4)
    v_mfma_f32_32x32x16_bf16 v[32:47], a[216:219], a[148:151], v[32:47]
    ds_read_b64_tr_b16 a[208:209], v188 offset:12288
    ds_read_b64_tr_b16 a[210:211], v188 offset:15360
    s_add_u32 m0, s28, 4096
    v_mfma_f32_32x32x16_bf16 v[48:63], a[220:223], a[148:151], v[48:63]
    ds_read_b64_tr_b16 a[212:213], v189 offset:12352
    ds_read_b64_tr_b16 a[214:215], v189 offset:15424
    buffer_load_dwordx4 v186, s[12:15], s33 offen lds
    s_waitcnt lgkmcnt(4)
    v_mfma_f32_32x32x16_bf16 v[64:79], a[224:227], a[148:151], v[64:79]
    ds_read_b64_tr_b16 a[216:217], v188 offset:12416
    ds_read_b64_tr_b16 a[218:219], v188 offset:15488
    s_add_u32 m0, s28, 5120
    v_mfma_f32_32x32x16_bf16 v[80:95], a[228:231], a[148:151], v[80:95]
    ds_read_b64_tr_b16 a[220:221], v189 offset:12480
    ds_read_b64_tr_b16 a[222:223], v189 offset:15552
    buffer_load_dwordx4 v187, s[12:15], s33 offen lds
    s_waitcnt lgkmcnt(4)
    v_mfma_f32_32x32x16_bf16 v[0:15], a[208:211], a[152:155], v[0:15]
    ds_read_b64_tr_b16 a[224:225], v188 offset:12544
    ds_read_b64_tr_b16 a[226:227], v188 offset:15616
    buffer_load_dwordx4 a[192:195], v184, s[8:11], s6 offen offset:0
    v_mfma_f32_32x32x16_bf16 v[16:31], a[212:215], a[152:155], v[16:31]
    ds_read_b64_tr_b16 a[228:229], v189 offset:12608
    ds_read_b64_tr_b16 a[230:231], v189 offset:15680
    s_add_u32 s55, s50, 16384
    buffer_load_dwordx4 a[64:67], v184, s[20:23], s55 offen
    s_waitcnt lgkmcnt(4)
    v_mfma_f32_32x32x16_bf16 v[32:47], a[216:219], a[152:155], v[32:47]
    ds_read_b64_tr_b16 a[208:209], v188 offset:18432
    ds_read_b64_tr_b16 a[210:211], v188 offset:21504
    buffer_load_dwordx4 a[196:199], v184, s[8:11], s6 offen offset:1024
    v_mfma_f32_32x32x16_bf16 v[48:63], a[220:223], a[152:155], v[48:63]
    ds_read_b64_tr_b16 a[212:213], v189 offset:18496
    ds_read_b64_tr_b16 a[214:215], v189 offset:21568
    s_add_u32 s55, s50, 17408
    buffer_load_dwordx4 a[68:71], v184, s[20:23], s55 offen
    s_waitcnt lgkmcnt(4)
    v_mfma_f32_32x32x16_bf16 v[64:79], a[224:227], a[152:155], v[64:79]
    ds_read_b64_tr_b16 a[216:217], v188 offset:18560
    ds_read_b64_tr_b16 a[218:219], v188 offset:21632
    buffer_load_dwordx4 a[200:203], v184, s[8:11], s6 offen offset:2048
    v_mfma_f32_32x32x16_bf16 v[80:95], a[228:231], a[152:155], v[80:95]
    ds_read_b64_tr_b16 a[220:221], v189 offset:18624
    ds_read_b64_tr_b16 a[222:223], v189 offset:21696
    s_waitcnt lgkmcnt(4)
    v_mfma_f32_32x32x16_bf16 v[0:15], a[208:211], a[156:159], v[0:15]
    ds_read_b64_tr_b16 a[224:225], v188 offset:18688
    ds_read_b64_tr_b16 a[226:227], v188 offset:21760
    buffer_load_dwordx4 a[204:207], v184, s[8:11], s6 offen offset:3072
    v_mfma_f32_32x32x16_bf16 v[16:31], a[212:215], a[156:159], v[16:31]
    ds_read_b64_tr_b16 a[228:229], v189 offset:18752
    ds_read_b64_tr_b16 a[230:231], v189 offset:21824
    s_waitcnt lgkmcnt(4)
    v_mfma_f32_32x32x16_bf16 v[32:47], a[216:219], a[156:159], v[32:47]
    s_add_u32 s6, s6, 4096
    s_add_u32 s32, s32, 73728
    s_add_u32 s33, s33, 73728
    v_mfma_f32_32x32x16_bf16 v[48:63], a[220:223], a[156:159], v[48:63]
    s_add_u32 s7, s7, 24576
    s_cmp_eq_u32 s7, 122880
    s_cselect_b32 s7, 0, s7
    v_add_u32 v188, s7, v190
    v_add_u32 v189, s7, v191
    s_waitcnt lgkmcnt(0)
    v_mfma_f32_32x32x16_bf16 v[64:79], a[224:227], a[156:159], v[64:79]
    s_waitcnt vmcnt(30) lgkmcnt(0)
    s_barrier
    ds_read_b64_tr_b16 a[208:209], v188 offset:0
    ds_read_b64_tr_b16 a[210:211], v188 offset:3072
    ds_read_b64_tr_b16 a[212:213], v189 offset:64
    ds_read_b64_tr_b16 a[214:215], v189 offset:3136
    v_mfma_f32_32x32x16_bf16 v[80:95], a[228:231], a[156:159], v[80:95]
    ds_read_b64_tr_b16 a[216:217], v188 offset:128
    ds_read_b64_tr_b16 a[218:219], v188 offset:3200
    ds_read_b64_tr_b16 a[220:221], v189 offset:192
    ds_read_b64_tr_b16 a[222:223], v189 offset:3264
    s_add_u32 s28, s28, 24576
    s_sub_u32 s44, s28, s43
    s_cmp_eq_u32 s44, 122880
    s_cselect_b32 s28, s43, s28
gm_l2_kernel_st9:
    s_waitcnt vmcnt(24)
    s_waitcnt lgkmcnt(4)
    v_mfma_f32_32x32x16_bf16 v[0:15], a[208:211], a[160:163], v[0:15]
    ds_read_b64_tr_b16 a[224:225], v188 offset:256
    ds_read_b64_tr_b16 a[226:227], v188 offset:3328
    s_add_u32 m0, s28, 0
    v_mfma_f32_32x32x16_bf16 v[16:31], a[212:215], a[160:163], v[16:31]
    ds_read_b64_tr_b16 a[228:229], v189 offset:320
    ds_read_b64_tr_b16 a[230:231], v189 offset:3392
    buffer_load_dwordx4 v185, s[12:15], s32 offen lds
    s_waitcnt lgkmcnt(4)
    v_mfma_f32_32x32x16_bf16 v[32:47], a[216:219], a[160:163], v[32:47]
    ds_read_b64_tr_b16 a[208:209], v188 offset:6144
    ds_read_b64_tr_b16 a[210:211], v188 offset:9216
    s_add_u32 m0, s28, 1024
    v_mfma_f32_32x32x16_bf16 v[48:63], a[220:223], a[160:163], v[48:63]
    ds_read_b64_tr_b16 a[212:213], v189 offset:6208
    ds_read_b64_tr_b16 a[214:215], v189 offset:9280
    buffer_load_dwordx4 v186, s[12:15], s32 offen lds
    s_waitcnt lgkmcnt(4)
    v_mfma_f32_32x32x16_bf16 v[64:79], a[224:227], a[160:163], v[64:79]
    ds_read_b64_tr_b16 a[216:217], v188 offset:6272
    ds_read_b64_tr_b16 a[218:219], v188 offset:9344
    s_add_u32 m0, s28, 2048
    v_mfma_f32_32x32x16_bf16 v[80:95], a[228:231], a[160:163], v[80:95]
    ds_read_b64_tr_b16 a[220:221], v189 offset:6336
    ds_read_b64_tr_b16 a[222:223], v189 offset:9408
    buffer_load_dwordx4 v187, s[12:15], s32 offen lds
    s_waitcnt lgkmcnt(4)
    v_mfma_f32_32x32x16_bf16 v[0:15], a[208:211], a[164:167], v[0:15]
    ds_read_b64_tr_b16 a[224:225], v188 offset:6400
    ds_read_b64_tr_b16 a[226:227], v188 offset:9472
    s_add_u32 m0, s28, 3072
    v_mfma_f32_32x32x16_bf16 v[16:31], a[212:215], a[164:167], v[16:31]
    ds_read_b64_tr_b16 a[228:229], v189 offset:6464
    ds_read_b64_tr_b16 a[230:231], v189 offset:9536
    buffer_load_dwordx4 v185, s[12:15], s33 offen lds
    s_waitcnt lgkmcnt(4)
    v_mfma_f32_32x32x16_bf16 v[32:47], a[216:219], a[164:167], v[32:47]
    ds_read_b64_tr_b16 a[208:209], v188 offset:12288
    ds_read_b64_tr_b16 a[210:211], v188 offset:15360
    s_add_u32 m0, s28, 4096
    v_mfma_f32_32x32x16_bf16 v[48:63], a[220:223], a[164:167], v[48:63]
    ds_read_b64_tr_b16 a[212:213], v189 offset:12352
    ds_read_b64_tr_b16 a[214:215], v189 offset:15424
    buffer_load_dwordx4 v186, s[12:15], s33 offen lds
    s_waitcnt lgkmcnt(4)
    v_mfma_f32_32x32x16_bf16 v[64:79], a[224:227], a[164:167], v[64:79]
    ds_read_b64_tr_b16 a[216:217], v188 offset:12416
    ds_read_b64_tr_b16 a[218:219], v188 offset:15488
    s_add_u32 m0, s28, 5120
    v_mfma_f32_32x32x16_bf16 v[80:95], a[228:231], a[164:167], v[80:95]
    ds_read_b64_tr_b16 a[220:221], v189 offset:12480
    ds_read_b64_tr_b16 a[222:223], v189 offset:15552
    buffer_load_dwordx4 v187, s[12:15], s33 offen lds
    s_waitcnt lgkmcnt(4)
    v_mfma_f32_32x32x16_bf16 v[0:15], a[208:211], a[168:171], v[0:15]
    ds_read_b64_tr_b16 a[224:225], v188 offset:12544
    ds_read_b64_tr_b16 a[226:227], v188 offset:15616
    buffer_load_dwordx4 a[144:147], v184, s[8:11], s6 offen offset:0
    v_mfma_f32_32x32x16_bf16 v[16:31], a[212:215], a[168:171], v[16:31]
    ds_read_b64_tr_b16 a[228:229], v189 offset:12608
    ds_read_b64_tr_b16 a[230:231], v189 offset:15680
    s_add_u32 s55, s50, 18432
    buffer_load_dwordx4 a[72:75], v184, s[20:23], s55 offen
    s_waitcnt lgkmcnt(4)
    v_mfma_f32_32x32x16_bf16 v[32:47], a[216:219], a[168:171], v[32:47]
    ds_read_b64_tr_b16 a[208:209], v188 offset:18432
    ds_read_b64_tr_b16 a[210:211], v188 offset:21504
    buffer_load_dwordx4 a[148:151], v184, s[8:11], s6 offen offset:1024
    v_mfma_f32_32x32x16_bf16 v[48:63], a[220:223], a[168:171], v[48:63]
    ds_read_b64_tr_b16 a[212:213], v189 offset:18496
    ds_read_b64_tr_b16 a[214:215], v189 offset:21568
    s_add_u32 s55, s50, 19456
    buffer_load_dwordx4 a[76:79], v184, s[20:23], s55 offen
    s_waitcnt lgkmcnt(4)
    v_mfma_f32_32x32x16_bf16 v[64:79], a[224:227], a[168:171], v[64:79]
    ds_read_b64_tr_b16 a[216:217], v188 offset:18560
    ds_read_b64_tr_b16 a[218:219], v188 offset:21632
    buffer_load_dwordx4 a[152:155], v184, s[8:11], s6 offen offset:2048
    v_mfma_f32_32x32x16_bf16 v[80:95], a[228:231], a[168:171], v[80:95]
    ds_read_b64_tr_b16 a[220:221], v189 offset:18624
    ds_read_b64_tr_b16 a[222:223], v189 offset:21696
    s_waitcnt lgkmcnt(4)
    v_mfma_f32_32x32x16_bf16 v[0:15], a[208:211], a[172:175], v[0:15]
    ds_read_b64_tr_b16 a[224:225], v188 offset:18688
    ds_read_b64_tr_b16 a[226:227], v188 offset:21760
    buffer_load_dwordx4 a[156:159], v184, s[8:11], s6 offen offset:3072
    v_mfma_f32_32x32x16_bf16 v[16:31], a[212:215], a[172:175], v[16:31]
    ds_read_b64_tr_b16 a[228:229], v189 offset:18752
    ds_read_b64_tr_b16 a[230:231], v189 offset:21824
    s_waitcnt lgkmcnt(4)
    v_mfma_f32_32x32x16_bf16 v[32:47], a[216:219], a[172:175], v[32:47]
    s_add_u32 s6, s6, 4096
    s_add_u32 s32, s32, 73728
    s_add_u32 s33, s33, 73728
    v_mfma_f32_32x32x16_bf16 v[48:63], a[220:223], a[172:175], v[48:63]
    s_add_u32 s7, s7, 24576
    s_cmp_eq_u32 s7, 122880
    s_cselect_b32 s7, 0, s7
    v_add_u32 v188, s7, v190
    v_add_u32 v189, s7, v191
    s_waitcnt lgkmcnt(0)
    v_mfma_f32_32x32x16_bf16 v[64:79], a[224:227], a[172:175], v[64:79]
    s_waitcnt vmcnt(30) lgkmcnt(0)
    s_barrier
    ds_read_b64_tr_b16 a[208:209], v188 offset:0
    ds_read_b64_tr_b16 a[210:211], v188 offset:3072
    ds_read_b64_tr_b16 a[212:213], v189 offset:64
    ds_read_b64_tr_b16 a[214:215], v189 offset:3136
    v_mfma_f32_32x32x16_bf16 v[80:95], a[228:231], a[172:175], v[80:95]
    ds_read_b64_tr_b16 a[216:217], v188 offset:128
    ds_read_b64_tr_b16 a[218:219], v188 offset:3200
    ds_read_b64_tr_b16 a[220:221], v189 offset:192
    ds_read_b64_tr_b16 a[222:223], v189 offset:3264
    s_add_u32 s28, s28, 24576
    s_sub_u32 s44, s28, s43
    s_cmp_eq_u32 s44, 122880
    s_cselect_b32 s28, s43, s28
gm_l2_kernel_st10:
    s_waitcnt vmcnt(24)
    s_waitcnt lgkmcnt(4)
    v_mfma_f32_32x32x16_bf16 v[0:15], a[208:211], a[176:179], v[0:15]
    ds_read_b64_tr_b16 a[224:225], v188 offset:256
    ds_read_b64_tr_b16 a[226:227], v188 offset:3328
    s_add_u32 m0, s28, 0
    v_mfma_f32_32x32x16_bf16 v[16:31], a[212:215], a[176:179], v[16:31]
    ds_read_b64_tr_b16 a[228:229], v189 offset:320
    ds_read_b64_tr_b16 a[230:231], v189 offset:3392
    buffer_load_dwordx4 v185, s[12:15], s32 offen lds
    s_waitcnt lgkmcnt(4)
    v_mfma_f32_32x32x16_bf16 v[32:47], a[216:219], a[176:179], v[32:47]
    ds_read_b64_tr_b16 a[208:209], v188 offset:6144
    ds_read_b64_tr_b16 a[210:211], v188 offset:9216
    s_add_u32 m0, s28, 1024
    v_mfma_f32_32x32x16_bf16 v[48:63], a[220:223], a[176:179], v[48:63]
    ds_read_b64_tr_b16 a[212:213], v189 offset:6208
    ds_read_b64_tr_b16 a[214:215], v189 offset:9280
    buffer_load_dwordx4 v186, s[12:15], s32 offen lds
    s_waitcnt lgkmcnt(4)
    v_mfma_f32_32x32x16_bf16 v[64:79], a[224:227], a[176:179], v[64:79]
    ds_read_b64_tr_b16 a[216:217], v188 offset:6272
    ds_read_b64_tr_b16 a[218:219], v188 offset:9344
    s_add_u32 m0, s28, 2048
    v_mfma_f32_32x32x16_bf16 v[80:95], a[228:231], a[176:179], v[80:95]
    ds_read_b64_tr_b16 a[220:221], v189 offset:6336
    ds_read_b64_tr_b16 a[222:223], v189 offset:9408
    buffer_load_dwordx4 v187, s[12:15], s32 offen lds
    s_waitcnt lgkmcnt(4)
    v_mfma_f32_32x32x16_bf16 v[0:15], a[208:211], a[180:183], v[0:15]
    ds_read_b64_tr_b16 a[224:225], v188 offset:6400
    ds_read_b64_tr_b16 a[226:227], v188 offset:9472
    s_add_u32 m0, s28, 3072
    v_mfma_f32_32x32x16_bf16 v[16:31], a[212:215], a[180:183], v[16:31]
    ds_read_b64_tr_b16 a[228:229], v189 offset:6464
    ds_read_b64_tr_b16 a[230:231], v189 offset:9536
    buffer_load_dwordx4 v185, s[12:15], s33 offen lds
    s_waitcnt lgkmcnt(4)
    v_mfma_f32_32x32x16_bf16 v[32:47], a[216:219], a[180:183], v[32:47]
    ds_read_b64_tr_b16 a[208:209], v188 offset:12288
    ds_read_b64_tr_b16 a[210:211], v188 offset:15360
    s_add_u32 m0, s28, 4096
    v_mfma_f32_32x32x16_bf16 v[48:63], a[220:223], a[180:183], v[48:63]
    ds_read_b64_tr_b16 a[212:213], v189 offset:12352
    ds_read_b64_tr_b16 a[214:215], v189 offset:15424
    buffer_load_dwordx4 v186, s[12:15], s33 offen lds
    s_waitcnt lgkmcnt(4)
    v_mfma_f32_32x32x16_bf16 v[64:79], a[224:227], a[180:183], v[64:79]
    ds_read_b64_tr_b16 a[216:217], v188 offset:12416
    ds_read_b64_tr_b16 a[218:219], v188 offset:15488
    s_add_u32 m0, s28, 5120
    v_mfma_f32_32x32x16_bf16 v[80:95], a[228:231], a[180:183], v[80:95]
    ds_read_b64_tr_b16 a[220:221], v189 offset:12480
    ds_read_b64_tr_b16 a[222:223], v189 offset:15552
    buffer_load_dwordx4 v187, s[12:15], s33 offen lds
    s_waitcnt lgkmcnt(4)
    v_mfma_f32_32x32x16_bf16 v[0:15], a[208:211], a[184:187], v[0:15]
    ds_read_b64_tr_b16 a[224:225], v188 offset:12544
    ds_read_b64_tr_b16 a[226:227], v188 offset:15616
    buffer_load_dwordx4 a[160:163], v184, s[8:11], s6 offen offset:0
    v_mfma_f32_32x32x16_bf16 v[16:31], a[212:215], a[184:187], v[16:31]
    ds_read_b64_tr_b16 a[228:229], v189 offset:12608
    ds_read_b64_tr_b16 a[230:231], v189 offset:15680
    s_add_u32 s55, s50, 20480
    buffer_load_dwordx4 a[80:83], v184, s[20:23], s55 offen
    s_waitcnt lgkmcnt(4)
    v_mfma_f32_32x32x16_bf16 v[32:47], a[216:219], a[184:187], v[32:47]
    ds_read_b64_tr_b16 a[208:209], v188 offset:18432
    ds_read_b64_tr_b16 a[210:211], v188 offset:21504
    buffer_load_dwordx4 a[164:167], v184, s[8:11], s6 offen offset:1024
    v_mfma_f32_32x32x16_bf16 v[48:63], a[220:223], a[184:187], v[48:63]
    ds_read_b64_tr_b16 a[212:213], v189 offset:18496
    ds_read_b64_tr_b16 a[214:215], v189 offset:21568
    s_add_u32 s55, s50, 21504
    buffer_load_dwordx4 a[84:87], v184, s[20:23], s55 offen
    s_waitcnt lgkmcnt(4)
    v_mfma_f32_32x32x16_bf16 v[64:79], a[224:227], a[184:187], v[64:79]
    ds_read_b64_tr_b16 a[216:217], v188 offset:18560
    ds_read_b64_tr_b16 a[218:219], v188 offset:21632
    buffer_load_dwordx4 a[168:171], v184, s[8:11], s6 offen offset:2048
    v_mfma_f32_32x32x16_bf16 v[80:95], a[228:231], a[184:187], v[80:95]
    ds_read_b64_tr_b16 a[220:221], v189 offset:18624
    ds_read_b64_tr_b16 a[222:223], v189 offset:21696
    s_waitcnt lgkmcnt(4)
    v_mfma_f32_32x32x16_bf16 v[0:15], a[208:211], a[188:191], v[0:15]
    ds_read_b64_tr_b16 a[224:225], v188 offset:18688
    ds_read_b64_tr_b16 a[226:227], v188 offset:21760
    buffer_load_dwordx4 a[172:175], v184, s[8:11], s6 offen offset:3072
    v_mfma_f32_32x32x16_bf16 v[16:31], a[212:215], a[188:191], v[16:31]
    ds_read_b64_tr_b16 a[228:229], v189 offset:18752
    ds_read_b64_tr_b16 a[230:231], v189 offset:21824
    s_waitcnt lgkmcnt(4)
    v_mfma_f32_32x32x16_bf16 v[32:47], a[216:219], a[188:191], v[32:47]
    s_add_u32 s6, s6, 4096
    s_add_u32 s32, s32, 73728
    s_add_u32 s33, s33, 73728
    v_mfma_f32_32x32x16_bf16 v[48:63], a[220:223], a[188:191], v[48:63]
    s_add_u32 s7, s7, 24576
    s_cmp_eq_u32 s7, 122880
    s_cselect_b32 s7, 0, s7
    v_add_u32 v188, s7, v190
    v_add_u32 v189, s7, v191
    s_waitcnt lgkmcnt(0)
    v_mfma_f32_32x32x16_bf16 v[64:79], a[224:227], a[188:191], v[64:79]
    s_waitcnt vmcnt(30) lgkmcnt(0)
    s_barrier
    ds_read_b64_tr_b16 a[208:209], v188 offset:0
    ds_read_b64_tr_b16 a[210:211], v188 offset:3072
    ds_read_b64_tr_b16 a[212:213], v189 offset:64
    ds_read_b64_tr_b16 a[214:215], v189 offset:3136
    v_mfma_f32_32x32x16_bf16 v[80:95], a[228:231], a[188:191], v[80:95]
    ds_read_b64_tr_b16 a[216:217], v188 offset:128
    ds_read_b64_tr_b16 a[218:219], v188 offset:3200
    ds_read_b64_tr_b16 a[220:221], v189 offset:192
    ds_read_b64_tr_b16 a[222:223], v189 offset:3264
    s_add_u32 s28, s28, 24576
    s_sub_u32 s44, s28, s43
    s_cmp_eq_u32 s44, 122880
    s_cselect_b32 s28, s43, s28
gm_l2_kernel_st11:
    s_waitcnt vmcnt(24)
    s_waitcnt lgkmcnt(4)
    v_mfma_f32_32x32x16_bf16 v[0:15], a[208:211], a[192:195], v[0:15]
    ds_read_b64_tr_b16 a[224:225], v188 offset:256
    ds_read_b64_tr_b16 a[226:227], v188 offset:3328
    s_add_u32 m0, s28, 0
    v_mfma_f32_32x32x16_bf16 v[16:31], a[212:215], a[192:195], v[16:31]
    ds_read_b64_tr_b16 a[228:229], v189 offset:320
    ds_read_b64_tr_b16 a[230:231], v189 offset:3392
    buffer_load_dwordx4 v185, s[12:15], s32 offen lds
    s_waitcnt lgkmcnt(4)
    v_mfma_f32_32x32x16_bf16 v[32:47], a[216:219], a[192:195], v[32:47]
    ds_read_b64_tr_b16 a[208:209], v188 offset:6144
    ds_read_b64_tr_b16 a[210:211], v188 offset:9216
    s_add_u32 m0, s28, 1024
    v_mfma_f32_32x32x16_bf16 v[48:63], a[220:223], a[192:195], v[48:63]
    ds_read_b64_tr_b16 a[212:213], v189 offset:6208
    ds_read_b64_tr_b16 a[214:215], v189 offset:9280
    buffer_load_dwordx4 v186, s[12:15], s32 offen lds
    s_waitcnt lgkmcnt(4)
    v_mfma_f32_32x32x16_bf16 v[64:79], a[224:227], a[192:195], v[64:79]
    ds_read_b64_tr_b16 a[216:217], v188 offset:6272
    ds_read_b64_tr_b16 a[218:219], v188 offset:9344
    s_add_u32 m0, s28, 2048
    v_mfma_f32_32x32x16_bf16 v[80:95], a[228:231], a[192:195], v[80:95]
    ds_read_b64_tr_b16 a[220:221], v189 offset:6336
    ds_read_b64_tr_b16 a[222:223], v189 offset:9408
    buffer_load_dwordx4 v187, s[12:15], s32 offen lds
    s_waitcnt lgkmcnt(4)
    v_mfma_f32_32x32x16_bf16 v[0:15], a[208:211], a[196:199], v[0:15]
    ds_read_b64_tr_b16 a[224:225], v188 offset:6400
    ds_read_b64_tr_b16 a[226:227], v188 offset:9472
    s_add_u32 m0, s28, 3072
    v_mfma_f32_32x32x16_bf16 v[16:31], a[212:215], a[196:199], v[16:31]
    ds_read_b64_tr_b16 a[228:229], v189 offset:6464
    ds_read_b64_tr_b16 a[230:231], v189 offset:9536
    buffer_load_dwordx4 v185, s[12:15], s33 offen lds
    s_waitcnt lgkmcnt(4)
    v_mfma_f32_32x32x16_bf16 v[32:47], a[216:219], a[196:199], v[32:47]
    ds_read_b64_tr_b16 a[208:209], v188 offset:12288
    ds_read_b64_tr_b16 a[210:211], v188 offset:15360
    s_add_u32 m0, s28, 4096
    v_mfma_f32_32x32x16_bf16 v[48:63], a[220:223], a[196:199], v[48:63]
    ds_read_b64_tr_b16 a[212:213], v189 offset:12352
    ds_read_b64_tr_b16 a[214:215], v189 offset:15424
    buffer_load_dwordx4 v186, s[12:15], s33 offen lds
    s_waitcnt lgkmcnt(4)
    v_mfma_f32_32x32x16_bf16 v[64:79], a[224:227], a[196:199], v[64:79]
    ds_read_b64_tr_b16 a[216:217], v188 offset:12416
    ds_read_b64_tr_b16 a[218:219], v188 offset:15488
    s_add_u32 m0, s28, 5120
    v_mfma_f32_32x32x16_bf16 v[80:95], a[228:231], a[196:199], v[80:95]
    ds_read_b64_tr_b16 a[220:221], v189 offset:12480
    ds_read_b64_tr_b16 a[222:223], v189 offset:15552
    buffer_load_dwordx4 v187, s[12:15], s33 offen lds
    s_waitcnt lgkmcnt(4)
    v_mfma_f32_32x32x16_bf16 v[0:15], a[208:211], a[200:203], v[0:15]
    ds_read_b64_tr_b16 a[224:225], v188 offset:12544
    ds_read_b64_tr_b16 a[226:227], v188 offset:15616
    buffer_load_dwordx4 a[176:179], v184, s[8:11], s6 offen offset:0
    v_mfma_f32_32x32x16_bf16 v[16:31], a[212:215], a[200:203], v[16:31]
    ds_read_b64_tr_b16 a[228:229], v189 offset:12608
    ds_read_b64_tr_b16 a[230:231], v189 offset:15680
    s_add_u32 s55, s50, 22528
    buffer_load_dwordx4 a[88:91], v184, s[20:23], s55 offen
    s_waitcnt lgkmcnt(4)
    v_mfma_f32_32x32x16_bf16 v[32:47], a[216:219], a[200:203], v[32:47]
    ds_read_b64_tr_b16 a[208:209], v188 offset:18432
    ds_read_b64_tr_b16 a[210:211], v188 offset:21504
    buffer_load_dwordx4 a[180:183], v184, s[8:11], s6 offen offset:1024
    v_mfma_f32_32x32x16_bf16 v[48:63], a[220:223], a[200:203], v[48:63]
    ds_read_b64_tr_b16 a[212:213], v189 offset:18496
    ds_read_b64_tr_b16 a[214:215], v189 offset:21568
    s_add_u32 s55, s50, 23552
    buffer_load_dwordx4 a[92:95], v184, s[20:23], s55 offen
    s_waitcnt lgkmcnt(4)
    v_mfma_f32_32x32x16_bf16 v[64:79], a[224:227], a[200:203], v[64:79]
    ds_read_b64_tr_b16 a[216:217], v188 offset:18560
    ds_read_b64_tr_b16 a[218:219], v188 offset:21632
    buffer_load_dwordx4 a[184:187], v184, s[8:11], s6 offen offset:2048
    v_mfma_f32_32x32x16_bf16 v[80:95], a[228:231], a[200:203], v[80:95]
    ds_read_b64_tr_b16 a[220:221], v189 offset:18624
    ds_read_b64_tr_b16 a[222:223], v189 offset:21696
    s_waitcnt lgkmcnt(4)
    v_mfma_f32_32x32x16_bf16 v[0:15], a[208:211], a[204:207], v[0:15]
    ds_read_b64_tr_b16 a[224:225], v188 offset:18688
    ds_read_b64_tr_b16 a[226:227], v188 offset:21760
    buffer_load_dwordx4 a[188:191], v184, s[8:11], s6 offen offset:3072
    v_mfma_f32_32x32x16_bf16 v[16:31], a[212:215], a[204:207], v[16:31]
    ds_read_b64_tr_b16 a[228:229], v189 offset:18752
    ds_read_b64_tr_b16 a[230:231], v189 offset:21824
    s_waitcnt lgkmcnt(4)
    v_mfma_f32_32x32x16_bf16 v[32:47], a[216:219], a[204:207], v[32:47]
    s_add_u32 s6, s6, 4096
    s_add_u32 s32, s32, 73728
    s_add_u32 s33, s33, 73728
    v_mfma_f32_32x32x16_bf16 v[48:63], a[220:223], a[204:207], v[48:63]
    s_add_u32 s7, s7, 24576
    s_cmp_eq_u32 s7, 122880
    s_cselect_b32 s7, 0, s7
    v_add_u32 v188, s7, v190
    v_add_u32 v189, s7, v191
    s_waitcnt lgkmcnt(0)
    v_mfma_f32_32x32x16_bf16 v[64:79], a[224:227], a[204:207], v[64:79]
    s_waitcnt vmcnt(30) lgkmcnt(0)
    s_barrier
    ds_read_b64_tr_b16 a[208:209], v188 offset:0
    ds_read_b64_tr_b16 a[210:211], v188 offset:3072
    ds_read_b64_tr_b16 a[212:213], v189 offset:64
    ds_read_b64_tr_b16 a[214:215], v189 offset:3136
    v_mfma_f32_32x32x16_bf16 v[80:95], a[228:231], a[204:207], v[80:95]
    ds_read_b64_tr_b16 a[216:217], v188 offset:128
    ds_read_b64_tr_b16 a[218:219], v188 offset:3200
    ds_read_b64_tr_b16 a[220:221], v189 offset:192
    ds_read_b64_tr_b16 a[222:223], v189 offset:3264
    s_add_u32 s28, s28, 24576
    s_sub_u32 s44, s28, s43
    s_cmp_eq_u32 s44, 122880
    s_cselect_b32 s28, s43, s28
gm_l2_kernel_st12:
    s_waitcnt vmcnt(24)
    s_waitcnt lgkmcnt(4)
    v_mfma_f32_32x32x16_bf16 v[0:15], a[208:211], a[144:147], v[0:15]
    ds_read_b64_tr_b16 a[224:225], v188 offset:256
    ds_read_b64_tr_b16 a[226:227], v188 offset:3328
    s_add_u32 m0, s28, 0
    v_mfma_f32_32x32x16_bf16 v[16:31], a[212:215], a[144:147], v[16:31]
    ds_read_b64_tr_b16 a[228:229], v189 offset:320
    ds_read_b64_tr_b16 a[230:231], v189 offset:3392
    buffer_load_dwordx4 v185, s[12:15], s32 offen lds
    s_waitcnt lgkmcnt(4)
    v_mfma_f32_32x32x16_bf16 v[32:47], a[216:219], a[144:147], v[32:47]
    ds_read_b64_tr_b16 a[208:209], v188 offset:6144
    ds_read_b64_tr_b16 a[210:211], v188 offset:9216
    s_add_u32 m0, s28, 1024
    v_mfma_f32_32x32x16_bf16 v[48:63], a[220:223], a[144:147], v[48:63]
    ds_read_b64_tr_b16 a[212:213], v189 offset:6208
    ds_read_b64_tr_b16 a[214:215], v189 offset:9280
    buffer_load_dwordx4 v186, s[12:15], s32 offen lds
    s_waitcnt lgkmcnt(4)
    v_mfma_f32_32x32x16_bf16 v[64:79], a[224:227], a[144:147], v[64:79]
    ds_read_b64_tr_b16 a[216:217], v188 offset:6272
    ds_read_b64_tr_b16 a[218:219], v188 offset:9344
    s_add_u32 m0, s28, 2048
    v_mfma_f32_32x32x16_bf16 v[80:95], a[228:231], a[144:147], v[80:95]
    ds_read_b64_tr_b16 a[220:221], v189 offset:6336
    ds_read_b64_tr_b16 a[222:223], v189 offset:9408
    buffer_load_dwordx4 v187, s[12:15], s32 offen lds
    s_waitcnt lgkmcnt(4)
    v_mfma_f32_32x32x16_bf16 v[0:15], a[208:211], a[148:151], v[0:15]
    ds_read_b64_tr_b16 a[224:225], v188 offset:6400
    ds_read_b64_tr_b16 a[226:227], v188 offset:9472
    s_add_u32 m0, s28, 3072
    v_mfma_f32_32x32x16_bf16 v[16:31], a[212:215], a[148:151], v[16:31]
    ds_read_b64_tr_b16 a[228:229], v189 offset:6464
    ds_read_b64_tr_b16 a[230:231], v189 offset:9536
    buffer_load_dwordx4 v185, s[12:15], s33 offen lds
    s_waitcnt lgkmcnt(4)
    v_mfma_f32_32x32x16_bf16 v[32:47], a[216:219], a[148:151], v[32:47]
    ds_read_b64_tr_b16 a[208:209], v188 offset:12288
    ds_read_b64_tr_b16 a[210:211], v188 offset:15360
    s_add_u32 m0, s28, 4096
    v_mfma_f32_32x32x16_bf16 v[48:63], a[220:223], a[148:151], v[48:63]
    ds_read_b64_tr_b16 a[212:213], v189 offset:12352
    ds_read_b64_tr_b16 a[214:215], v189 offset:15424
    buffer_load_dwordx4 v186, s[12:15], s33 offen lds
    s_waitcnt lgkmcnt(4)
    v_mfma_f32_32x32x16_bf16 v[64:79], a[224:227], a[148:151], v[64:79]
    ds_read_b64_tr_b16 a[216:217], v188 offset:12416
    ds_read_b64_tr_b16 a[218:219], v188 offset:15488
    s_add_u32 m0, s28, 5120
    v_mfma_f32_32x32x16_bf16 v[80:95], a[228:231], a[148:151], v[80:95]
    ds_read_b64_tr_b16 a[220:221], v189 offset:12480
    ds_read_b64_tr_b16 a[222:223], v189 offset:15552
    buffer_load_dwordx4 v187, s[12:15], s33 offen lds
    s_waitcnt lgkmcnt(4)
    v_mfma_f32_32x32x16_bf16 v[0:15], a[208:211], a[152:155], v[0:15]
    ds_read_b64_tr_b16 a[224:225], v188 offset:12544
    ds_read_b64_tr_b16 a[226:227], v188 offset:15616
    buffer_load_dwordx4 a[192:195], v184, s[8:11], s6 offen offset:0
    v_mfma_f32_32x32x16_bf16 v[16:31], a[212:215], a[152:155], v[16:31]
    ds_read_b64_tr_b16 a[228:229], v189 offset:12608
    ds_read_b64_tr_b16 a[230:231], v189 offset:15680
    s_add_u32 s55, s50, 24576
    buffer_load_dwordx4 a[96:99], v184, s[20:23], s55 offen
    s_waitcnt lgkmcnt(4)
    v_mfma_f32_32x32x16_bf16 v[32:47], a[216:219], a[152:155], v[32:47]
    ds_read_b64_tr_b16 a[208:209], v188 offset:18432
    ds_read_b64_tr_b16 a[210:211], v188 offset:21504
    buffer_load_dwordx4 a[196:199], v184, s[8:11], s6 offen offset:1024
    v_mfma_f32_32x32x16_bf16 v[48:63], a[220:223], a[152:155], v[48:63]
    ds_read_b64_tr_b16 a[212:213], v189 offset:18496
    ds_read_b64_tr_b16 a[214:215], v189 offset:21568
    s_add_u32 s55, s50, 25600
    buffer_load_dwordx4 a[100:103], v184, s[20:23], s55 offen
    s_waitcnt lgkmcnt(4)
    v_mfma_f32_32x32x16_bf16 v[64:79], a[224:227], a[152:155], v[64:79]
    ds_read_b64_tr_b16 a[216:217], v188 offset:18560
    ds_read_b64_tr_b16 a[218:219], v188 offset:21632
    buffer_load_dwordx4 a[200:203], v184, s[8:11], s6 offen offset:2048
    v_mfma_f32_32x32x16_bf16 v[80:95], a[228:231], a[152:155], v[80:95]
    ds_read_b64_tr_b16 a[220:221], v189 offset:18624
    ds_read_b64_tr_b16 a[222:223], v189 offset:21696
    s_waitcnt lgkmcnt(4)
    v_mfma_f32_32x32x16_bf16 v[0:15], a[208:211], a[156:159], v[0:15]
    ds_read_b64_tr_b16 a[224:225], v188 offset:18688
    ds_read_b64_tr_b16 a[226:227], v188 offset:21760
    buffer_load_dwordx4 a[204:207], v184, s[8:11], s6 offen offset:3072
    v_mfma_f32_32x32x16_bf16 v[16:31], a[212:215], a[156:159], v[16:31]
    ds_read_b64_tr_b16 a[228:229], v189 offset:18752
    ds_read_b64_tr_b16 a[230:231], v189 offset:21824
    s_waitcnt lgkmcnt(4)
    v_mfma_f32_32x32x16_bf16 v[32:47], a[216:219], a[156:159], v[32:47]
    s_add_u32 s6, s6, 4096
    s_add_u32 s32, s32, 73728
    s_add_u32 s33, s33, 73728
    v_mfma_f32_32x32x16_bf16 v[48:63], a[220:223], a[156:159], v[48:63]
    s_add_u32 s7, s7, 24576
    s_cmp_eq_u32 s7, 122880
    s_cselect_b32 s7, 0, s7
    v_add_u32 v188, s7, v190
    v_add_u32 v189, s7, v191
    s_waitcnt lgkmcnt(0)
    v_mfma_f32_32x32x16_bf16 v[64:79], a[224:227], a[156:159], v[64:79]
    s_waitcnt vmcnt(30) lgkmcnt(0)
    s_barrier
    ds_read_b64_tr_b16 a[208:209], v188 offset:0
    ds_read_b64_tr_b16 a[210:211], v188 offset:3072
    ds_read_b64_tr_b16 a[212:213], v189 offset:64
    ds_read_b64_tr_b16 a[214:215], v189 offset:3136
    v_mfma_f32_32x32x16_bf16 v[80:95], a[228:231], a[156:159], v[80:95]
    ds_read_b64_tr_b16 a[216:217], v188 offset:128
    ds_read_b64_tr_b16 a[218:219], v188 offset:3200
    ds_read_b64_tr_b16 a[220:221], v189 offset:192
    ds_read_b64_tr_b16 a[222:223], v189 offset:3264
    s_add_u32 s28, s28, 24576
    s_sub_u32 s44, s28, s43
    s_cmp_eq_u32 s44, 122880
    s_cselect_b32 s28, s43, s28
gm_l2_kernel_st13:
    s_waitcnt vmcnt(24)
    s_waitcnt lgkmcnt(4)
    v_mfma_f32_32x32x16_bf16 v[0:15], a[208:211], a[160:163], v[0:15]
    ds_read_b64_tr_b16 a[224:225], v188 offset:256
    ds_read_b64_tr_b16 a[226:227], v188 offset:3328
    s_add_u32 m0, s28, 0
    v_mfma_f32_32x32x16_bf16 v[16:31], a[212:215], a[160:163], v[16:31]
    ds_read_b64_tr_b16 a[228:229], v189 offset:320
    ds_read_b64_tr_b16 a[230:231], v189 offset:3392
    buffer_load_dwordx4 v185, s[12:15], s32 offen lds
    s_waitcnt lgkmcnt(4)
    v_mfma_f32_32x32x16_bf16 v[32:47], a[216:219], a[160:163], v[32:47]
    ds_read_b64_tr_b16 a[208:209], v188 offset:6144
    ds_read_b64_tr_b16 a[210:211], v188 offset:9216
    s_add_u32 m0, s28, 1024
    v_mfma_f32_32x32x16_bf16 v[48:63], a[220:223], a[160:163], v[48:63]
    ds_read_b64_tr_b16 a[212:213], v189 offset:6208
    ds_read_b64_tr_b16 a[214:215], v189 offset:9280
    buffer_load_dwordx4 v186, s[12:15], s32 offen lds
    s_waitcnt lgkmcnt(4)
    v_mfma_f32_32x32x16_bf16 v[64:79], a[224:227], a[160:163], v[64:79]
    ds_read_b64_tr_b16 a[216:217], v188 offset:6272
    ds_read_b64_tr_b16 a[218:219], v188 offset:9344
    s_add_u32 m0, s28, 2048
    v_mfma_f32_32x32x16_bf16 v[80:95], a[228:231], a[160:163], v[80:95]
    ds_read_b64_tr_b16 a[220:221], v189 offset:6336
    ds_read_b64_tr_b16 a[222:223], v189 offset:9408
    buffer_load_dwordx4 v187, s[12:15], s32 offen lds
    s_waitcnt lgkmcnt(4)
    v_mfma_f32_32x32x16_bf16 v[0:15], a[208:211], a[164:167], v[0:15]
    ds_read_b64_tr_b16 a[224:225], v188 offset:6400
    ds_read_b64_tr_b16 a[226:227], v188 offset:9472
    s_add_u32 m0, s28, 3072
    v_mfma_f32_32x32x16_bf16 v[16:31], a[212:215], a[164:167], v[16:31]
    ds_read_b64_tr_b16 a[228:229], v189 offset:6464
    ds_read_b64_tr_b16 a[230:231], v189 offset:9536
    buffer_load_dwordx4 v185, s[12:15], s33 offen lds
    s_waitcnt lgkmcnt(4)
    v_mfma_f32_32x32x16_bf16 v[32:47], a[216:219], a[164:167], v[32:47]
    ds_read_b64_tr_b16 a[208:209], v188 offset:12288
    ds_read_b64_tr_b16 a[210:211], v188 offset:15360
    s_add_u32 m0, s28, 4096
    v_mfma_f32_32x32x16_bf16 v[48:63], a[220:223], a[164:167], v[48:63]
    ds_read_b64_tr_b16 a[212:213], v189 offset:12352
    ds_read_b64_tr_b16 a[214:215], v189 offset:15424
    buffer_load_dwordx4 v186, s[12:15], s33 offen lds
    s_waitcnt lgkmcnt(4)
    v_mfma_f32_32x32x16_bf16 v[64:79], a[224:227], a[164:167], v[64:79]
    ds_read_b64_tr_b16 a[216:217], v188 offset:12416
    ds_read_b64_tr_b16 a[218:219], v188 offset:15488
    s_add_u32 m0, s28, 5120
    v_mfma_f32_32x32x16_bf16 v[80:95], a[228:231], a[164:167], v[80:95]
    ds_read_b64_tr_b16 a[220:221], v189 offset:12480
    ds_read_b64_tr_b16 a[222:223], v189 offset:15552
    buffer_load_dwordx4 v187, s[12:15], s33 offen lds
    s_waitcnt lgkmcnt(4)
    v_mfma_f32_32x32x16_bf16 v[0:15], a[208:211], a[168:171], v[0:15]
    ds_read_b64_tr_b16 a[224:225], v188 offset:12544
    ds_read_b64_tr_b16 a[226:227], v188 offset:15616
    buffer_load_dwordx4 a[144:147], v184, s[8:11], s6 offen offset:0
    v_mfma_f32_32x32x16_bf16 v[16:31], a[212:215], a[168:171], v[16:31]
    ds_read_b64_tr_b16 a[228:229], v189 offset:12608
    ds_read_b64_tr_b16 a[230:231], v189 offset:15680
    s_add_u32 s55, s50, 26624
    buffer_load_dwordx4 a[104:107], v184, s[20:23], s55 offen
    s_waitcnt lgkmcnt(4)
    v_mfma_f32_32x32x16_bf16 v[32:47], a[216:219], a[168:171], v[32:47]
    ds_read_b64_tr_b16 a[208:209], v188 offset:18432
    ds_read_b64_tr_b16 a[210:211], v188 offset:21504
    buffer_load_dwordx4 a[148:151], v184, s[8:11], s6 offen offset:1024
    v_mfma_f32_32x32x16_bf16 v[48:63], a[220:223], a[168:171], v[48:63]
    ds_read_b64_tr_b16 a[212:213], v189 offset:18496
    ds_read_b64_tr_b16 a[214:215], v189 offset:21568
    s_add_u32 s55, s50, 27648
    buffer_load_dwordx4 a[108:111], v184, s[20:23], s55 offen
    s_waitcnt lgkmcnt(4)
    v_mfma_f32_32x32x16_bf16 v[64:79], a[224:227], a[168:171], v[64:79]
    ds_read_b64_tr_b16 a[216:217], v188 offset:18560
    ds_read_b64_tr_b16 a[218:219], v188 offset:21632
    buffer_load_dwordx4 a[152:155], v184, s[8:11], s6 offen offset:2048
    v_mfma_f32_32x32x16_bf16 v[80:95], a[228:231], a[168:171], v[80:95]
    ds_read_b64_tr_b16 a[220:221], v189 offset:18624
    ds_read_b64_tr_b16 a[222:223], v189 offset:21696
    s_waitcnt lgkmcnt(4)
    v_mfma_f32_32x32x16_bf16 v[0:15], a[208:211], a[172:175], v[0:15]
    ds_read_b64_tr_b16 a[224:225], v188 offset:18688
    ds_read_b64_tr_b16 a[226:227], v188 offset:21760
    buffer_load_dwordx4 a[156:159], v184, s[8:11], s6 offen offset:3072
    v_mfma_f32_32x32x16_bf16 v[16:31], a[212:215], a[172:175], v[16:31]
    ds_read_b64_tr_b16 a[228:229], v189 offset:18752
    ds_read_b64_tr_b16 a[230:231], v189 offset:21824
    s_waitcnt lgkmcnt(4)
    v_mfma_f32_32x32x16_bf16 v[32:47], a[216:219], a[172:175], v[32:47]
    s_add_u32 s6, s6, 4096
    s_add_u32 s32, s32, 73728
    s_add_u32 s33, s33, 73728
    v_mfma_f32_32x32x16_bf16 v[48:63], a[220:223], a[172:175], v[48:63]
    s_add_u32 s7, s7, 24576
    s_cmp_eq_u32 s7, 122880
    s_cselect_b32 s7, 0, s7
    v_add_u32 v188, s7, v190
    v_add_u32 v189, s7, v191
    s_waitcnt lgkmcnt(0)
    v_mfma_f32_32x32x16_bf16 v[64:79], a[224:227], a[172:175], v[64:79]
    s_waitcnt vmcnt(30) lgkmcnt(0)
    s_barrier
    ds_read_b64_tr_b16 a[208:209], v188 offset:0
    ds_read_b64_tr_b16 a[210:211], v188 offset:3072
    ds_read_b64_tr_b16 a[212:213], v189 offset:64
    ds_read_b64_tr_b16 a[214:215], v189 offset:3136
    v_mfma_f32_32x32x16_bf16 v[80:95], a[228:231], a[172:175], v[80:95]
    ds_read_b64_tr_b16 a[216:217], v188 offset:128
    ds_read_b64_tr_b16 a[218:219], v188 offset:3200
    ds_read_b64_tr_b16 a[220:221], v189 offset:192
    ds_read_b64_tr_b16 a[222:223], v189 offset:3264
    s_add_u32 s28, s28, 24576
    s_sub_u32 s44, s28, s43
    s_cmp_eq_u32 s44, 122880
    s_cselect_b32 s28, s43, s28
gm_l2_kernel_st14:
    s_waitcnt vmcnt(24)
    s_waitcnt lgkmcnt(4)
    v_mfma_f32_32x32x16_bf16 v[0:15], a[208:211], a[176:179], v[0:15]
    ds_read_b64_tr_b16 a[224:225], v188 offset:256
    ds_read_b64_tr_b16 a[226:227], v188 offset:3328
    s_add_u32 m0, s28, 0
    v_mfma_f32_32x32x16_bf16 v[16:31], a[212:215], a[176:179], v[16:31]
    ds_read_b64_tr_b16 a[228:229], v189 offset:320
    ds_read_b64_tr_b16 a[230:231], v189 offset:3392
    buffer_load_dwordx4 v185, s[12:15], s32 offen lds
    s_waitcnt lgkmcnt(4)
    v_mfma_f32_32x32x16_bf16 v[32:47], a[216:219], a[176:179], v[32:47]
    ds_read_b64_tr_b16 a[208:209], v188 offset:6144
    ds_read_b64_tr_b16 a[210:211], v188 offset:9216
    s_add_u32 m0, s28, 1024
    v_mfma_f32_32x32x16_bf16 v[48:63], a[220:223], a[176:179], v[48:63]
    ds_read_b64_tr_b16 a[212:213], v189 offset:6208
    ds_read_b64_tr_b16 a[214:215], v189 offset:9280
    buffer_load_dwordx4 v186, s[12:15], s32 offen lds
    s_waitcnt lgkmcnt(4)
    v_mfma_f32_32x32x16_bf16 v[64:79], a[224:227], a[176:179], v[64:79]
    ds_read_b64_tr_b16 a[216:217], v188 offset:6272
    ds_read_b64_tr_b16 a[218:219], v188 offset:9344
    s_add_u32 m0, s28, 2048
    v_mfma_f32_32x32x16_bf16 v[80:95], a[228:231], a[176:179], v[80:95]
    ds_read_b64_tr_b16 a[220:221], v189 offset:6336
    ds_read_b64_tr_b16 a[222:223], v189 offset:9408
    buffer_load_dwordx4 v187, s[12:15], s32 offen lds
    s_waitcnt lgkmcnt(4)
    v_mfma_f32_32x32x16_bf16 v[0:15], a[208:211], a[180:183], v[0:15]
    ds_read_b64_tr_b16 a[224:225], v188 offset:6400
    ds_read_b64_tr_b16 a[226:227], v188 offset:9472
    s_add_u32 m0, s28, 3072
    v_mfma_f32_32x32x16_bf16 v[16:31], a[212:215], a[180:183], v[16:31]
    ds_read_b64_tr_b16 a[228:229], v189 offset:6464
    ds_read_b64_tr_b16 a[230:231], v189 offset:9536
    buffer_load_dwordx4 v185, s[12:15], s33 offen lds
    s_waitcnt lgkmcnt(4)
    v_mfma_f32_32x32x16_bf16 v[32:47], a[216:219], a[180:183], v[32:47]
    ds_read_b64_tr_b16 a[208:209], v188 offset:12288
    ds_read_b64_tr_b16 a[210:211], v188 offset:15360
    s_add_u32 m0, s28, 4096
    v_mfma_f32_32x32x16_bf16 v[48:63], a[220:223], a[180:183], v[48:63]
    ds_read_b64_tr_b16 a[212:213], v189 offset:12352
    ds_read_b64_tr_b16 a[214:215], v189 offset:15424
    buffer_load_dwordx4 v186, s[12:15], s33 offen lds
    s_waitcnt lgkmcnt(4)
    v_mfma_f32_32x32x16_bf16 v[64:79], a[224:227], a[180:183], v[64:79]
    ds_read_b64_tr_b16 a[216:217], v188 offset:12416
    ds_read_b64_tr_b16 a[218:219], v188 offset:15488
    s_add_u32 m0, s28, 5120
    v_mfma_f32_32x32x16_bf16 v[80:95], a[228:231], a[180:183], v[80:95]
    ds_read_b64_tr_b16 a[220:221], v189 offset:12480
    ds_read_b64_tr_b16 a[222:223], v189 offset:15552
    buffer_load_dwordx4 v187, s[12:15], s33 offen lds
    s_waitcnt lgkmcnt(4)
    v_mfma_f32_32x32x16_bf16 v[0:15], a[208:211], a[184:187], v[0:15]
    ds_read_b64_tr_b16 a[224:225], v188 offset:12544
    ds_read_b64_tr_b16 a[226:227], v188 offset:15616
    buffer_load_dwordx4 a[160:163], v184, s[8:11], s6 offen offset:0
    v_mfma_f32_32x32x16_bf16 v[16:31], a[212:215], a[184:187], v[16:31]
    ds_read_b64_tr_b16 a[228:229], v189 offset:12608
    ds_read_b64_tr_b16 a[230:231], v189 offset:15680
    s_add_u32 s55, s50, 28672
    buffer_load_dwordx4 a[112:115], v184, s[20:23], s55 offen
    s_waitcnt lgkmcnt(4)
    v_mfma_f32_32x32x16_bf16 v[32:47], a[216:219], a[184:187], v[32:47]
    ds_read_b64_tr_b16 a[208:209], v188 offset:18432
    ds_read_b64_tr_b16 a[210:211], v188 offset:21504
    buffer_load_dwordx4 a[164:167], v184, s[8:11], s6 offen offset:1024
    v_mfma_f32_32x32x16_bf16 v[48:63], a[220:223], a[184:187], v[48:63]
    ds_read_b64_tr_b16 a[212:213], v189 offset:18496
    ds_read_b64_tr_b16 a[214:215], v189 offset:21568
    s_add_u32 s55, s50, 29696
    buffer_load_dwordx4 a[116:119], v184, s[20:23], s55 offen
    s_waitcnt lgkmcnt(4)
    v_mfma_f32_32x32x16_bf16 v[64:79], a[224:227], a[184:187], v[64:79]
    ds_read_b64_tr_b16 a[216:217], v188 offset:18560
    ds_read_b64_tr_b16 a[218:219], v188 offset:21632
    buffer_load_dwordx4 a[168:171], v184, s[8:11], s6 offen offset:2048
    v_mfma_f32_32x32x16_bf16 v[80:95], a[228:231], a[184:187], v[80:95]
    ds_read_b64_tr_b16 a[220:221], v189 offset:18624
    ds_read_b64_tr_b16 a[222:223], v189 offset:21696
    s_waitcnt lgkmcnt(4)
    v_mfma_f32_32x32x16_bf16 v[0:15], a[208:211], a[188:191], v[0:15]
    ds_read_b64_tr_b16 a[224:225], v188 offset:18688
    ds_read_b64_tr_b16 a[226:227], v188 offset:21760
    buffer_load_dwordx4 a[172:175], v184, s[8:11], s6 offen offset:3072
    v_mfma_f32_32x32x16_bf16 v[16:31], a[212:215], a[188:191], v[16:31]
    ds_read_b64_tr_b16 a[228:229], v189 offset:18752
    ds_read_b64_tr_b16 a[230:231], v189 offset:21824
    s_waitcnt lgkmcnt(4)
    v_mfma_f32_32x32x16_bf16 v[32:47], a[216:219], a[188:191], v[32:47]
    s_add_u32 s6, s6, 4096
    s_add_u32 s32, s32, 73728
    s_add_u32 s33, s33, 73728
    v_mfma_f32_32x32x16_bf16 v[48:63], a[220:223], a[188:191], v[48:63]
    s_add_u32 s7, s7, 24576
    s_cmp_eq_u32 s7, 122880
    s_cselect_b32 s7, 0, s7
    v_add_u32 v188, s7, v190
    v_add_u32 v189, s7, v191
    s_waitcnt lgkmcnt(0)
    v_mfma_f32_32x32x16_bf16 v[64:79], a[224:227], a[188:191], v[64:79]
    s_waitcnt vmcnt(30) lgkmcnt(0)
    s_barrier
    ds_read_b64_tr_b16 a[208:209], v188 offset:0
    ds_read_b64_tr_b16 a[210:211], v188 offset:3072
    ds_read_b64_tr_b16 a[212:213], v189 offset:64
    ds_read_b64_tr_b16 a[214:215], v189 offset:3136
    v_mfma_f32_32x32x16_bf16 v[80:95], a[228:231], a[188:191], v[80:95]
    ds_read_b64_tr_b16 a[216:217], v188 offset:128
    ds_read_b64_tr_b16 a[218:219], v188 offset:3200
    ds_read_b64_tr_b16 a[220:221], v189 offset:192
    ds_read_b64_tr_b16 a[222:223], v189 offset:3264
    s_add_u32 s28, s28, 24576
    s_sub_u32 s44, s28, s43
    s_cmp_eq_u32 s44, 122880
    s_cselect_b32 s28, s43, s28
gm_l2_kernel_st15:
    s_waitcnt vmcnt(24)
    s_waitcnt lgkmcnt(4)
    v_mfma_f32_32x32x16_bf16 v[0:15], a[208:211], a[192:195], v[0:15]
    ds_read_b64_tr_b16 a[224:225], v188 offset:256
    ds_read_b64_tr_b16 a[226:227], v188 offset:3328
    v_mfma_f32_32x32x16_bf16 v[16:31], a[212:215], a[192:195], v[16:31]
    ds_read_b64_tr_b16 a[228:229], v189 offset:320
    ds_read_b64_tr_b16 a[230:231], v189 offset:3392
    s_waitcnt lgkmcnt(4)
    v_mfma_f32_32x32x16_bf16 v[32:47], a[216:219], a[192:195], v[32:47]
    ds_read_b64_tr_b16 a[208:209], v188 offset:6144
    ds_read_b64_tr_b16 a[210:211], v188 offset:9216
    v_mfma_f32_32x32x16_bf16 v[48:63], a[220:223], a[192:195], v[48:63]
    ds_read_b64_tr_b16 a[212:213], v189 offset:6208
    ds_read_b64_tr_b16 a[214:215], v189 offset:9280
    s_waitcnt lgkmcnt(4)
    v_mfma_f32_32x32x16_bf16 v[64:79], a[224:227], a[192:195], v[64:79]
    ds_read_b64_tr_b16 a[216:217], v188 offset:6272
    ds_read_b64_tr_b16 a[218:219], v188 offset:9344
    v_mfma_f32_32x32x16_bf16 v[80:95], a[228:231], a[192:195], v[80:95]
    ds_read_b64_tr_b16 a[220:221], v189 offset:6336
    ds_read_b64_tr_b16 a[222:223], v189 offset:9408
    s_waitcnt lgkmcnt(4)
    v_mfma_f32_32x32x16_bf16 v[0:15], a[208:211], a[196:199], v[0:15]
    ds_read_b64_tr_b16 a[224:225], v188 offset:6400
    ds_read_b64_tr_b16 a[226:227], v188 offset:9472
    v_mfma_f32_32x32x16_bf16 v[16:31], a[212:215], a[196:199], v[16:31]
    ds_read_b64_tr_b16 a[228:229], v189 offset:6464
    ds_read_b64_tr_b16 a[230:231], v189 offset:9536
    s_waitcnt lgkmcnt(4)
    v_mfma_f32_32x32x16_bf16 v[32:47], a[216:219], a[196:199], v[32:47]
    ds_read_b64_tr_b16 a[208:209], v188 offset:12288
    ds_read_b64_tr_b16 a[210:211], v188 offset:15360
    v_mfma_f32_32x32x16_bf16 v[48:63], a[220:223], a[196:199], v[48:63]
    ds_read_b64_tr_b16 a[212:213], v189 offset:12352
    ds_read_b64_tr_b16 a[214:215], v189 offset:15424
    s_waitcnt lgkmcnt(4)
    v_mfma_f32_32x32x16_bf16 v[64:79], a[224:227], a[196:199], v[64:79]
    ds_read_b64_tr_b16 a[216:217], v188 offset:12416
    ds_read_b64_tr_b16 a[218:219], v188 offset:15488
    v_mfma_f32_32x32x16_bf16 v[80:95], a[228:231], a[196:199], v[80:95]
    ds_read_b64_tr_b16 a[220:221], v189 offset:12480
    ds_read_b64_tr_b16 a[222:223], v189 offset:15552
    s_waitcnt lgkmcnt(4)
    v_mfma_f32_32x32x16_bf16 v[0:15], a[208:211], a[200:203], v[0:15]
    ds_read_b64_tr_b16 a[224:225], v188 offset:12544
    ds_read_b64_tr_b16 a[226:227], v188 offset:15616
    v_mfma_f32_32x32x16_bf16 v[16:31], a[212:215], a[200:203], v[16:31]
    ds_read_b64_tr_b16 a[228:229], v189 offset:12608
    ds_read_b64_tr_b16 a[230:231], v189 offset:15680
    s_add_u32 s55, s50, 30720
    buffer_load_dwordx4 a[120:123], v184, s[20:23], s55 offen
    s_waitcnt lgkmcnt(4)
    v_mfma_f32_32x32x16_bf16 v[32:47], a[216:219], a[200:203], v[32:47]
    ds_read_b64_tr_b16 a[208:209], v188 offset:18432
    ds_read_b64_tr_b16 a[210:211], v188 offset:21504
    v_mfma_f32_32x32x16_bf16 v[48:63], a[220:223], a[200:203], v[48:63]
    ds_read_b64_tr_b16 a[212:213], v189 offset:18496
    ds_read_b64_tr_b16 a[214:215], v189 offset:21568
    s_add_u32 s55, s50, 31744
    buffer_load_dwordx4 a[124:127], v184, s[20:23], s55 offen
    s_waitcnt lgkmcnt(4)
    v_mfma_f32_32x32x16_bf16 v[64:79], a[224:227], a[200:203], v[64:79]
    ds_read_b64_tr_b16 a[216:217], v188 offset:18560
    ds_read_b64_tr_b16 a[218:219], v188 offset:21632
    v_mfma_f32_32x32x16_bf16 v[80:95], a[228:231], a[200:203], v[80:95]
    ds_read_b64_tr_b16 a[220:221], v189 offset:18624
    ds_read_b64_tr_b16 a[222:223], v189 offset:21696
    s_waitcnt lgkmcnt(4)
    v_mfma_f32_32x32x16_bf16 v[0:15], a[208:211], a[204:207], v[0:15]
    ds_read_b64_tr_b16 a[224:225], v188 offset:18688
    ds_read_b64_tr_b16 a[226:227], v188 offset:21760
    v_mfma_f32_32x32x16_bf16 v[16:31], a[212:215], a[204:207], v[16:31]
    ds_read_b64_tr_b16 a[228:229], v189 offset:18752
    ds_read_b64_tr_b16 a[230:231], v189 offset:21824
    s_waitcnt lgkmcnt(4)
    v_mfma_f32_32x32x16_bf16 v[32:47], a[216:219], a[204:207], v[32:47]
    v_mfma_f32_32x32x16_bf16 v[48:63], a[220:223], a[204:207], v[48:63]
    s_add_u32 s7, s7, 24576
    s_cmp_eq_u32 s7, 122880
    s_cselect_b32 s7, 0, s7
    v_add_u32 v188, s7, v190
    v_add_u32 v189, s7, v191
    s_waitcnt lgkmcnt(0)
    v_mfma_f32_32x32x16_bf16 v[64:79], a[224:227], a[204:207], v[64:79]
    s_waitcnt vmcnt(20) lgkmcnt(0)
    s_barrier
    ds_read_b64_tr_b16 a[208:209], v188 offset:0
    ds_read_b64_tr_b16 a[210:211], v188 offset:3072
    ds_read_b64_tr_b16 a[212:213], v189 offset:64
    ds_read_b64_tr_b16 a[214:215], v189 offset:3136
    v_mfma_f32_32x32x16_bf16 v[80:95], a[228:231], a[204:207], v[80:95]
    ds_read_b64_tr_b16 a[216:217], v188 offset:128
    ds_read_b64_tr_b16 a[218:219], v188 offset:3200
    ds_read_b64_tr_b16 a[220:221], v189 offset:192
    ds_read_b64_tr_b16 a[222:223], v189 offset:3264
gm_l2_kernel_st16:
    s_waitcnt vmcnt(14)
    s_waitcnt lgkmcnt(4)
    v_mfma_f32_32x32x16_bf16 v[0:15], a[208:211], a[144:147], v[0:15]
    ds_read_b64_tr_b16 a[224:225], v188 offset:256
    ds_read_b64_tr_b16 a[226:227], v188 offset:3328
    v_mfma_f32_32x32x16_bf16 v[16:31], a[212:215], a[144:147], v[16:31]
    ds_read_b64_tr_b16 a[228:229], v189 offset:320
    ds_read_b64_tr_b16 a[230:231], v189 offset:3392
    s_waitcnt lgkmcnt(4)
    v_mfma_f32_32x32x16_bf16 v[32:47], a[216:219], a[144:147], v[32:47]
    ds_read_b64_tr_b16 a[208:209], v188 offset:6144
    ds_read_b64_tr_b16 a[210:211], v188 offset:9216
    v_lshlrev_b32 v204, 2, v192
    s_and_b32 s47, s2, 7
    s_lshl_b32 s47, s47, 8
    s_add_u32 s47, s47, 37789696
    buffer_load_dword v200, v204, s[8:11], s47 offen sc1
    v_min_u32 v205, 3, v192
    v_lshlrev_b32 v205, 2, v205
    buffer_load_dword v212, v205, s[8:11], s84 offen sc1
    v_mfma_f32_32x32x16_bf16 v[48:63], a[220:223], a[144:147], v[48:63]
    ds_read_b64_tr_b16 a[212:213], v189 offset:6208
    ds_read_b64_tr_b16 a[214:215], v189 offset:9280
    s_waitcnt lgkmcnt(4)
    v_mfma_f32_32x32x16_bf16 v[64:79], a[224:227], a[144:147], v[64:79]
    ds_read_b64_tr_b16 a[216:217], v188 offset:6272
    ds_read_b64_tr_b16 a[218:219], v188 offset:9344
    v_mfma_f32_32x32x16_bf16 v[80:95], a[228:231], a[144:147], v[80:95]
    ds_read_b64_tr_b16 a[220:221], v189 offset:6336
    ds_read_b64_tr_b16 a[222:223], v189 offset:9408
    s_waitcnt lgkmcnt(4)
    v_mfma_f32_32x32x16_bf16 v[0:15], a[208:211], a[148:151], v[0:15]
    ds_read_b64_tr_b16 a[224:225], v188 offset:6400
    ds_read_b64_tr_b16 a[226:227], v188 offset:9472
    v_mfma_f32_32x32x16_bf16 v[16:31], a[212:215], a[148:151], v[16:31]
    ds_read_b64_tr_b16 a[228:229], v189 offset:6464
    ds_read_b64_tr_b16 a[230:231], v189 offset:9536
    s_waitcnt lgkmcnt(4)
    v_mfma_f32_32x32x16_bf16 v[32:47], a[216:219], a[148:151], v[32:47]
    ds_read_b64_tr_b16 a[208:209], v188 offset:12288
    ds_read_b64_tr_b16 a[210:211], v188 offset:15360
    v_mfma_f32_32x32x16_bf16 v[48:63], a[220:223], a[148:151], v[48:63]
    ds_read_b64_tr_b16 a[212:213], v189 offset:12352
    ds_read_b64_tr_b16 a[214:215], v189 offset:15424
    s_waitcnt lgkmcnt(4)
    v_mfma_f32_32x32x16_bf16 v[64:79], a[224:227], a[148:151], v[64:79]
    ds_read_b64_tr_b16 a[216:217], v188 offset:12416
    ds_read_b64_tr_b16 a[218:219], v188 offset:15488
    v_mfma_f32_32x32x16_bf16 v[80:95], a[228:231], a[148:151], v[80:95]
    ds_read_b64_tr_b16 a[220:221], v189 offset:12480
    ds_read_b64_tr_b16 a[222:223], v189 offset:15552
    s_waitcnt lgkmcnt(4)
    v_mfma_f32_32x32x16_bf16 v[0:15], a[208:211], a[152:155], v[0:15]
    ds_read_b64_tr_b16 a[224:225], v188 offset:12544
    ds_read_b64_tr_b16 a[226:227], v188 offset:15616
    v_mfma_f32_32x32x16_bf16 v[16:31], a[212:215], a[152:155], v[16:31]
    ds_read_b64_tr_b16 a[228:229], v189 offset:12608
    ds_read_b64_tr_b16 a[230:231], v189 offset:15680
    s_add_u32 s55, s50, 32768
    buffer_load_dwordx4 a[128:131], v184, s[20:23], s55 offen
    s_waitcnt lgkmcnt(4)
    v_mfma_f32_32x32x16_bf16 v[32:47], a[216:219], a[152:155], v[32:47]
    ds_read_b64_tr_b16 a[208:209], v188 offset:18432
    ds_read_b64_tr_b16 a[210:211], v188 offset:21504
    v_mfma_f32_32x32x16_bf16 v[48:63], a[220:223], a[152:155], v[48:63]
    ds_read_b64_tr_b16 a[212:213], v189 offset:18496
    ds_read_b64_tr_b16 a[214:215], v189 offset:21568
    s_add_u32 s55, s50, 33792
    buffer_load_dwordx4 a[132:135], v184, s[20:23], s55 offen
    s_waitcnt lgkmcnt(4)
    v_mfma_f32_32x32x16_bf16 v[64:79], a[224:227], a[152:155], v[64:79]
    ds_read_b64_tr_b16 a[216:217], v188 offset:18560
    ds_read_b64_tr_b16 a[218:219], v188 offset:21632
    v_mfma_f32_32x32x16_bf16 v[80:95], a[228:231], a[152:155], v[80:95]
    ds_read_b64_tr_b16 a[220:221], v189 offset:18624
    ds_read_b64_tr_b16 a[222:223], v189 offset:21696
    s_waitcnt lgkmcnt(4)
    v_mfma_f32_32x32x16_bf16 v[0:15], a[208:211], a[156:159], v[0:15]
    ds_read_b64_tr_b16 a[224:225], v188 offset:18688
    ds_read_b64_tr_b16 a[226:227], v188 offset:21760
    v_mfma_f32_32x32x16_bf16 v[16:31], a[212:215], a[156:159], v[16:31]
    ds_read_b64_tr_b16 a[228:229], v189 offset:18752
    ds_read_b64_tr_b16 a[230:231], v189 offset:21824
    s_waitcnt lgkmcnt(4)
    v_mfma_f32_32x32x16_bf16 v[32:47], a[216:219], a[156:159], v[32:47]
    v_mfma_f32_32x32x16_bf16 v[48:63], a[220:223], a[156:159], v[48:63]
    s_add_u32 s7, s7, 24576
    s_cmp_eq_u32 s7, 122880
    s_cselect_b32 s7, 0, s7
    v_add_u32 v188, s7, v190
    v_add_u32 v189, s7, v191
    s_waitcnt lgkmcnt(0)
    v_mfma_f32_32x32x16_bf16 v[64:79], a[224:227], a[156:159], v[64:79]
    s_waitcnt vmcnt(12) lgkmcnt(0)
    s_barrier
    ds_read_b64_tr_b16 a[208:209], v188 offset:0
    ds_read_b64_tr_b16 a[210:211], v188 offset:3072
    ds_read_b64_tr_b16 a[212:213], v189 offset:64
    ds_read_b64_tr_b16 a[214:215], v189 offset:3136
    v_mfma_f32_32x32x16_bf16 v[80:95], a[228:231], a[156:159], v[80:95]
    ds_read_b64_tr_b16 a[216:217], v188 offset:128
    ds_read_b64_tr_b16 a[218:219], v188 offset:3200
    ds_read_b64_tr_b16 a[220:221], v189 offset:192
    ds_read_b64_tr_b16 a[222:223], v189 offset:3264
gm_l2_kernel_st17:
    s_waitcnt vmcnt(6)
    s_waitcnt lgkmcnt(4)
    v_mfma_f32_32x32x16_bf16 v[0:15], a[208:211], a[160:163], v[0:15]
    ds_read_b64_tr_b16 a[224:225], v188 offset:256
    ds_read_b64_tr_b16 a[226:227], v188 offset:3328
    v_mfma_f32_32x32x16_bf16 v[16:31], a[212:215], a[160:163], v[16:31]
    ds_read_b64_tr_b16 a[228:229], v189 offset:320
    ds_read_b64_tr_b16 a[230:231], v189 offset:3392
    s_waitcnt lgkmcnt(4)
    v_mfma_f32_32x32x16_bf16 v[32:47], a[216:219], a[160:163], v[32:47]
    ds_read_b64_tr_b16 a[208:209], v188 offset:6144
    ds_read_b64_tr_b16 a[210:211], v188 offset:9216
    v_mfma_f32_32x32x16_bf16 v[48:63], a[220:223], a[160:163], v[48:63]
    ds_read_b64_tr_b16 a[212:213], v189 offset:6208
    ds_read_b64_tr_b16 a[214:215], v189 offset:9280
    s_waitcnt lgkmcnt(4)
    v_mfma_f32_32x32x16_bf16 v[64:79], a[224:227], a[160:163], v[64:79]
    ds_read_b64_tr_b16 a[216:217], v188 offset:6272
    ds_read_b64_tr_b16 a[218:219], v188 offset:9344
    v_mfma_f32_32x32x16_bf16 v[80:95], a[228:231], a[160:163], v[80:95]
    ds_read_b64_tr_b16 a[220:221], v189 offset:6336
    ds_read_b64_tr_b16 a[222:223], v189 offset:9408
    s_waitcnt lgkmcnt(4)
    v_mfma_f32_32x32x16_bf16 v[0:15], a[208:211], a[164:167], v[0:15]
    ds_read_b64_tr_b16 a[224:225], v188 offset:6400
    ds_read_b64_tr_b16 a[226:227], v188 offset:9472
    v_mfma_f32_32x32x16_bf16 v[16:31], a[212:215], a[164:167], v[16:31]
    ds_read_b64_tr_b16 a[228:229], v189 offset:6464
    ds_read_b64_tr_b16 a[230:231], v189 offset:9536
    s_waitcnt lgkmcnt(4)
    v_mfma_f32_32x32x16_bf16 v[32:47], a[216:219], a[164:167], v[32:47]
    ds_read_b64_tr_b16 a[208:209], v188 offset:12288
    ds_read_b64_tr_b16 a[210:211], v188 offset:15360
    v_mfma_f32_32x32x16_bf16 v[48:63], a[220:223], a[164:167], v[48:63]
    ds_read_b64_tr_b16 a[212:213], v189 offset:12352
    ds_read_b64_tr_b16 a[214:215], v189 offset:15424
    s_waitcnt lgkmcnt(4)
    v_mfma_f32_32x32x16_bf16 v[64:79], a[224:227], a[164:167], v[64:79]
    ds_read_b64_tr_b16 a[216:217], v188 offset:12416
    ds_read_b64_tr_b16 a[218:219], v188 offset:15488
    v_mfma_f32_32x32x16_bf16 v[80:95], a[228:231], a[164:167], v[80:95]
    ds_read_b64_tr_b16 a[220:221], v189 offset:12480
    ds_read_b64_tr_b16 a[222:223], v189 offset:15552
    s_waitcnt lgkmcnt(4)
    v_mfma_f32_32x32x16_bf16 v[0:15], a[208:211], a[168:171], v[0:15]
    ds_read_b64_tr_b16 a[224:225], v188 offset:12544
    ds_read_b64_tr_b16 a[226:227], v188 offset:15616
    v_mfma_f32_32x32x16_bf16 v[16:31], a[212:215], a[168:171], v[16:31]
    ds_read_b64_tr_b16 a[228:229], v189 offset:12608
    ds_read_b64_tr_b16 a[230:231], v189 offset:15680
    s_add_u32 s55, s50, 34816
    buffer_load_dwordx4 a[136:139], v184, s[20:23], s55 offen
    s_waitcnt lgkmcnt(4)
    v_mfma_f32_32x32x16_bf16 v[32:47], a[216:219], a[168:171], v[32:47]
    ds_read_b64_tr_b16 a[208:209], v188 offset:18432
    ds_read_b64_tr_b16 a[210:211], v188 offset:21504
    v_mfma_f32_32x32x16_bf16 v[48:63], a[220:223], a[168:171], v[48:63]
    ds_read_b64_tr_b16 a[212:213], v189 offset:18496
    ds_read_b64_tr_b16 a[214:215], v189 offset:21568
    s_add_u32 s55, s50, 35840
    buffer_load_dwordx4 a[140:143], v184, s[20:23], s55 offen
    s_waitcnt lgkmcnt(4)
    v_mfma_f32_32x32x16_bf16 v[64:79], a[224:227], a[168:171], v[64:79]
    ds_read_b64_tr_b16 a[216:217], v188 offset:18560
    ds_read_b64_tr_b16 a[218:219], v188 offset:21632
    v_mfma_f32_32x32x16_bf16 v[80:95], a[228:231], a[168:171], v[80:95]
    ds_read_b64_tr_b16 a[220:221], v189 offset:18624
    ds_read_b64_tr_b16 a[222:223], v189 offset:21696
    s_waitcnt lgkmcnt(4)
    v_mfma_f32_32x32x16_bf16 v[0:15], a[208:211], a[172:175], v[0:15]
    ds_read_b64_tr_b16 a[224:225], v188 offset:18688
    ds_read_b64_tr_b16 a[226:227], v188 offset:21760
    v_mfma_f32_32x32x16_bf16 v[16:31], a[212:215], a[172:175], v[16:31]
    ds_read_b64_tr_b16 a[228:229], v189 offset:18752
    ds_read_b64_tr_b16 a[230:231], v189 offset:21824
    s_waitcnt lgkmcnt(4)
    v_mfma_f32_32x32x16_bf16 v[32:47], a[216:219], a[172:175], v[32:47]
    v_mfma_f32_32x32x16_bf16 v[48:63], a[220:223], a[172:175], v[48:63]
    s_waitcnt lgkmcnt(0)
    v_mfma_f32_32x32x16_bf16 v[64:79], a[224:227], a[172:175], v[64:79]
    v_mfma_f32_32x32x16_bf16 v[80:95], a[228:231], a[172:175], v[80:95]
gm_l2_kernel_epi:
    s_waitcnt lgkmcnt(0)
    s_barrier
    v_cvt_pk_bf16_f32 v96, v0, v1
    v_cvt_pk_bf16_f32 v97, v2, v3
    v_cvt_pk_bf16_f32 v98, v4, v5
    v_cvt_pk_bf16_f32 v99, v6, v7
    v_cvt_pk_bf16_f32 v100, v8, v9
    v_cvt_pk_bf16_f32 v101, v10, v11
    v_cvt_pk_bf16_f32 v102, v12, v13
    v_cvt_pk_bf16_f32 v103, v14, v15
    v_cvt_pk_bf16_f32 v104, v16, v17
    v_cvt_pk_bf16_f32 v105, v18, v19
    v_cvt_pk_bf16_f32 v106, v20, v21
    v_cvt_pk_bf16_f32 v107, v22, v23
    v_cvt_pk_bf16_f32 v108, v24, v25
    v_cvt_pk_bf16_f32 v109, v26, v27
    v_cvt_pk_bf16_f32 v110, v28, v29
    v_cvt_pk_bf16_f32 v111, v30, v31
    v_cvt_pk_bf16_f32 v112, v32, v33
    v_cvt_pk_bf16_f32 v113, v34, v35
    v_cvt_pk_bf16_f32 v114, v36, v37
    v_cvt_pk_bf16_f32 v115, v38, v39
    v_cvt_pk_bf16_f32 v116, v40, v41
    v_cvt_pk_bf16_f32 v117, v42, v43
    v_cvt_pk_bf16_f32 v118, v44, v45
    v_cvt_pk_bf16_f32 v119, v46, v47
    v_cvt_pk_bf16_f32 v120, v48, v49
    v_cvt_pk_bf16_f32 v121, v50, v51
    v_cvt_pk_bf16_f32 v122, v52, v53
    v_cvt_pk_bf16_f32 v123, v54, v55
    v_cvt_pk_bf16_f32 v124, v56, v57
    v_cvt_pk_bf16_f32 v125, v58, v59
    v_cvt_pk_bf16_f32 v126, v60, v61
    v_cvt_pk_bf16_f32 v127, v62, v63
    v_cvt_pk_bf16_f32 v128, v64, v65
    v_cvt_pk_bf16_f32 v129, v66, v67
    v_cvt_pk_bf16_f32 v130, v68, v69
    v_cvt_pk_bf16_f32 v131, v70, v71
    v_cvt_pk_bf16_f32 v132, v72, v73
    v_cvt_pk_bf16_f32 v133, v74, v75
    v_cvt_pk_bf16_f32 v134, v76, v77
    v_cvt_pk_bf16_f32 v135, v78, v79
    v_cvt_pk_bf16_f32 v136, v80, v81
    v_cvt_pk_bf16_f32 v137, v82, v83
    v_cvt_pk_bf16_f32 v138, v84, v85
    v_cvt_pk_bf16_f32 v139, v86, v87
    v_cvt_pk_bf16_f32 v140, v88, v89
    v_cvt_pk_bf16_f32 v141, v90, v91
    v_cvt_pk_bf16_f32 v142, v92, v93
    v_cvt_pk_bf16_f32 v143, v94, v95
    s_lshr_b32 s52, s3, 1
    s_and_b32 s53, s3, 1
    s_mul_i32 s53, s53, 6144
    v_add_u32 v210, s53, v184
    v_add_u32 v210, 77824, v210
    s_cmp_eq_u32 s52, s45
    s_cselect_b32 s54, s46, 2
    s_cmp_eq_u32 s54, 0
    s_cbranch_scc1 gm_l2_kernel_own0
    s_add_u32 s55, s42, 0
    buffer_store_dwordx4 v[96:99], v184, s[8:11], s55 offen offset:0 sc1
    buffer_store_dwordx4 v[100:103], v184, s[8:11], s55 offen offset:1024 sc1
    s_add_u32 s55, s42, 2048
    buffer_store_dwordx4 v[104:107], v184, s[8:11], s55 offen offset:0 sc1
    buffer_store_dwordx4 v[108:111], v184, s[8:11], s55 offen offset:1024 sc1
    s_add_u32 s55, s42, 4096
    buffer_store_dwordx4 v[112:115], v184, s[8:11], s55 offen offset:0 sc1
    buffer_store_dwordx4 v[116:119], v184, s[8:11], s55 offen offset:1024 sc1
    s_branch gm_l2_kernel_hd0
gm_l2_kernel_own0:
    ds_write_b128 v210, v[96:99] offset:0
    buffer_store_dwordx4 v[96:99], v184, s[24:27], 0 offen
    ds_write_b128 v210, v[100:103] offset:1024
    buffer_store_dwordx4 v[100:103], v184, s[24:27], 0 offen
    ds_write_b128 v210, v[104:107] offset:2048
    buffer_store_dwordx4 v[104:107], v184, s[24:27], 0 offen
    ds_write_b128 v210, v[108:111] offset:3072
    buffer_store_dwordx4 v[108:111], v184, s[24:27], 0 offen
    ds_write_b128 v210, v[112:115] offset:4096
    buffer_store_dwordx4 v[112:115], v184, s[24:27], 0 offen
    ds_write_b128 v210, v[116:119] offset:5120
    buffer_store_dwordx4 v[116:119], v184, s[24:27], 0 offen
gm_l2_kernel_hd0:
    s_cmp_eq_u32 s54, 1
    s_cbranch_scc1 gm_l2_kernel_own1
    s_add_u32 s55, s42, 6144
    buffer_store_dwordx4 v[120:123], v184, s[8:11], s55 offen offset:0 sc1
    buffer_store_dwordx4 v[124:127], v184, s[8:11], s55 offen offset:1024 sc1
    s_add_u32 s55, s42, 8192
    buffer_store_dwordx4 v[128:131], v184, s[8:11], s55 offen offset:0 sc1
    buffer_store_dwordx4 v[132:135], v184, s[8:11], s55 offen offset:1024 sc1
    s_add_u32 s55, s42, 10240
    buffer_store_dwordx4 v[136:139], v184, s[8:11], s55 offen offset:0 sc1
    buffer_store_dwordx4 v[140:143], v184, s[8:11], s55 offen offset:1024 sc1
    s_branch gm_l2_kernel_hd1
gm_l2_kernel_own1:
    ds_write_b128 v210, v[120:123] offset:0
    buffer_store_dwordx4 v[120:123], v184, s[24:27], 0 offen
    ds_write_b128 v210, v[124:127] offset:1024
    buffer_store_dwordx4 v[124:127], v184, s[24:27], 0 offen
    ds_write_b128 v210, v[128:131] offset:2048
    buffer_store_dwordx4 v[128:131], v184, s[24:27], 0 offen
    ds_write_b128 v210, v[132:135] offset:3072
    buffer_store_dwordx4 v[132:135], v184, s[24:27], 0 offen
    ds_write_b128 v210, v[136:139] offset:4096
    buffer_store_dwordx4 v[136:139], v184, s[24:27], 0 offen
    ds_write_b128 v210, v[140:143] offset:5120
    buffer_store_dwordx4 v[140:143], v184, s[24:27], 0 offen
gm_l2_kernel_hd1:
    s_waitcnt vmcnt(16)
    s_cmp_eq_u32 s3, 0
    s_cbranch_scc0 gm_l2_kernel_pf_ok
    s_mov_b32 s52, 0
gm_l2_kernel_pf:
    v_cmp_eq_u32 vcc, 0, v200
    s_add_u32 s52, s52, 1
    s_mov_b64 s[54:55], vcc
    s_cmp_eq_u64 s[54:55], 0
    s_cbranch_scc1 gm_l2_kernel_pf_ok
    s_cmp_ge_u32 s52, 0x40000
    s_cbranch_scc1 gm_l2_kernel_pf_ok
    s_sleep 4
    buffer_load_dword v200, v204, s[8:11], s47 offen sc1
    s_waitcnt vmcnt(0)
    s_branch gm_l2_kernel_pf
gm_l2_kernel_pf_ok:
    s_cmp_eq_u32 s3, 0
    s_cbranch_scc0 gm_l2_kernel_pg_ok
    s_mov_b32 s52, 0
gm_l2_kernel_pg:
    v_cmp_eq_u32 vcc, 0, v212
    s_add_u32 s52, s52, 1
    s_mov_b64 s[54:55], vcc
    s_cmp_eq_u64 s[54:55], 0
    s_cbranch_scc1 gm_l2_kernel_pg_ok
    s_cmp_ge_u32 s52, 0x40000
    s_cbranch_scc1 gm_l2_kernel_pg_ok
    s_sleep 4
    buffer_load_dword v212, v205, s[8:11], s84 offen sc1
    s_waitcnt vmcnt(0)
    s_branch gm_l2_kernel_pg
gm_l2_kernel_pg_ok:
    s_waitcnt lgkmcnt(0)
    s_barrier
    s_mul_i32 s59, s48, 36864
    s_mul_i32 s55, s3, 18432
    s_add_u32 s59, s59, s55
    s_add_u32 s59, s59, 25493504
    s_add_u32 m0, s55, 0
    s_add_u32 s52, s59, 0
    buffer_load_dwordx4 v184, s[8:11], s52 offen offset:0 lds
    buffer_load_dwordx4 v184, s[8:11], s52 offen offset:1024 lds
    buffer_load_dwordx4 v184, s[8:11], s52 offen offset:2048 lds
    buffer_load_dwordx4 v184, s[8:11], s52 offen offset:3072 lds
    s_add_u32 m0, s55, 4096
    s_add_u32 s52, s59, 4096
    buffer_load_dwordx4 v184, s[8:11], s52 offen offset:0 lds
    buffer_load_dwordx4 v184, s[8:11], s52 offen offset:1024 lds
    buffer_load_dwordx4 v184, s[8:11], s52 offen offset:2048 lds
    buffer_load_dwordx4 v184, s[8:11], s52 offen offset:3072 lds
    s_add_u32 m0, s55, 8192
    s_add_u32 s52, s59, 8192
    buffer_load_dwordx4 v184, s[8:11], s52 offen offset:0 lds
    buffer_load_dwordx4 v184, s[8:11], s52 offen offset:1024 lds
    buffer_load_dwordx4 v184, s[8:11], s52 offen offset:2048 lds
    buffer_load_dwordx4 v184, s[8:11], s52 offen offset:3072 lds
    s_add_u32 m0, s55, 12288
    s_add_u32 s52, s59, 12288
    buffer_load_dwordx4 v184, s[8:11], s52 offen offset:0 lds
    buffer_load_dwordx4 v184, s[8:11], s52 offen offset:1024 lds
    buffer_load_dwordx4 v184, s[8:11], s52 offen offset:2048 lds
    buffer_load_dwordx4 v184, s[8:11], s52 offen offset:3072 lds
    s_add_u32 m0, s55, 16384
    s_add_u32 s52, s59, 16384
    buffer_load_dwordx4 v184, s[8:11], s52 offen offset:0 lds
    buffer_load_dwordx4 v184, s[8:11], s52 offen offset:1024 lds
    v_and_b32 v208, 31, v192
    v_lshlrev_b32 v216, 1, v208
    s_lshl_b32 s52, s48, 6
    s_add_u32 s52, s52, 22020096
    buffer_load_ushort v188, v216, s[8:11], s52 offen
    buffer_load_ushort v189, v216, s[8:11], s52 offen offset:64
    v_lshrrev_b32 v209, 5, v192
    v_lshlrev_b32 v209, 3, v209
    v_bfe_u32 v211, v192, 2, 2
    v_add_u32 v209, v209, v211
    v_lshlrev_b32 v209, 6, v209
    v_bfe_u32 v211, v192, 4, 1
    v_lshlrev_b32 v211, 5, v211
    v_add_u32 v209, v209, v211
    v_and_b32 v211, 3, v192
    v_lshlrev_b32 v211, 3, v211
    v_add_u32 v186, v209, v211
    v_add_u32 v190, 36864, v186
    v_mul_u32_u24 v208, 1152, v208
    v_lshrrev_b32 v209, 5, v192
    v_lshlrev_b32 v209, 4, v209
    v_add_u32 v187, v208, v209
    s_mul_i32 s53, s48, 36864
    s_lshl_b32 s52, s49, 6
    s_add_u32 s53, s53, s52
    s_mov_b32 s16, s68
    s_mov_b32 s17, s69
    s_mov_b32 s18, 2359296
    s_mov_b32 s19, 0x20000
    s_cmp_eq_u32 s3, 3
    s_cselect_b32 s18, 0, s18
    s_mul_i32 s52, s48, 18
    s_add_u32 s52, s52, s49
    s_lshl_b32 s52, s52, 11
    s_add_u32 s52, s52, 27852800
    s_add_u32 s51, s5, 1
    s_and_b32 s51, s51, 3
    s_mul_i32 s51, s51, 2359296
    s_add_u32 s56, s51, s52
    s_add_u32 s51, s5, 2
    s_and_b32 s51, s51, 3
    s_mul_i32 s51, s51, 2359296
    s_add_u32 s57, s51, s52
    s_add_u32 s51, s5, 3
    s_and_b32 s51, s51, 3
    s_mul_i32 s51, s51, 2359296
    s_add_u32 s58, s51, s52
    s_lshl_b32 s51, s3, 11
    s_add_u32 s51, s51, 77824
    v_add_u32 v211, s51, v184
    s_waitcnt vmcnt(0) lgkmcnt(0)
    s_barrier
    ds_read_b128 v[64:67], v211 offset:0
    ds_read_b128 v[68:71], v211 offset:1024
    ds_read_b128 v[72:75], v211 offset:6144
    ds_read_b128 v[76:79], v211 offset:7168
    ds_read_b64_tr_b16 v[160:161], v186 offset:0
    ds_read_b64_tr_b16 v[162:163], v186 offset:256
    ds_read_b64_tr_b16 v[164:165], v190 offset:0
    ds_read_b64_tr_b16 v[166:167], v190 offset:256
    ds_read_b64_tr_b16 v[168:169], v186 offset:1024
    ds_read_b64_tr_b16 v[170:171], v186 offset:1280
    ds_read_b64_tr_b16 v[172:173], v190 offset:1024
    ds_read_b64_tr_b16 v[174:175], v190 offset:1280
    s_waitcnt vmcnt(63)
    s_waitcnt lgkmcnt(4)
    v_mfma_f32_32x32x16_bf16 v[0:15], a[0:3], v[160:163], 0
    ds_read_b64_tr_b16 v[176:177], v186 offset:2048
    ds_read_b64_tr_b16 v[178:179], v186 offset:2304
    v_mfma_f32_32x32x16_bf16 v[16:31], a[0:3], v[164:167], 0
    ds_read_b64_tr_b16 v[180:181], v190 offset:2048
    ds_read_b64_tr_b16 v[182:183], v190 offset:2304
    s_waitcnt vmcnt(63)
    s_waitcnt lgkmcnt(4)
    v_mfma_f32_32x32x16_bf16 v[0:15], a[4:7], v[168:171], v[0:15]
    ds_read_b64_tr_b16 v[160:161], v186 offset:3072
    ds_read_b64_tr_b16 v[162:163], v186 offset:3328
    v_mfma_f32_32x32x16_bf16 v[16:31], a[4:7], v[172:175], v[16:31]
    ds_read_b64_tr_b16 v[164:165], v190 offset:3072
    ds_read_b64_tr_b16 v[166:167], v190 offset:3328
    s_waitcnt vmcnt(63)
    s_waitcnt lgkmcnt(4)
    v_mfma_f32_32x32x16_bf16 v[0:15], a[8:11], v[176:179], v[0:15]
    ds_read_b64_tr_b16 v[168:169], v186 offset:4096
    ds_read_b64_tr_b16 v[170:171], v186 offset:4352
    s_add_u32 s55, s56, 0
    buffer_load_dwordx4 v[96:99], v184, s[20:23], s55 offen offset:0 sc1
    v_mfma_f32_32x32x16_bf16 v[16:31], a[8:11], v[180:183], v[16:31]
    ds_read_b64_tr_b16 v[172:173], v190 offset:4096
    ds_read_b64_tr_b16 v[174:175], v190 offset:4352
    s_waitcnt vmcnt(63)
    s_waitcnt lgkmcnt(4)
    v_mfma_f32_32x32x16_bf16 v[0:15], a[12:15], v[160:163], v[0:15]
    ds_read_b64_tr_b16 v[176:177], v186 offset:5120
    ds_read_b64_tr_b16 v[178:179], v186 offset:5376
    buffer_load_dwordx4 v[100:103], v184, s[20:23], s55 offen offset:1024 sc1
    v_mfma_f32_32x32x16_bf16 v[16:31], a[12:15], v[164:167], v[16:31]
    ds_read_b64_tr_b16 v[180:181], v190 offset:5120
    ds_read_b64_tr_b16 v[182:183], v190 offset:5376
    s_waitcnt vmcnt(63)
    s_waitcnt lgkmcnt(4)
    v_mfma_f32_32x32x16_bf16 v[0:15], a[16:19], v[168:171], v[0:15]
    ds_read_b64_tr_b16 v[160:161], v186 offset:6144
    ds_read_b64_tr_b16 v[162:163], v186 offset:6400
    s_add_u32 s55, s56, 36864
    buffer_load_dwordx4 v[104:107], v184, s[20:23], s55 offen offset:0 sc1
    v_mfma_f32_32x32x16_bf16 v[16:31], a[16:19], v[172:175], v[16:31]
    ds_read_b64_tr_b16 v[164:165], v190 offset:6144
    ds_read_b64_tr_b16 v[166:167], v190 offset:6400
    v_lshlrev_b32 v188, 16, v188
    s_waitcnt vmcnt(63)
    s_waitcnt lgkmcnt(4)
    v_mfma_f32_32x32x16_bf16 v[0:15], a[20:23], v[176:179], v[0:15]
    ds_read_b64_tr_b16 v[168:169], v186 offset:7168
    ds_read_b64_tr_b16 v[170:171], v186 offset:7424
    buffer_load_dwordx4 v[108:111], v184, s[20:23], s55 offen offset:1024 sc1
    v_mfma_f32_32x32x16_bf16 v[16:31], a[20:23], v[180:183], v[16:31]
    ds_read_b64_tr_b16 v[172:173], v190 offset:7168
    ds_read_b64_tr_b16 v[174:175], v190 offset:7424
    v_mul_f32 v188, 0xbfb8aa3b, v188
    s_waitcnt vmcnt(63)
    s_waitcnt lgkmcnt(4)
    v_mfma_f32_32x32x16_bf16 v[0:15], a[24:27], v[160:163], v[0:15]
    ds_read_b64_tr_b16 v[176:177], v186 offset:8192
    ds_read_b64_tr_b16 v[178:179], v186 offset:8448
    s_add_u32 s55, s57, 0
    buffer_load_dwordx4 v[112:115], v184, s[20:23], s55 offen offset:0 sc1
    v_mfma_f32_32x32x16_bf16 v[16:31], a[24:27], v[164:167], v[16:31]
    ds_read_b64_tr_b16 v[180:181], v190 offset:8192
    ds_read_b64_tr_b16 v[182:183], v190 offset:8448
    s_waitcnt vmcnt(63)
    s_waitcnt lgkmcnt(4)
    v_mfma_f32_32x32x16_bf16 v[0:15], a[28:31], v[168:171], v[0:15]
    ds_read_b64_tr_b16 v[160:161], v186 offset:9216
    ds_read_b64_tr_b16 v[162:163], v186 offset:9472
    buffer_load_dwordx4 v[116:119], v184, s[20:23], s55 offen offset:1024 sc1
    v_exp_f32 v188, v188
    s_nop 0
    v_mfma_f32_32x32x16_bf16 v[16:31], a[28:31], v[172:175], v[16:31]
    ds_read_b64_tr_b16 v[164:165], v190 offset:9216
    ds_read_b64_tr_b16 v[166:167], v190 offset:9472
    s_waitcnt vmcnt(63)
    s_waitcnt lgkmcnt(4)
    v_mfma_f32_32x32x16_bf16 v[0:15], a[32:35], v[176:179], v[0:15]
    ds_read_b64_tr_b16 v[168:169], v186 offset:10240
    ds_read_b64_tr_b16 v[170:171], v186 offset:10496
    s_add_u32 s55, s57, 36864
    buffer_load_dwordx4 v[120:123], v184, s[20:23], s55 offen offset:0 sc1
    v_mfma_f32_32x32x16_bf16 v[16:31], a[32:35], v[180:183], v[16:31]
    ds_read_b64_tr_b16 v[172:173], v190 offset:10240
    ds_read_b64_tr_b16 v[174:175], v190 offset:10496
    s_waitcnt vmcnt(63)
    s_waitcnt lgkmcnt(4)
    v_mfma_f32_32x32x16_bf16 v[0:15], a[36:39], v[160:163], v[0:15]
    ds_read_b64_tr_b16 v[176:177], v186 offset:11264
    ds_read_b64_tr_b16 v[178:179], v186 offset:11520
    buffer_load_dwordx4 v[124:127], v184, s[20:23], s55 offen offset:1024 sc1
    v_add_f32 v188, 1.0, v188
    v_mfma_f32_32x32x16_bf16 v[16:31], a[36:39], v[164:167], v[16:31]
    ds_read_b64_tr_b16 v[180:181], v190 offset:11264
    ds_read_b64_tr_b16 v[182:183], v190 offset:11520
    s_waitcnt vmcnt(63)
    s_waitcnt lgkmcnt(4)
    v_mfma_f32_32x32x16_bf16 v[0:15], a[40:43], v[168:171], v[0:15]
    ds_read_b64_tr_b16 v[160:161], v186 offset:12288
    ds_read_b64_tr_b16 v[162:163], v186 offset:12544
    s_add_u32 s55, s58, 0
    buffer_load_dwordx4 v[128:131], v184, s[20:23], s55 offen offset:0 sc1
    v_mfma_f32_32x32x16_bf16 v[16:31], a[40:43], v[172:175], v[16:31]
    ds_read_b64_tr_b16 v[164:165], v190 offset:12288
    ds_read_b64_tr_b16 v[166:167], v190 offset:12544
    s_waitcnt vmcnt(63)
    s_waitcnt lgkmcnt(4)
    v_mfma_f32_32x32x16_bf16 v[0:15], a[44:47], v[176:179], v[0:15]
    ds_read_b64_tr_b16 v[168:169], v186 offset:13312
    ds_read_b64_tr_b16 v[170:171], v186 offset:13568
    buffer_load_dwordx4 v[132:135], v184, s[20:23], s55 offen offset:1024 sc1
    v_rcp_f32 v188, v188
    s_nop 0
    v_mfma_f32_32x32x16_bf16 v[16:31], a[44:47], v[180:183], v[16:31]
    ds_read_b64_tr_b16 v[172:173], v190 offset:13312
    ds_read_b64_tr_b16 v[174:175], v190 offset:13568
    s_waitcnt vmcnt(63)
    s_waitcnt lgkmcnt(4)
    v_mfma_f32_32x32x16_bf16 v[0:15], a[48:51], v[160:163], v[0:15]
    ds_read_b64_tr_b16 v[176:177], v186 offset:14336
    ds_read_b64_tr_b16 v[178:179], v186 offset:14592
    s_add_u32 s55, s58, 36864
    buffer_load_dwordx4 v[136:139], v184, s[20:23], s55 offen offset:0 sc1
    v_mfma_f32_32x32x16_bf16 v[16:31], a[48:51], v[164:167], v[16:31]
    ds_read_b64_tr_b16 v[180:181], v190 offset:14336
    ds_read_b64_tr_b16 v[182:183], v190 offset:14592
    v_lshlrev_b32 v189, 16, v189
    s_waitcnt vmcnt(63)
    s_waitcnt lgkmcnt(4)
    v_mfma_f32_32x32x16_bf16 v[0:15], a[52:55], v[168:171], v[0:15]
    ds_read_b64_tr_b16 v[160:161], v186 offset:15360
    ds_read_b64_tr_b16 v[162:163], v186 offset:15616
    buffer_load_dwordx4 v[140:143], v184, s[20:23], s55 offen offset:1024 sc1
    v_mfma_f32_32x32x16_bf16 v[16:31], a[52:55], v[172:175], v[16:31]
    ds_read_b64_tr_b16 v[164:165], v190 offset:15360
    ds_read_b64_tr_b16 v[166:167], v190 offset:15616
    v_mul_f32 v189, 0xbfb8aa3b, v189
    s_waitcnt vmcnt(63)
    s_waitcnt lgkmcnt(4)
    v_mfma_f32_32x32x16_bf16 v[0:15], a[56:59], v[176:179], v[0:15]
    ds_read_b64_tr_b16 v[168:169], v186 offset:16384
    ds_read_b64_tr_b16 v[170:171], v186 offset:16640
    v_mfma_f32_32x32x16_bf16 v[16:31], a[56:59], v[180:183], v[16:31]
    ds_read_b64_tr_b16 v[172:173], v190 offset:16384
    ds_read_b64_tr_b16 v[174:175], v190 offset:16640
    v_exp_f32 v189, v189
    s_nop 0
    s_waitcnt vmcnt(63)
    s_waitcnt lgkmcnt(4)
    v_mfma_f32_32x32x16_bf16 v[0:15], a[60:63], v[160:163], v[0:15]
    ds_read_b64_tr_b16 v[176:177], v186 offset:17408
    ds_read_b64_tr_b16 v[178:179], v186 offset:17664
    v_mfma_f32_32x32x16_bf16 v[16:31], a[60:63], v[164:167], v[16:31]
    ds_read_b64_tr_b16 v[180:181], v190 offset:17408
    ds_read_b64_tr_b16 v[182:183], v190 offset:17664
    s_waitcnt vmcnt(63)
    s_waitcnt lgkmcnt(4)
    v_mfma_f32_32x32x16_bf16 v[0:15], a[64:67], v[168:171], v[0:15]
    ds_read_b64_tr_b16 v[160:161], v186 offset:18432
    ds_read_b64_tr_b16 v[162:163], v186 offset:18688
    v_add_f32 v189, 1.0, v189
    v_mfma_f32_32x32x16_bf16 v[16:31], a[64:67], v[172:175], v[16:31]
    ds_read_b64_tr_b16 v[164:165], v190 offset:18432
    ds_read_b64_tr_b16 v[166:167], v190 offset:18688
    s_waitcnt vmcnt(63)
    s_waitcnt lgkmcnt(4)
    v_mfma_f32_32x32x16_bf16 v[0:15], a[68:71], v[176:179], v[0:15]
    ds_read_b64_tr_b16 v[168:169], v186 offset:19456
    ds_read_b64_tr_b16 v[170:171], v186 offset:19712
    v_rcp_f32 v189, v189
    s_nop 0
    v_mfma_f32_32x32x16_bf16 v[16:31], a[68:71], v[180:183], v[16:31]
    ds_read_b64_tr_b16 v[172:173], v190 offset:19456
    ds_read_b64_tr_b16 v[174:175], v190 offset:19712
    s_waitcnt vmcnt(63)
    s_waitcnt lgkmcnt(4)
    v_mfma_f32_32x32x16_bf16 v[0:15], a[72:75], v[160:163], v[0:15]
    ds_read_b64_tr_b16 v[176:177], v186 offset:20480
    ds_read_b64_tr_b16 v[178:179], v186 offset:20736
    v_lshlrev_b32 v32, 16, v64
    v_mfma_f32_32x32x16_bf16 v[16:31], a[72:75], v[164:167], v[16:31]
    ds_read_b64_tr_b16 v[180:181], v190 offset:20480
    ds_read_b64_tr_b16 v[182:183], v190 offset:20736
    s_waitcnt vmcnt(63)
    s_waitcnt lgkmcnt(4)
    v_mfma_f32_32x32x16_bf16 v[0:15], a[76:79], v[168:171], v[0:15]
    ds_read_b64_tr_b16 v[160:161], v186 offset:21504
    ds_read_b64_tr_b16 v[162:163], v186 offset:21760
    v_and_b32 v33, 0xffff0000, v64
    v_mfma_f32_32x32x16_bf16 v[16:31], a[76:79], v[172:175], v[16:31]
    ds_read_b64_tr_b16 v[164:165], v190 offset:21504
    ds_read_b64_tr_b16 v[166:167], v190 offset:21760
    v_lshlrev_b32 v34, 16, v65
    s_waitcnt vmcnt(63)
    s_waitcnt lgkmcnt(4)
    v_mfma_f32_32x32x16_bf16 v[0:15], a[80:83], v[176:179], v[0:15]
    ds_read_b64_tr_b16 v[168:169], v186 offset:22528
    ds_read_b64_tr_b16 v[170:171], v186 offset:22784
    v_and_b32 v35, 0xffff0000, v65
    v_mfma_f32_32x32x16_bf16 v[16:31], a[80:83], v[180:183], v[16:31]
    ds_read_b64_tr_b16 v[172:173], v190 offset:22528
    ds_read_b64_tr_b16 v[174:175], v190 offset:22784
    v_lshlrev_b32 v36, 16, v66
    s_waitcnt vmcnt(63)
    s_waitcnt lgkmcnt(4)
    v_mfma_f32_32x32x16_bf16 v[0:15], a[84:87], v[160:163], v[0:15]
    ds_read_b64_tr_b16 v[176:177], v186 offset:23552
    ds_read_b64_tr_b16 v[178:179], v186 offset:23808
    v_and_b32 v37, 0xffff0000, v66
    v_mfma_f32_32x32x16_bf16 v[16:31], a[84:87], v[164:167], v[16:31]
    ds_read_b64_tr_b16 v[180:181], v190 offset:23552
    ds_read_b64_tr_b16 v[182:183], v190 offset:23808
    s_waitcnt vmcnt(63)
    s_waitcnt lgkmcnt(4)
    v_mfma_f32_32x32x16_bf16 v[0:15], a[88:91], v[168:171], v[0:15]
    ds_read_b64_tr_b16 v[160:161], v186 offset:24576
    ds_read_b64_tr_b16 v[162:163], v186 offset:24832
    v_lshlrev_b32 v38, 16, v67
    v_mfma_f32_32x32x16_bf16 v[16:31], a[88:91], v[172:175], v[16:31]
    ds_read_b64_tr_b16 v[164:165], v190 offset:24576
    ds_read_b64_tr_b16 v[166:167], v190 offset:24832
    v_and_b32 v39, 0xffff0000, v67
    s_waitcnt vmcnt(63)
    s_waitcnt lgkmcnt(4)
    v_mfma_f32_32x32x16_bf16 v[0:15], a[92:95], v[176:179], v[0:15]
    ds_read_b64_tr_b16 v[168:169], v186 offset:25600
    ds_read_b64_tr_b16 v[170:171], v186 offset:25856
    v_lshlrev_b32 v40, 16, v68
    v_mfma_f32_32x32x16_bf16 v[16:31], a[92:95], v[180:183], v[16:31]
    ds_read_b64_tr_b16 v[172:173], v190 offset:25600
    ds_read_b64_tr_b16 v[174:175], v190 offset:25856
    v_and_b32 v41, 0xffff0000, v68
    s_waitcnt vmcnt(63)
    s_waitcnt lgkmcnt(4)
    v_mfma_f32_32x32x16_bf16 v[0:15], a[96:99], v[160:163], v[0:15]
    ds_read_b64_tr_b16 v[176:177], v186 offset:26624
    ds_read_b64_tr_b16 v[178:179], v186 offset:26880
    v_lshlrev_b32 v42, 16, v69
    v_mfma_f32_32x32x16_bf16 v[16:31], a[96:99], v[164:167], v[16:31]
    ds_read_b64_tr_b16 v[180:181], v190 offset:26624
    ds_read_b64_tr_b16 v[182:183], v190 offset:26880
    s_waitcnt vmcnt(63)
    s_waitcnt lgkmcnt(4)
    v_mfma_f32_32x32x16_bf16 v[0:15], a[100:103], v[168:171], v[0:15]
    ds_read_b64_tr_b16 v[160:161], v186 offset:27648
    ds_read_b64_tr_b16 v[162:163], v186 offset:27904
    v_and_b32 v43, 0xffff0000, v69
    v_mfma_f32_32x32x16_bf16 v[16:31], a[100:103], v[172:175], v[16:31]
    ds_read_b64_tr_b16 v[164:165], v190 offset:27648
    ds_read_b64_tr_b16 v[166:167], v190 offset:27904
    v_lshlrev_b32 v44, 16, v70
    s_waitcnt vmcnt(63)
    s_waitcnt lgkmcnt(4)
    v_mfma_f32_32x32x16_bf16 v[0:15], a[104:107], v[176:179], v[0:15]
    ds_read_b64_tr_b16 v[168:169], v186 offset:28672
    ds_read_b64_tr_b16 v[170:171], v186 offset:28928
    v_and_b32 v45, 0xffff0000, v70
    v_mfma_f32_32x32x16_bf16 v[16:31], a[104:107], v[180:183], v[16:31]
    ds_read_b64_tr_b16 v[172:173], v190 offset:28672
    ds_read_b64_tr_b16 v[174:175], v190 offset:28928
    v_lshlrev_b32 v46, 16, v71
    s_waitcnt vmcnt(63)
    s_waitcnt lgkmcnt(4)
    v_mfma_f32_32x32x16_bf16 v[0:15], a[108:111], v[160:163], v[0:15]
    ds_read_b64_tr_b16 v[176:177], v186 offset:29696
    ds_read_b64_tr_b16 v[178:179], v186 offset:29952
    v_and_b32 v47, 0xffff0000, v71
    v_mfma_f32_32x32x16_bf16 v[16:31], a[108:111], v[164:167], v[16:31]
    ds_read_b64_tr_b16 v[180:181], v190 offset:29696
    ds_read_b64_tr_b16 v[182:183], v190 offset:29952
    s_waitcnt vmcnt(56)
    s_waitcnt lgkmcnt(4)
    v_mfma_f32_32x32x16_bf16 v[0:15], a[112:115], v[168:171], v[0:15]
    ds_read_b64_tr_b16 v[160:161], v186 offset:30720
    ds_read_b64_tr_b16 v[162:163], v186 offset:30976
    v_lshlrev_b32 v48, 16, v72
    v_mfma_f32_32x32x16_bf16 v[16:31], a[112:115], v[172:175], v[16:31]
    ds_read_b64_tr_b16 v[164:165], v190 offset:30720
    ds_read_b64_tr_b16 v[166:167], v190 offset:30976
    v_and_b32 v49, 0xffff0000, v72
    s_waitcnt vmcnt(54)
    s_waitcnt lgkmcnt(4)
    v_mfma_f32_32x32x16_bf16 v[0:15], a[116:119], v[176:179], v[0:15]
    ds_read_b64_tr_b16 v[168:169], v186 offset:31744
    ds_read_b64_tr_b16 v[170:171], v186 offset:32000
    v_lshlrev_b32 v50, 16, v73
    v_mfma_f32_32x32x16_bf16 v[16:31], a[116:119], v[180:183], v[16:31]
    ds_read_b64_tr_b16 v[172:173], v190 offset:31744
    ds_read_b64_tr_b16 v[174:175], v190 offset:32000
    v_and_b32 v51, 0xffff0000, v73
    s_waitcnt vmcnt(51)
    s_waitcnt lgkmcnt(4)
    v_mfma_f32_32x32x16_bf16 v[0:15], a[120:123], v[160:163], v[0:15]
    ds_read_b64_tr_b16 v[176:177], v186 offset:32768
    ds_read_b64_tr_b16 v[178:179], v186 offset:33024
    v_lshlrev_b32 v52, 16, v74
    v_mfma_f32_32x32x16_bf16 v[16:31], a[120:123], v[164:167], v[16:31]
    ds_read_b64_tr_b16 v[180:181], v190 offset:32768
    ds_read_b64_tr_b16 v[182:183], v190 offset:33024
    s_waitcnt vmcnt(50)
    s_waitcnt lgkmcnt(4)
    v_mfma_f32_32x32x16_bf16 v[0:15], a[124:127], v[168:171], v[0:15]
    ds_read_b64_tr_b16 v[160:161], v186 offset:33792
    ds_read_b64_tr_b16 v[162:163], v186 offset:34048
    v_and_b32 v53, 0xffff0000, v74
    v_mfma_f32_32x32x16_bf16 v[16:31], a[124:127], v[172:175], v[16:31]
    ds_read_b64_tr_b16 v[164:165], v190 offset:33792
    ds_read_b64_tr_b16 v[166:167], v190 offset:34048
    v_lshlrev_b32 v54, 16, v75
    s_waitcnt vmcnt(47)
    s_waitcnt lgkmcnt(4)
    v_mfma_f32_32x32x16_bf16 v[0:15], a[128:131], v[176:179], v[0:15]
    ds_read_b64_tr_b16 v[168:169], v186 offset:34816
    ds_read_b64_tr_b16 v[170:171], v186 offset:35072
    v_and_b32 v55, 0xffff0000, v75
    v_mfma_f32_32x32x16_bf16 v[16:31], a[128:131], v[180:183], v[16:31]
    ds_read_b64_tr_b16 v[172:173], v190 offset:34816
    ds_read_b64_tr_b16 v[174:175], v190 offset:35072
    v_lshlrev_b32 v56, 16, v76
    s_waitcnt vmcnt(46)
    s_waitcnt lgkmcnt(4)
    v_mfma_f32_32x32x16_bf16 v[0:15], a[132:135], v[160:163], v[0:15]
    ds_read_b64_tr_b16 v[176:177], v186 offset:35840
    ds_read_b64_tr_b16 v[178:179], v186 offset:36096
    v_and_b32 v57, 0xffff0000, v76
    v_mfma_f32_32x32x16_bf16 v[16:31], a[132:135], v[164:167], v[16:31]
    ds_read_b64_tr_b16 v[180:181], v190 offset:35840
    ds_read_b64_tr_b16 v[182:183], v190 offset:36096
    s_waitcnt vmcnt(45)
    s_waitcnt lgkmcnt(4)
    v_mfma_f32_32x32x16_bf16 v[0:15], a[136:139], v[168:171], v[0:15]
    v_lshlrev_b32 v58, 16, v77
    v_and_b32 v59, 0xffff0000, v77
    v_mfma_f32_32x32x16_bf16 v[16:31], a[136:139], v[172:175], v[16:31]
    v_lshlrev_b32 v60, 16, v78
    s_waitcnt vmcnt(44)
    s_waitcnt lgkmcnt(0)
    v_mfma_f32_32x32x16_bf16 v[0:15], a[140:143], v[176:179], v[0:15]
    v_and_b32 v61, 0xffff0000, v78
    v_lshlrev_b32 v62, 16, v79
    v_mfma_f32_32x32x16_bf16 v[16:31], a[140:143], v[180:183], v[16:31]
    v_and_b32 v63, 0xffff0000, v79
    s_mov_b32 s51, 0
    s_waitcnt vmcnt(0)
gm_l2_kernel_qchk:
    v_max3_u32 v208, v96, v97, v98
    v_max3_u32 v208, v208, v99, v100
    v_max3_u32 v208, v208, v101, v102
    v_max3_u32 v208, v208, v103, v104
    v_max3_u32 v208, v208, v105, v106
    v_max3_u32 v208, v208, v107, v108
    v_max3_u32 v208, v208, v109, v110
    v_max3_u32 v208, v208, v111, v112
    v_max3_u32 v208, v208, v113, v114
    v_max3_u32 v208, v208, v115, v116
    v_max3_u32 v208, v208, v117, v118
    v_max3_u32 v208, v208, v119, v120
    v_max3_u32 v208, v208, v121, v122
    v_max3_u32 v208, v208, v123, v124
    v_max3_u32 v208, v208, v125, v126
    v_max3_u32 v208, v208, v127, v128
    v_max3_u32 v208, v208, v129, v130
    v_max3_u32 v208, v208, v131, v132
    v_max3_u32 v208, v208, v133, v134
    v_max3_u32 v208, v208, v135, v136
    v_max3_u32 v208, v208, v137, v138
    v_max3_u32 v208, v208, v139, v140
    v_max3_u32 v208, v208, v141, v142
    v_max_u32 v208, v208, v143
    v_cmp_eq_u32 vcc, -1, v208
    s_add_u32 s51, s51, 1
    s_cmp_eq_u64 vcc, 0
    s_cbranch_scc1 gm_l2_kernel_qok
    s_cmp_ge_u32 s51, 4096
    s_cbranch_scc1 gm_l2_kernel_qok
    s_add_u32 s55, s56, 0
    buffer_load_dwordx4 v[96:99], v184, s[20:23], s55 offen offset:0 sc1
    buffer_load_dwordx4 v[100:103], v184, s[20:23], s55 offen offset:1024 sc1
    s_add_u32 s55, s56, 36864
    buffer_load_dwordx4 v[104:107], v184, s[20:23], s55 offen offset:0 sc1
    buffer_load_dwordx4 v[108:111], v184, s[20:23], s55 offen offset:1024 sc1
    s_add_u32 s55, s57, 0
    buffer_load_dwordx4 v[112:115], v184, s[20:23], s55 offen offset:0 sc1
    buffer_load_dwordx4 v[116:119], v184, s[20:23], s55 offen offset:1024 sc1
    s_add_u32 s55, s57, 36864
    buffer_load_dwordx4 v[120:123], v184, s[20:23], s55 offen offset:0 sc1
    buffer_load_dwordx4 v[124:127], v184, s[20:23], s55 offen offset:1024 sc1
    s_add_u32 s55, s58, 0
    buffer_load_dwordx4 v[128:131], v184, s[20:23], s55 offen offset:0 sc1
    buffer_load_dwordx4 v[132:135], v184, s[20:23], s55 offen offset:1024 sc1
    s_add_u32 s55, s58, 36864
    buffer_load_dwordx4 v[136:139], v184, s[20:23], s55 offen offset:0 sc1
    buffer_load_dwordx4 v[140:143], v184, s[20:23], s55 offen offset:1024 sc1
    s_waitcnt vmcnt(0)
    s_branch gm_l2_kernel_qchk
gm_l2_kernel_qok:
    v_lshlrev_b32 v208, 16, v96
    v_and_b32 v96, 0xffff0000, v96
    v_add_f32 v32, v32, v208
    v_add_f32 v33, v33, v96
    v_lshlrev_b32 v208, 16, v97
    v_and_b32 v97, 0xffff0000, v97
    v_add_f32 v34, v34, v208
    v_add_f32 v35, v35, v97
    v_lshlrev_b32 v208, 16, v98
    v_and_b32 v98, 0xffff0000, v98
    v_add_f32 v36, v36, v208
    v_add_f32 v37, v37, v98
    v_lshlrev_b32 v208, 16, v99
    v_and_b32 v99, 0xffff0000, v99
    v_add_f32 v38, v38, v208
    v_add_f32 v39, v39, v99
    v_lshlrev_b32 v208, 16, v100
    v_and_b32 v100, 0xffff0000, v100
    v_add_f32 v40, v40, v208
    v_add_f32 v41, v41, v100
    v_lshlrev_b32 v208, 16, v101
    v_and_b32 v101, 0xffff0000, v101
    v_add_f32 v42, v42, v208
    v_add_f32 v43, v43, v101
    v_lshlrev_b32 v208, 16, v102
    v_and_b32 v102, 0xffff0000, v102
    v_add_f32 v44, v44, v208
    v_add_f32 v45, v45, v102
    v_lshlrev_b32 v208, 16, v103
    v_and_b32 v103, 0xffff0000, v103
    v_add_f32 v46, v46, v208
    v_add_f32 v47, v47, v103
    v_lshlrev_b32 v208, 16, v104
    v_and_b32 v104, 0xffff0000, v104
    v_add_f32 v48, v48, v208
    v_add_f32 v49, v49, v104
    v_lshlrev_b32 v208, 16, v105
    v_and_b32 v105, 0xffff0000, v105
    v_add_f32 v50, v50, v208
    v_add_f32 v51, v51, v105
    v_lshlrev_b32 v208, 16, v106
    v_and_b32 v106, 0xffff0000, v106
    v_add_f32 v52, v52, v208
    v_add_f32 v53, v53, v106
    v_lshlrev_b32 v208, 16, v107
    v_and_b32 v107, 0xffff0000, v107
    v_add_f32 v54, v54, v208
    v_add_f32 v55, v55, v107
    v_lshlrev_b32 v208, 16, v108
    v_and_b32 v108, 0xffff0000, v108
    v_add_f32 v56, v56, v208
    v_add_f32 v57, v57, v108
    v_lshlrev_b32 v208, 16, v109
    v_and_b32 v109, 0xffff0000, v109
    v_add_f32 v58, v58, v208
    v_add_f32 v59, v59, v109
    v_lshlrev_b32 v208, 16, v110
    v_and_b32 v110, 0xffff0000, v110
    v_add_f32 v60, v60, v208
    v_add_f32 v61, v61, v110
    v_lshlrev_b32 v208, 16, v111
    v_and_b32 v111, 0xffff0000, v111
    v_add_f32 v62, v62, v208
    v_add_f32 v63, v63, v111
    v_lshlrev_b32 v208, 16, v112
    v_and_b32 v112, 0xffff0000, v112
    v_add_f32 v32, v32, v208
    v_add_f32 v33, v33, v112
    v_lshlrev_b32 v208, 16, v113
    v_and_b32 v113, 0xffff0000, v113
    v_add_f32 v34, v34, v208
    v_add_f32 v35, v35, v113
    v_lshlrev_b32 v208, 16, v114
    v_and_b32 v114, 0xffff0000, v114
    v_add_f32 v36, v36, v208
    v_add_f32 v37, v37, v114
    v_lshlrev_b32 v208, 16, v115
    v_and_b32 v115, 0xffff0000, v115
    v_add_f32 v38, v38, v208
    v_add_f32 v39, v39, v115
    v_lshlrev_b32 v208, 16, v116
    v_and_b32 v116, 0xffff0000, v116
    v_add_f32 v40, v40, v208
    v_add_f32 v41, v41, v116
    v_lshlrev_b32 v208, 16, v117
    v_and_b32 v117, 0xffff0000, v117
    v_add_f32 v42, v42, v208
    v_add_f32 v43, v43, v117
    v_lshlrev_b32 v208, 16, v118
    v_and_b32 v118, 0xffff0000, v118
    v_add_f32 v44, v44, v208
    v_add_f32 v45, v45, v118
    v_lshlrev_b32 v208, 16, v119
    v_and_b32 v119, 0xffff0000, v119
    v_add_f32 v46, v46, v208
    v_add_f32 v47, v47, v119
    v_lshlrev_b32 v208, 16, v120
    v_and_b32 v120, 0xffff0000, v120
    v_add_f32 v48, v48, v208
    v_add_f32 v49, v49, v120
    v_lshlrev_b32 v208, 16, v121
    v_and_b32 v121, 0xffff0000, v121
    v_add_f32 v50, v50, v208
    v_add_f32 v51, v51, v121
    v_lshlrev_b32 v208, 16, v122
    v_and_b32 v122, 0xffff0000, v122
    v_add_f32 v52, v52, v208
    v_add_f32 v53, v53, v122
    v_lshlrev_b32 v208, 16, v123
    v_and_b32 v123, 0xffff0000, v123
    v_add_f32 v54, v54, v208
    v_add_f32 v55, v55, v123
    v_lshlrev_b32 v208, 16, v124
    v_and_b32 v124, 0xffff0000, v124
    v_add_f32 v56, v56, v208
    v_add_f32 v57, v57, v124
    v_lshlrev_b32 v208, 16, v125
    v_and_b32 v125, 0xffff0000, v125
    v_add_f32 v58, v58, v208
    v_add_f32 v59, v59, v125
    v_lshlrev_b32 v208, 16, v126
    v_and_b32 v126, 0xffff0000, v126
    v_add_f32 v60, v60, v208
    v_add_f32 v61, v61, v126
    v_lshlrev_b32 v208, 16, v127
    v_and_b32 v127, 0xffff0000, v127
    v_add_f32 v62, v62, v208
    v_add_f32 v63, v63, v127
    v_lshlrev_b32 v208, 16, v128
    v_and_b32 v128, 0xffff0000, v128
    v_add_f32 v32, v32, v208
    v_add_f32 v33, v33, v128
    v_lshlrev_b32 v208, 16, v129
    v_and_b32 v129, 0xffff0000, v129
    v_add_f32 v34, v34, v208
    v_add_f32 v35, v35, v129
    v_lshlrev_b32 v208, 16, v130
    v_and_b32 v130, 0xffff0000, v130
    v_add_f32 v36, v36, v208
    v_add_f32 v37, v37, v130
    v_lshlrev_b32 v208, 16, v131
    v_and_b32 v131, 0xffff0000, v131
    v_add_f32 v38, v38, v208
    v_add_f32 v39, v39, v131
    v_lshlrev_b32 v208, 16, v132
    v_and_b32 v132, 0xffff0000, v132
    v_add_f32 v40, v40, v208
    v_add_f32 v41, v41, v132
    v_lshlrev_b32 v208, 16, v133
    v_and_b32 v133, 0xffff0000, v133
    v_add_f32 v42, v42, v208
    v_add_f32 v43, v43, v133
    v_lshlrev_b32 v208, 16, v134
    v_and_b32 v134, 0xffff0000, v134
    v_add_f32 v44, v44, v208
    v_add_f32 v45, v45, v134
    v_lshlrev_b32 v208, 16, v135
    v_and_b32 v135, 0xffff0000, v135
    v_add_f32 v46, v46, v208
    v_add_f32 v47, v47, v135
    v_lshlrev_b32 v208, 16, v136
    v_and_b32 v136, 0xffff0000, v136
    v_add_f32 v48, v48, v208
    v_add_f32 v49, v49, v136
    v_lshlrev_b32 v208, 16, v137
    v_and_b32 v137, 0xffff0000, v137
    v_add_f32 v50, v50, v208
    v_add_f32 v51, v51, v137
    v_lshlrev_b32 v208, 16, v138
    v_and_b32 v138, 0xffff0000, v138
    v_add_f32 v52, v52, v208
    v_add_f32 v53, v53, v138
    v_lshlrev_b32 v208, 16, v139
    v_and_b32 v139, 0xffff0000, v139
    v_add_f32 v54, v54, v208
    v_add_f32 v55, v55, v139
    v_lshlrev_b32 v208, 16, v140
    v_and_b32 v140, 0xffff0000, v140
    v_add_f32 v56, v56, v208
    v_add_f32 v57, v57, v140
    v_lshlrev_b32 v208, 16, v141
    v_and_b32 v141, 0xffff0000, v141
    v_add_f32 v58, v58, v208
    v_add_f32 v59, v59, v141
    v_lshlrev_b32 v208, 16, v142
    v_and_b32 v142, 0xffff0000, v142
    v_add_f32 v60, v60, v208
    v_add_f32 v61, v61, v142
    v_lshlrev_b32 v208, 16, v143
    v_and_b32 v143, 0xffff0000, v143
    v_add_f32 v62, v62, v208
    v_add_f32 v63, v63, v143
    v_sub_f32 v0, v0, v32
    v_fma_f32 v0, v0, v188, v32
    v_sub_f32 v1, v1, v33
    v_fma_f32 v1, v1, v188, v33
    v_sub_f32 v2, v2, v34
    v_fma_f32 v2, v2, v188, v34
    v_sub_f32 v3, v3, v35
    v_fma_f32 v3, v3, v188, v35
    v_sub_f32 v4, v4, v36
    v_fma_f32 v4, v4, v188, v36
    v_sub_f32 v5, v5, v37
    v_fma_f32 v5, v5, v188, v37
    v_sub_f32 v6, v6, v38
    v_fma_f32 v6, v6, v188, v38
    v_sub_f32 v7, v7, v39
    v_fma_f32 v7, v7, v188, v39
    v_cvt_pk_bf16_f32 v144, v0, v1
    v_cvt_pk_bf16_f32 v145, v2, v3
    v_cvt_pk_bf16_f32 v146, v4, v5
    v_cvt_pk_bf16_f32 v147, v6, v7
    s_nop 1
    v_permlane32_swap_b32 v144, v146
    v_permlane32_swap_b32 v145, v147
    buffer_store_dwordx4 v[144:147], v187, s[16:19], s53 offen offset:0
    v_sub_f32 v8, v8, v40
    v_fma_f32 v8, v8, v188, v40
    v_sub_f32 v9, v9, v41
    v_fma_f32 v9, v9, v188, v41
    v_sub_f32 v10, v10, v42
    v_fma_f32 v10, v10, v188, v42
    v_sub_f32 v11, v11, v43
    v_fma_f32 v11, v11, v188, v43
    v_sub_f32 v12, v12, v44
    v_fma_f32 v12, v12, v188, v44
    v_sub_f32 v13, v13, v45
    v_fma_f32 v13, v13, v188, v45
    v_sub_f32 v14, v14, v46
    v_fma_f32 v14, v14, v188, v46
    v_sub_f32 v15, v15, v47
    v_fma_f32 v15, v15, v188, v47
    v_cvt_pk_bf16_f32 v148, v8, v9
    v_cvt_pk_bf16_f32 v149, v10, v11
    v_cvt_pk_bf16_f32 v150, v12, v13
    v_cvt_pk_bf16_f32 v151, v14, v15
    s_nop 1
    v_permlane32_swap_b32 v148, v150
    v_permlane32_swap_b32 v149, v151
    buffer_store_dwordx4 v[148:151], v187, s[16:19], s53 offen offset:32
    s_add_u32 s53, s53, 36864
    v_sub_f32 v16, v16, v48
    v_fma_f32 v16, v16, v189, v48
    v_sub_f32 v17, v17, v49
    v_fma_f32 v17, v17, v189, v49
    v_sub_f32 v18, v18, v50
    v_fma_f32 v18, v18, v189, v50
    v_sub_f32 v19, v19, v51
    v_fma_f32 v19, v19, v189, v51
    v_sub_f32 v20, v20, v52
    v_fma_f32 v20, v20, v189, v52
    v_sub_f32 v21, v21, v53
    v_fma_f32 v21, v21, v189, v53
    v_sub_f32 v22, v22, v54
    v_fma_f32 v22, v22, v189, v54
    v_sub_f32 v23, v23, v55
    v_fma_f32 v23, v23, v189, v55
    v_cvt_pk_bf16_f32 v152, v16, v17
    v_cvt_pk_bf16_f32 v153, v18, v19
    v_cvt_pk_bf16_f32 v154, v20, v21
    v_cvt_pk_bf16_f32 v155, v22, v23
    s_nop 1
    v_permlane32_swap_b32 v152, v154
    v_permlane32_swap_b32 v153, v155
    buffer_store_dwordx4 v[152:155], v187, s[16:19], s53 offen offset:0
    v_sub_f32 v24, v24, v56
    v_fma_f32 v24, v24, v189, v56
    v_sub_f32 v25, v25, v57
    v_fma_f32 v25, v25, v189, v57
    v_sub_f32 v26, v26, v58
    v_fma_f32 v26, v26, v189, v58
    v_sub_f32 v27, v27, v59
    v_fma_f32 v27, v27, v189, v59
    v_sub_f32 v28, v28, v60
    v_fma_f32 v28, v28, v189, v60
    v_sub_f32 v29, v29, v61
    v_fma_f32 v29, v29, v189, v61
    v_sub_f32 v30, v30, v62
    v_fma_f32 v30, v30, v189, v62
    v_sub_f32 v31, v31, v63
    v_fma_f32 v31, v31, v189, v63
    v_cvt_pk_bf16_f32 v156, v24, v25
    v_cvt_pk_bf16_f32 v157, v26, v27
    v_cvt_pk_bf16_f32 v158, v28, v29
    v_cvt_pk_bf16_f32 v159, v30, v31
    s_nop 1
    v_permlane32_swap_b32 v156, v158
    v_permlane32_swap_b32 v157, v159
    buffer_store_dwordx4 v[156:159], v187, s[16:19], s53 offen offset:32
    s_branch gm_l2_kernel_fin
gm_l2_kernel_fft:
    s_load_dwordx2 s[66:67], s[0:1], 80
    v_and_b32 v192, 63, v0
    v_readfirstlane_b32 s3, v0
    v_lshlrev_b32 v173, 4, v192
    v_mov_b32 v199, v0
    s_and_b32 s5, s2, 7
    s_lshl_b32 s5, s5, 3
    s_lshr_b32 s32, s2, 3
    s_add_u32 s5, s5, s32
    s_sub_u32 s5, s5, 24
    s_xor_b32 s5, s5, 0
    s_lshr_b32 s3, s3, 6
    s_mov_b32 s4, s5
    s_mov_b32 s6, 0
    s_lshl_b32 s33, s3, 10
    s_lshl_b32 s40, s5, 12
    s_add_u32 s40, s40, s33
    s_add_u32 s40, s40, 19660800
    s_lshl_b32 s41, s5, 13
    s_lshl_b32 s34, s3, 11
    s_add_u32 s41, s41, s34
    s_add_u32 s41, s41, 22282240
    s_lshl_b32 s42, s5, 6
    s_add_u32 s42, s42, 25493504
    s_mov_b32 s43, s5
    s_mul_i32 s35, s3, 12288
    s_add_u32 s35, s35, 24707072
    v_and_b32 v144, 15, v192
    v_lshlrev_b32 v161, 2, v144
    v_lshrrev_b32 v144, 4, v192
    v_lshlrev_b32 v144, 10, v144
    v_add_u32 v161, v161, v144
    s_lshl_b32 s39, s3, 6
    v_add_u32 v161, s39, v161
    s_waitcnt lgkmcnt(0)
    s_mov_b32 s8, s66
    s_mov_b32 s9, s67
    s_mov_b32 s10, 268435456
    s_mov_b32 s11, 0x20000
    s_mov_b32 s16, s66
    s_mov_b32 s17, s67
    s_mov_b32 s18, 268435456
    s_mov_b32 s19, 0x20000
    v_lshlrev_b32 v174, 3, v192
    s_and_b32 s44, s2, 7
    s_lshl_b32 s44, s44, 9
    s_add_u32 s44, s44, 37781504
    s_cmp_eq_u32 s3, 0
    s_cbranch_scc0 gm_l2_kernel_fw_ok
    s_mov_b32 s52, 0
gm_l2_kernel_fw:
    buffer_load_dwordx2 v[176:177], v174, s[8:11], s44 offen sc1
    s_waitcnt vmcnt(0)
    s_mov_b64 s[54:55], 0
    s_mov_b32 s56, 0x88888888
    s_mov_b32 s57, 0x88888888
    v_cmp_eq_u32 vcc, 0, v176
    s_and_b64 vcc, vcc, s[56:57]
    s_or_b64 s[54:55], s[54:55], vcc
    s_mov_b32 s56, 0xcccccccc
    s_mov_b32 s57, 0xcccccccc
    v_cmp_eq_u32 vcc, 0, v177
    s_and_b64 vcc, vcc, s[56:57]
    s_or_b64 s[54:55], s[54:55], vcc
    s_add_u32 s52, s52, 1
    s_cmp_eq_u64 s[54:55], 0
    s_cbranch_scc1 gm_l2_kernel_fw_ok
    s_cmp_ge_u32 s52, 0x40000
    s_cbranch_scc1 gm_l2_kernel_fw_ok
    s_sleep 4
    s_branch gm_l2_kernel_fw
gm_l2_kernel_fw_ok:
    s_barrier
    buffer_load_dwordx4 v[64:67], v173, s[8:11], s35 offen offset:0
    buffer_load_dwordx4 v[68:71], v173, s[8:11], s35 offen offset:1024
    buffer_load_dwordx4 v[72:75], v173, s[8:11], s35 offen offset:2048
    buffer_load_dwordx4 v[76:79], v173, s[8:11], s35 offen offset:3072
    s_add_u32 s35, s35, 4096
    buffer_load_dwordx4 v[88:91], v173, s[8:11], s35 offen offset:0
    buffer_load_dwordx4 v[92:95], v173, s[8:11], s35 offen offset:1024
    buffer_load_dwordx4 v[96:99], v173, s[8:11], s35 offen offset:2048
    buffer_load_dwordx4 v[100:103], v173, s[8:11], s35 offen offset:3072
    s_add_u32 s35, s35, 4096
    buffer_load_dwordx4 v[112:115], v173, s[8:11], s35 offen offset:0
    buffer_load_dwordx4 v[116:119], v173, s[8:11], s35 offen offset:1024
    buffer_load_dwordx4 v[120:123], v173, s[8:11], s35 offen offset:2048
    buffer_load_dwordx4 v[124:127], v173, s[8:11], s35 offen offset:3072
    v_lshrrev_b32 v144, 4, v192
    v_lshlrev_b32 v144, 3, v144
    v_bfe_u32 v145, v192, 2, 2
    v_add_u32 v144, v144, v145
    v_lshlrev_b32 v144, 6, v144
    v_and_b32 v145, 3, v192
    v_lshlrev_b32 v145, 3, v145
    v_add_u32 v160, v144, v145
    v_and_b32 v144, 15, v192
    v_mul_u32_u24 v144, 144, v144
    v_lshrrev_b32 v145, 4, v192
    v_lshlrev_b32 v145, 3, v145
    v_add_u32 v144, v144, v145
    s_lshl_b32 s39, s3, 5
    v_add_u32 v162, s39, v144
    v_bfe_u32 v146, v192, 2, 2
    v_lshlrev_b32 v146, 3, v146
    v_and_b32 v147, 3, v192
    v_add_u32 v146, v146, v147
    v_mul_u32_u24 v146, 144, v146
    v_lshrrev_b32 v147, 4, v192
    v_lshlrev_b32 v147, 4, v147
    v_add_u32 v163, v146, v147
    v_and_b32 v144, 15, v192
    s_lshl_b32 s39, s3, 4
    v_add_u32 v144, s39, v144
    v_mul_u32_u24 v145, 36864, v144
    v_lshrrev_b32 v144, 4, v192
    v_lshlrev_b32 v144, 4, v144
    v_add_u32 v172, v145, v144
    s_waitcnt vmcnt(0)
    v_cvt_f32_f16 v164, v112
    v_cvt_f32_f16 v165, v113
    v_cvt_f32_f16 v166, v114
    v_cvt_f32_f16 v167, v115
    v_cvt_f32_f16 v168, v116
    v_cvt_f32_f16 v169, v117
    v_cvt_f32_f16 v170, v118
    v_cvt_f32_f16 v171, v119
    v_cvt_f32_f16_sdwa v240, v112 dst_sel:DWORD dst_unused:UNUSED_PAD src0_sel:WORD_1
    v_cvt_f32_f16_sdwa v241, v113 dst_sel:DWORD dst_unused:UNUSED_PAD src0_sel:WORD_1
    v_cvt_f32_f16_sdwa v242, v114 dst_sel:DWORD dst_unused:UNUSED_PAD src0_sel:WORD_1
    v_cvt_f32_f16_sdwa v243, v115 dst_sel:DWORD dst_unused:UNUSED_PAD src0_sel:WORD_1
    v_cvt_f32_f16_sdwa v244, v116 dst_sel:DWORD dst_unused:UNUSED_PAD src0_sel:WORD_1
    v_cvt_f32_f16_sdwa v245, v117 dst_sel:DWORD dst_unused:UNUSED_PAD src0_sel:WORD_1
    v_cvt_f32_f16_sdwa v246, v118 dst_sel:DWORD dst_unused:UNUSED_PAD src0_sel:WORD_1
    v_cvt_f32_f16_sdwa v247, v119 dst_sel:DWORD dst_unused:UNUSED_PAD src0_sel:WORD_1
    v_cvt_f32_f16_sdwa v112, v120 dst_sel:DWORD dst_unused:UNUSED_PAD src0_sel:WORD_1
    v_cvt_f32_f16_sdwa v113, v121 dst_sel:DWORD dst_unused:UNUSED_PAD src0_sel:WORD_1
    v_cvt_f32_f16_sdwa v114, v122 dst_sel:DWORD dst_unused:UNUSED_PAD src0_sel:WORD_1
    v_cvt_f32_f16_sdwa v115, v123 dst_sel:DWORD dst_unused:UNUSED_PAD src0_sel:WORD_1
    v_cvt_f32_f16_sdwa v116, v124 dst_sel:DWORD dst_unused:UNUSED_PAD src0_sel:WORD_1
    v_cvt_f32_f16_sdwa v117, v125 dst_sel:DWORD dst_unused:UNUSED_PAD src0_sel:WORD_1
    v_cvt_f32_f16_sdwa v118, v126 dst_sel:DWORD dst_unused:UNUSED_PAD src0_sel:WORD_1
    v_cvt_f32_f16_sdwa v119, v127 dst_sel:DWORD dst_unused:UNUSED_PAD src0_sel:WORD_1
    v_cvt_f32_f16 v120, v120
    v_cvt_f32_f16 v121, v121
    v_cvt_f32_f16 v122, v122
    v_cvt_f32_f16 v123, v123
    v_cvt_f32_f16 v124, v124
    v_cvt_f32_f16 v125, v125
    v_cvt_f32_f16 v126, v126
    v_cvt_f32_f16 v127, v127
    s_mov_b32 s39, 0x80008000
    v_xor_b32 v80, s39, v72
    v_xor_b32 v81, s39, v73
    v_xor_b32 v82, s39, v74
    v_xor_b32 v83, s39, v75
    v_xor_b32 v84, s39, v76
    v_xor_b32 v85, s39, v77
    v_xor_b32 v86, s39, v78
    v_xor_b32 v87, s39, v79
    v_xor_b32 v104, s39, v96
    v_xor_b32 v105, s39, v97
    v_xor_b32 v106, s39, v98
    v_xor_b32 v107, s39, v99
    v_xor_b32 v108, s39, v100
    v_xor_b32 v109, s39, v101
    v_xor_b32 v110, s39, v102
    v_xor_b32 v111, s39, v103
    s_cmp_eq_u32 s3, 0
    s_cbranch_scc0 gm_l2_kernel_fz_ok
    s_mov_b32 s52, 0
gm_l2_kernel_fz:
    buffer_load_dwordx2 v[176:177], v174, s[8:11], s44 offen sc1
    s_waitcnt vmcnt(0)
    s_mov_b64 s[54:55], 0
    s_mov_b32 s56, 0x77777777
    s_mov_b32 s57, 0x77777777
    v_cmp_eq_u32 vcc, 0, v176
    s_and_b64 vcc, vcc, s[56:57]
    s_or_b64 s[54:55], s[54:55], vcc
    s_mov_b32 s56, 0x33333333
    s_mov_b32 s57, 0x33333333
    v_cmp_eq_u32 vcc, 0, v177
    s_and_b64 vcc, vcc, s[56:57]
    s_or_b64 s[54:55], s[54:55], vcc
    s_add_u32 s52, s52, 1
    s_cmp_eq_u64 s[54:55], 0
    s_cbranch_scc1 gm_l2_kernel_fz_ok
    s_cmp_ge_u32 s52, 0x40000
    s_cbranch_scc1 gm_l2_kernel_fz_ok
    s_sleep 4
    s_branch gm_l2_kernel_fz
gm_l2_kernel_fz_ok:
    s_barrier
    s_cmp_eq_u32 s43, 0
    s_cselect_b32 s38, 1, 0
    s_cmp_eq_u32 s43, 288
    s_cselect_b32 s38, 1, s38
    s_cmp_eq_u32 s38, 1
    s_cselect_b32 s18, 0, 268435456
    s_add_u32 s39, s6, s33
    s_lshl_b32 s37, s33, 1
    s_add_u32 s37, s37, s6
    s_add_u32 m0, s39, 0
    s_add_u32 s32, s40, 0
    buffer_load_dwordx4 v173, s[8:11], s32 offen lds
    s_add_u32 m0, s39, 4096
    s_add_u32 s32, s40, 1179648
    buffer_load_dwordx4 v173, s[16:19], s32 offen lds
    s_add_u32 m0, s37, 53248
    s_add_u32 s32, s41, 0
    buffer_load_dwordx4 v173, s[8:11], s32 offen lds
    buffer_load_dwordx4 v173, s[8:11], s32 offen offset:1024 lds
    s_add_u32 m0, s39, 16384
    s_add_u32 s32, s40, 262144
    buffer_load_dwordx4 v173, s[8:11], s32 offen lds
    s_add_u32 m0, s39, 20480
    s_add_u32 s32, s40, 1441792
    buffer_load_dwordx4 v173, s[8:11], s32 offen lds
    s_add_u32 m0, s37, 69632
    s_add_u32 s32, s41, 524288
    buffer_load_dwordx4 v173, s[8:11], s32 offen lds
    buffer_load_dwordx4 v173, s[8:11], s32 offen offset:1024 lds
    s_add_u32 s40, s40, 524288
    s_add_u32 s41, s41, 1048576
    s_add_u32 s43, s43, 128
    s_waitcnt vmcnt(0)
gm_l2_kernel_col:
    s_waitcnt vmcnt(4)
    s_barrier
    v_add_u32 v144, s6, v160
    ds_read_b64_tr_b16 v[0:1], v144 offset:0
    ds_read_b64_tr_b16 v[2:3], v144 offset:256
    ds_read_b64_tr_b16 v[4:5], v144 offset:2048
    ds_read_b64_tr_b16 v[6:7], v144 offset:2304
    ds_read_b64_tr_b16 v[8:9], v144 offset:32
    ds_read_b64_tr_b16 v[10:11], v144 offset:288
    ds_read_b64_tr_b16 v[12:13], v144 offset:2080
    ds_read_b64_tr_b16 v[14:15], v144 offset:2336
    ds_read_b64_tr_b16 v[16:17], v144 offset:4096
    ds_read_b64_tr_b16 v[18:19], v144 offset:4352
    ds_read_b64_tr_b16 v[20:21], v144 offset:6144
    ds_read_b64_tr_b16 v[22:23], v144 offset:6400
    ds_read_b64_tr_b16 v[24:25], v144 offset:4128
    ds_read_b64_tr_b16 v[26:27], v144 offset:4384
    ds_read_b64_tr_b16 v[28:29], v144 offset:6176
    ds_read_b64_tr_b16 v[30:31], v144 offset:6432
    v_add_u32 v174, s6, v160
    ds_read_b64_tr_b16 v[200:201], v174 offset:16384
    ds_read_b64_tr_b16 v[202:203], v174 offset:16640
    ds_read_b64_tr_b16 v[204:205], v174 offset:18432
    ds_read_b64_tr_b16 v[206:207], v174 offset:18688
    ds_read_b64_tr_b16 v[208:209], v174 offset:16416
    ds_read_b64_tr_b16 v[210:211], v174 offset:16672
    ds_read_b64_tr_b16 v[212:213], v174 offset:18464
    ds_read_b64_tr_b16 v[214:215], v174 offset:18720
    s_mov_b32 s46, s42
    s_add_u32 s47, s42, 18432
    s_add_u32 s50, s42, 4096
    s_add_u32 s51, s42, 22528
    s_cmp_eq_u32 s4, 0
    s_cselect_b32 s48, 1, 0
    s_cmp_eq_u32 s4, 288
    s_cselect_b32 s48, 1, s48
    s_add_u32 s42, s42, 8192
    s_waitcnt lgkmcnt(8)
    v_mfma_f32_16x16x32_bf16 v[32:35], v[0:3], v[64:67], 0
    ds_read_b64_tr_b16 v[216:217], v174 offset:20480
    v_mfma_f32_16x16x32_bf16 v[36:39], v[16:19], v[64:67], 0
    ds_read_b64_tr_b16 v[218:219], v174 offset:20736
    ds_read_b64_tr_b16 v[220:221], v174 offset:22528
    v_mfma_f32_16x16x32_bf16 v[40:43], v[8:11], v[64:67], 0
    ds_read_b64_tr_b16 v[222:223], v174 offset:22784
    ds_read_b64_tr_b16 v[224:225], v174 offset:20512
    v_mfma_f32_16x16x32_bf16 v[44:47], v[24:27], v[64:67], 0
    ds_read_b64_tr_b16 v[226:227], v174 offset:20768
    ds_read_b64_tr_b16 v[228:229], v174 offset:22560
    v_mfma_f32_16x16x32_bf16 v[32:35], v[16:19], v[72:75], v[32:35]
    ds_read_b64_tr_b16 v[230:231], v174 offset:22816
    v_mfma_f32_16x16x32_bf16 v[36:39], v[0:3], v[80:83], v[36:39]
    v_add_u32 v145, s6, v161
    v_add_u32 v145, 53248, v145
    v_mfma_f32_16x16x32_bf16 v[40:43], v[24:27], v[72:75], v[40:43]
    ds_read_b32 v128, v145 offset:0
    ds_read_b32 v129, v145 offset:256
    v_mfma_f32_16x16x32_bf16 v[44:47], v[8:11], v[80:83], v[44:47]
    ds_read_b32 v130, v145 offset:512
    ds_read_b32 v131, v145 offset:768
    v_mfma_f32_16x16x32_bf16 v[32:35], v[4:7], v[68:71], v[32:35]
    ds_read_b32 v132, v145 offset:4096
    v_mfma_f32_16x16x32_bf16 v[36:39], v[20:23], v[68:71], v[36:39]
    ds_read_b32 v133, v145 offset:4352
    ds_read_b32 v134, v145 offset:4608
    v_mfma_f32_16x16x32_bf16 v[40:43], v[12:15], v[68:71], v[40:43]
    ds_read_b32 v135, v145 offset:4864
    v_add_u32 v175, s6, v161
    v_mfma_f32_16x16x32_bf16 v[44:47], v[28:31], v[68:71], v[44:47]
    v_add_u32 v175, 69632, v175
    ds_read_b32 v232, v175 offset:0
    v_mfma_f32_16x16x32_bf16 v[32:35], v[20:23], v[76:79], v[32:35]
    ds_read_b32 v233, v175 offset:256
    v_mfma_f32_16x16x32_bf16 v[36:39], v[4:7], v[84:87], v[36:39]
    ds_read_b32 v234, v175 offset:512
    ds_read_b32 v235, v175 offset:768
    v_mfma_f32_16x16x32_bf16 v[40:43], v[28:31], v[76:79], v[40:43]
    ds_read_b32 v236, v175 offset:4096
    ds_read_b32 v237, v175 offset:4352
    v_mfma_f32_16x16x32_bf16 v[44:47], v[12:15], v[84:87], v[44:47]
    ds_read_b32 v238, v175 offset:4608
    ds_read_b32 v239, v175 offset:4864
    s_add_u32 s4, s4, 128
    s_xor_b32 s6, s6, 8192
    s_waitcnt lgkmcnt(0)
    v_mfma_f32_16x16x32_bf16 v[48:51], v[200:203], v[64:67], 0
    s_nop 7
    v_mul_f32 v148, v32, v164
    v_mfma_f32_16x16x32_bf16 v[52:55], v[216:219], v[64:67], 0
    v_mul_f32 v152, v36, v164
    v_mul_f32 v149, v33, v165
    v_mul_f32 v153, v37, v165
    v_mfma_f32_16x16x32_bf16 v[56:59], v[208:211], v[64:67], 0
    v_mul_f32 v150, v34, v166
    v_mul_f32 v154, v38, v166
    v_mfma_f32_16x16x32_bf16 v[60:63], v[224:227], v[64:67], 0
    v_mul_f32 v151, v35, v167
    v_mul_f32 v155, v39, v167
    v_fma_f32 v148, v36, v240, v148
    v_mfma_f32_16x16x32_bf16 v[48:51], v[216:219], v[72:75], v[48:51]
    v_fma_f32 v152, -v32, v240, v152
    v_fma_f32 v149, v37, v241, v149
    v_mfma_f32_16x16x32_bf16 v[52:55], v[200:203], v[80:83], v[52:55]
    v_fma_f32 v153, -v33, v241, v153
    v_fma_f32 v150, v38, v242, v150
    v_fma_f32 v154, -v34, v242, v154
    v_mfma_f32_16x16x32_bf16 v[56:59], v[224:227], v[72:75], v[56:59]
    v_fma_f32 v151, v39, v243, v151
    v_fma_f32 v155, -v35, v243, v155
    v_mfma_f32_16x16x32_bf16 v[60:63], v[208:211], v[80:83], v[60:63]
    v_cvt_pk_bf16_f32 v136, v148, v149
    v_cvt_pk_bf16_f32 v140, v152, v153
    v_cvt_pk_bf16_f32 v137, v150, v151
    v_mfma_f32_16x16x32_bf16 v[48:51], v[204:207], v[68:71], v[48:51]
    v_cvt_pk_bf16_f32 v141, v154, v155
    v_mul_f32 v148, v40, v168
    v_mul_f32 v152, v44, v168
    v_mfma_f32_16x16x32_bf16 v[52:55], v[220:223], v[68:71], v[52:55]
    v_mul_f32 v149, v41, v169
    v_mul_f32 v153, v45, v169
    v_mfma_f32_16x16x32_bf16 v[56:59], v[212:215], v[68:71], v[56:59]
    v_mul_f32 v150, v42, v170
    v_mul_f32 v154, v46, v170
    v_mul_f32 v151, v43, v171
    v_mfma_f32_16x16x32_bf16 v[60:63], v[228:231], v[68:71], v[60:63]
    v_mul_f32 v155, v47, v171
    v_fma_f32 v148, v44, v244, v148
    v_mfma_f32_16x16x32_bf16 v[48:51], v[220:223], v[76:79], v[48:51]
    v_fma_f32 v152, -v40, v244, v152
    v_fma_f32 v149, v45, v245, v149
    v_fma_f32 v153, -v41, v245, v153
    v_mfma_f32_16x16x32_bf16 v[52:55], v[204:207], v[84:87], v[52:55]
    v_fma_f32 v150, v46, v246, v150
    v_fma_f32 v154, -v42, v246, v154
    v_mfma_f32_16x16x32_bf16 v[56:59], v[228:231], v[76:79], v[56:59]
    v_fma_f32 v151, v47, v247, v151
    v_fma_f32 v155, -v43, v247, v155
    v_cvt_pk_bf16_f32 v138, v148, v149
    v_mfma_f32_16x16x32_bf16 v[60:63], v[212:215], v[84:87], v[60:63]
    v_cvt_pk_bf16_f32 v142, v152, v153
    v_cvt_pk_bf16_f32 v139, v150, v151
    v_cvt_pk_bf16_f32 v143, v154, v155
    s_nop 1
    v_mfma_f32_16x16x32_bf16 v[32:35], v[88:91], v[136:139], 0
    s_nop 7
    v_mul_f32 v178, v48, v164
    v_mul_f32 v182, v52, v164
    v_mul_f32 v179, v49, v165
    v_mul_f32 v183, v53, v165
    v_mfma_f32_16x16x32_bf16 v[36:39], v[88:91], v[140:143], 0
    v_mul_f32 v180, v50, v166
    v_mul_f32 v184, v54, v166
    v_mul_f32 v181, v51, v167
    v_mul_f32 v185, v55, v167
    v_fma_f32 v178, v52, v240, v178
    v_mfma_f32_16x16x32_bf16 v[40:43], v[92:95], v[136:139], 0
    v_fma_f32 v182, -v48, v240, v182
    v_fma_f32 v179, v53, v241, v179
    v_fma_f32 v183, -v49, v241, v183
    v_fma_f32 v180, v54, v242, v180
    v_fma_f32 v184, -v50, v242, v184
    v_mfma_f32_16x16x32_bf16 v[44:47], v[92:95], v[140:143], 0
    v_fma_f32 v181, v55, v243, v181
    v_fma_f32 v185, -v51, v243, v185
    v_cvt_pk_bf16_f32 v248, v178, v179
    v_cvt_pk_bf16_f32 v252, v182, v183
    v_cvt_pk_bf16_f32 v249, v180, v181
    v_mfma_f32_16x16x32_bf16 v[32:35], v[96:99], v[140:143], v[32:35]
    v_cvt_pk_bf16_f32 v253, v184, v185
    v_mul_f32 v178, v56, v168
    v_mul_f32 v182, v60, v168
    v_mul_f32 v179, v57, v169
    v_mul_f32 v183, v61, v169
    v_mfma_f32_16x16x32_bf16 v[36:39], v[104:107], v[136:139], v[36:39]
    v_mul_f32 v180, v58, v170
    v_mul_f32 v184, v62, v170
    v_mul_f32 v181, v59, v171
    v_mul_f32 v185, v63, v171
    v_fma_f32 v178, v60, v244, v178
    v_mfma_f32_16x16x32_bf16 v[40:43], v[100:103], v[140:143], v[40:43]
    v_fma_f32 v182, -v56, v244, v182
    v_fma_f32 v179, v61, v245, v179
    v_fma_f32 v183, -v57, v245, v183
    v_fma_f32 v180, v62, v246, v180
    v_fma_f32 v184, -v58, v246, v184
    v_mfma_f32_16x16x32_bf16 v[44:47], v[108:111], v[136:139], v[44:47]
    v_fma_f32 v181, v63, v247, v181
    v_fma_f32 v185, -v59, v247, v185
    v_cvt_pk_bf16_f32 v250, v178, v179
    v_cvt_pk_bf16_f32 v254, v182, v183
    v_cvt_pk_bf16_f32 v251, v180, v181
    v_cvt_pk_bf16_f32 v255, v184, v185
    s_nop 1
    v_mfma_f32_16x16x32_bf16 v[48:51], v[88:91], v[248:251], 0
    s_nop 7
    v_lshlrev_b32 v144, 16, v128
    v_and_b32 v145, 0xffff0000, v128
    v_mul_f32 v148, v32, v144
    v_mul_f32 v152, v36, v144
    v_fma_f32 v148, -v36, v145, v148
    v_fmac_f32 v152, v32, v145
    v_mfma_f32_16x16x32_bf16 v[52:55], v[88:91], v[252:255], 0
    v_lshlrev_b32 v146, 16, v129
    v_and_b32 v147, 0xffff0000, v129
    v_mul_f32 v149, v33, v146
    v_mul_f32 v153, v37, v146
    v_fma_f32 v149, -v37, v147, v149
    v_fmac_f32 v153, v33, v147
    v_lshlrev_b32 v144, 16, v130
    v_mfma_f32_16x16x32_bf16 v[56:59], v[92:95], v[248:251], 0
    v_and_b32 v145, 0xffff0000, v130
    v_mul_f32 v150, v34, v144
    v_mul_f32 v154, v38, v144
    v_fma_f32 v150, -v38, v145, v150
    v_fmac_f32 v154, v34, v145
    v_lshlrev_b32 v146, 16, v131
    v_and_b32 v147, 0xffff0000, v131
    v_mfma_f32_16x16x32_bf16 v[60:63], v[92:95], v[252:255], 0
    v_mul_f32 v151, v35, v146
    v_mul_f32 v155, v39, v146
    v_fma_f32 v151, -v39, v147, v151
    v_fmac_f32 v155, v35, v147
    v_cvt_pk_bf16_f32 v136, v148, v149
    v_cvt_pk_bf16_f32 v140, v152, v153
    v_cvt_pk_bf16_f32 v137, v150, v151
    v_mfma_f32_16x16x32_bf16 v[48:51], v[96:99], v[252:255], v[48:51]
    v_cvt_pk_bf16_f32 v141, v154, v155
    v_lshlrev_b32 v144, 16, v132
    v_and_b32 v145, 0xffff0000, v132
    v_mul_f32 v148, v40, v144
    v_mul_f32 v152, v44, v144
    v_fma_f32 v148, -v44, v145, v148
    v_fmac_f32 v152, v40, v145
    v_mfma_f32_16x16x32_bf16 v[52:55], v[104:107], v[248:251], v[52:55]
    v_lshlrev_b32 v146, 16, v133
    v_and_b32 v147, 0xffff0000, v133
    v_mul_f32 v149, v41, v146
    v_mul_f32 v153, v45, v146
    v_fma_f32 v149, -v45, v147, v149
    v_fmac_f32 v153, v41, v147
    v_lshlrev_b32 v144, 16, v134
    v_mfma_f32_16x16x32_bf16 v[56:59], v[100:103], v[252:255], v[56:59]
    v_and_b32 v145, 0xffff0000, v134
    v_mul_f32 v150, v42, v144
    v_mul_f32 v154, v46, v144
    v_fma_f32 v150, -v46, v145, v150
    v_fmac_f32 v154, v42, v145
    v_lshlrev_b32 v146, 16, v135
    v_and_b32 v147, 0xffff0000, v135
    v_mfma_f32_16x16x32_bf16 v[60:63], v[108:111], v[248:251], v[60:63]
    v_mul_f32 v151, v43, v146
    v_mul_f32 v155, v47, v146
    v_fma_f32 v151, -v47, v147, v151
    v_fmac_f32 v155, v43, v147
    v_cvt_pk_bf16_f32 v138, v148, v149
    v_cvt_pk_bf16_f32 v142, v152, v153
    v_cvt_pk_bf16_f32 v139, v150, v151
    v_cvt_pk_bf16_f32 v143, v154, v155
    s_nop 1
    v_mfma_f32_16x16x32_bf16 v[32:35], v[136:139], v[88:91], 0
    s_nop 7
    v_lshlrev_b32 v174, 16, v232
    v_and_b32 v175, 0xffff0000, v232
    v_mul_f32 v178, v48, v174
    v_mul_f32 v182, v52, v174
    v_fma_f32 v178, -v52, v175, v178
    v_fmac_f32 v182, v48, v175
    v_mfma_f32_16x16x32_bf16 v[36:39], v[140:143], v[88:91], 0
    v_lshlrev_b32 v176, 16, v233
    v_and_b32 v177, 0xffff0000, v233
    v_mul_f32 v179, v49, v176
    v_mul_f32 v183, v53, v176
    v_fma_f32 v179, -v53, v177, v179
    v_fmac_f32 v183, v49, v177
    v_lshlrev_b32 v174, 16, v234
    v_mfma_f32_16x16x32_bf16 v[40:43], v[136:139], v[92:95], 0
    v_and_b32 v175, 0xffff0000, v234
    v_mul_f32 v180, v50, v174
    v_mul_f32 v184, v54, v174
    v_fma_f32 v180, -v54, v175, v180
    v_fmac_f32 v184, v50, v175
    v_lshlrev_b32 v176, 16, v235
    v_and_b32 v177, 0xffff0000, v235
    v_mfma_f32_16x16x32_bf16 v[44:47], v[140:143], v[92:95], 0
    v_mul_f32 v181, v51, v176
    v_mul_f32 v185, v55, v176
    v_fma_f32 v181, -v55, v177, v181
    v_fmac_f32 v185, v51, v177
    v_cvt_pk_bf16_f32 v248, v178, v179
    v_cvt_pk_bf16_f32 v252, v182, v183
    v_cvt_pk_bf16_f32 v249, v180, v181
    v_mfma_f32_16x16x32_bf16 v[32:35], v[140:143], v[104:107], v[32:35]
    v_cvt_pk_bf16_f32 v253, v184, v185
    v_lshlrev_b32 v174, 16, v236
    v_and_b32 v175, 0xffff0000, v236
    v_mul_f32 v178, v56, v174
    v_mul_f32 v182, v60, v174
    v_fma_f32 v178, -v60, v175, v178
    v_fmac_f32 v182, v56, v175
    v_mfma_f32_16x16x32_bf16 v[36:39], v[136:139], v[96:99], v[36:39]
    v_lshlrev_b32 v176, 16, v237
    v_and_b32 v177, 0xffff0000, v237
    v_mul_f32 v179, v57, v176
    v_mul_f32 v183, v61, v176
    v_fma_f32 v179, -v61, v177, v179
    v_fmac_f32 v183, v57, v177
    v_lshlrev_b32 v174, 16, v238
    v_mfma_f32_16x16x32_bf16 v[40:43], v[140:143], v[108:111], v[40:43]
    v_and_b32 v175, 0xffff0000, v238
    v_mul_f32 v180, v58, v174
    v_mul_f32 v184, v62, v174
    v_fma_f32 v180, -v62, v175, v180
    v_fmac_f32 v184, v58, v175
    v_lshlrev_b32 v176, 16, v239
    v_and_b32 v177, 0xffff0000, v239
    v_mfma_f32_16x16x32_bf16 v[44:47], v[136:139], v[100:103], v[44:47]
    v_mul_f32 v181, v59, v176
    v_mul_f32 v185, v63, v176
    v_fma_f32 v181, -v63, v177, v181
    v_fmac_f32 v185, v59, v177
    v_cvt_pk_bf16_f32 v250, v178, v179
    v_cvt_pk_bf16_f32 v254, v182, v183
    v_cvt_pk_bf16_f32 v251, v180, v181
    v_cvt_pk_bf16_f32 v255, v184, v185
    s_nop 1
    v_mfma_f32_16x16x32_bf16 v[48:51], v[248:251], v[88:91], 0
    s_nop 7
    v_mul_f32 v148, v32, v120
    v_mul_f32 v152, v36, v120
    v_mul_f32 v149, v33, v121
    v_mul_f32 v153, v37, v121
    v_mfma_f32_16x16x32_bf16 v[52:55], v[252:255], v[88:91], 0
    v_mul_f32 v150, v34, v122
    v_mul_f32 v154, v38, v122
    v_mul_f32 v151, v35, v123
    v_mul_f32 v155, v39, v123
    v_fma_f32 v148, -v36, v112, v148
    v_mfma_f32_16x16x32_bf16 v[56:59], v[248:251], v[92:95], 0
    v_fma_f32 v152, v32, v112, v152
    v_fma_f32 v149, -v37, v113, v149
    v_fma_f32 v153, v33, v113, v153
    v_fma_f32 v150, -v38, v114, v150
    v_fma_f32 v154, v34, v114, v154
    v_mfma_f32_16x16x32_bf16 v[60:63], v[252:255], v[92:95], 0
    v_fma_f32 v151, -v39, v115, v151
    v_fma_f32 v155, v35, v115, v155
    v_cvt_pk_bf16_f32 v136, v148, v149
    v_cvt_pk_bf16_f32 v140, v152, v153
    v_cvt_pk_bf16_f32 v137, v150, v151
    v_mfma_f32_16x16x32_bf16 v[48:51], v[252:255], v[104:107], v[48:51]
    v_cvt_pk_bf16_f32 v141, v154, v155
    v_mul_f32 v148, v40, v124
    v_mul_f32 v152, v44, v124
    v_mul_f32 v149, v41, v125
    v_mul_f32 v153, v45, v125
    v_mfma_f32_16x16x32_bf16 v[52:55], v[248:251], v[96:99], v[52:55]
    v_mul_f32 v150, v42, v126
    v_mul_f32 v154, v46, v126
    v_mul_f32 v151, v43, v127
    v_mul_f32 v155, v47, v127
    v_fma_f32 v148, -v44, v116, v148
    v_mfma_f32_16x16x32_bf16 v[56:59], v[252:255], v[108:111], v[56:59]
    v_fma_f32 v152, v40, v116, v152
    v_fma_f32 v149, -v45, v117, v149
    v_fma_f32 v153, v41, v117, v153
    v_fma_f32 v150, -v46, v118, v150
    v_fma_f32 v154, v42, v118, v154
    v_mfma_f32_16x16x32_bf16 v[60:63], v[248:251], v[100:103], v[60:63]
    v_fma_f32 v151, -v47, v119, v151
    v_fma_f32 v155, v43, v119, v155
    v_cvt_pk_bf16_f32 v138, v148, v149
    v_cvt_pk_bf16_f32 v142, v152, v153
    v_cvt_pk_bf16_f32 v139, v150, v151
    v_cvt_pk_bf16_f32 v143, v154, v155
    ds_write_b64 v162, v[136:137] offset:32768
    ds_write_b64 v162, v[140:141] offset:37376
    ds_write_b64 v162, v[138:139] offset:35072
    ds_write_b64 v162, v[142:143] offset:39680
    s_cmp_eq_u32 s43, 0
    s_cselect_b32 s38, 1, 0
    s_cmp_eq_u32 s43, 288
    s_cselect_b32 s38, 1, s38
    s_cmp_eq_u32 s38, 1
    s_cselect_b32 s18, 0, 268435456
    s_add_u32 s39, s6, s33
    s_lshl_b32 s37, s33, 1
    s_add_u32 s37, s37, s6
    s_add_u32 m0, s39, 0
    s_add_u32 s32, s40, 0
    buffer_load_dwordx4 v173, s[8:11], s32 offen lds
    s_add_u32 m0, s39, 4096
    s_add_u32 s32, s40, 1179648
    buffer_load_dwordx4 v173, s[16:19], s32 offen lds
    s_add_u32 m0, s37, 53248
    s_add_u32 s32, s41, 0
    buffer_load_dwordx4 v173, s[8:11], s32 offen lds
    buffer_load_dwordx4 v173, s[8:11], s32 offen offset:1024 lds
    s_add_u32 m0, s39, 16384
    s_add_u32 s32, s40, 262144
    buffer_load_dwordx4 v173, s[8:11], s32 offen lds
    s_add_u32 m0, s39, 20480
    s_add_u32 s32, s40, 1441792
    buffer_load_dwordx4 v173, s[8:11], s32 offen lds
    s_add_u32 m0, s37, 69632
    s_add_u32 s32, s41, 524288
    buffer_load_dwordx4 v173, s[8:11], s32 offen lds
    buffer_load_dwordx4 v173, s[8:11], s32 offen offset:1024 lds
    s_add_u32 s40, s40, 524288
    s_add_u32 s41, s41, 1048576
    s_add_u32 s43, s43, 128
    s_waitcnt lgkmcnt(0)
    s_barrier
    ds_read_b128 v[0:3], v163 offset:32768
    ds_read_b128 v[4:7], v163 offset:32832
    ds_read_b128 v[8:11], v163 offset:33344
    ds_read_b128 v[12:15], v163 offset:33408
    ds_read_b128 v[16:19], v163 offset:37376
    ds_read_b128 v[20:23], v163 offset:37440
    ds_read_b128 v[24:27], v163 offset:37952
    ds_read_b128 v[28:31], v163 offset:38016
    s_waitcnt lgkmcnt(0)
    v_mfma_f32_16x16x32_bf16 v[32:35], v[0:3], v[64:67], 0
    s_nop 7
    v_mul_f32 v178, v48, v120
    v_mfma_f32_16x16x32_bf16 v[36:39], v[16:19], v[64:67], 0
    v_mul_f32 v182, v52, v120
    v_mul_f32 v179, v49, v121
    v_mul_f32 v183, v53, v121
    v_mfma_f32_16x16x32_bf16 v[40:43], v[8:11], v[64:67], 0
    v_mul_f32 v180, v50, v122
    v_mul_f32 v184, v54, v122
    v_mfma_f32_16x16x32_bf16 v[44:47], v[24:27], v[64:67], 0
    v_mul_f32 v181, v51, v123
    v_mul_f32 v185, v55, v123
    v_fma_f32 v178, -v52, v112, v178
    v_mfma_f32_16x16x32_bf16 v[32:35], v[16:19], v[80:83], v[32:35]
    v_fma_f32 v182, v48, v112, v182
    v_fma_f32 v179, -v53, v113, v179
    v_mfma_f32_16x16x32_bf16 v[36:39], v[0:3], v[72:75], v[36:39]
    v_fma_f32 v183, v49, v113, v183
    v_fma_f32 v180, -v54, v114, v180
    v_fma_f32 v184, v50, v114, v184
    v_mfma_f32_16x16x32_bf16 v[40:43], v[24:27], v[80:83], v[40:43]
    v_fma_f32 v181, -v55, v115, v181
    v_fma_f32 v185, v51, v115, v185
    v_mfma_f32_16x16x32_bf16 v[44:47], v[8:11], v[72:75], v[44:47]
    v_cvt_pk_bf16_f32 v248, v178, v179
    v_cvt_pk_bf16_f32 v252, v182, v183
    v_cvt_pk_bf16_f32 v249, v180, v181
    v_mfma_f32_16x16x32_bf16 v[32:35], v[4:7], v[68:71], v[32:35]
    v_cvt_pk_bf16_f32 v253, v184, v185
    v_mul_f32 v178, v56, v124
    v_mul_f32 v182, v60, v124
    v_mfma_f32_16x16x32_bf16 v[36:39], v[20:23], v[68:71], v[36:39]
    v_mul_f32 v179, v57, v125
    v_mul_f32 v183, v61, v125
    v_mfma_f32_16x16x32_bf16 v[40:43], v[12:15], v[68:71], v[40:43]
    v_mul_f32 v180, v58, v126
    v_mul_f32 v184, v62, v126
    v_mul_f32 v181, v59, v127
    v_mfma_f32_16x16x32_bf16 v[44:47], v[28:31], v[68:71], v[44:47]
    v_mul_f32 v185, v63, v127
    v_fma_f32 v178, -v60, v116, v178
    v_mfma_f32_16x16x32_bf16 v[32:35], v[20:23], v[84:87], v[32:35]
    v_fma_f32 v182, v56, v116, v182
    v_fma_f32 v179, -v61, v117, v179
    v_fma_f32 v183, v57, v117, v183
    v_mfma_f32_16x16x32_bf16 v[36:39], v[4:7], v[76:79], v[36:39]
    v_fma_f32 v180, -v62, v118, v180
    v_fma_f32 v184, v58, v118, v184
    v_mfma_f32_16x16x32_bf16 v[40:43], v[28:31], v[84:87], v[40:43]
    v_fma_f32 v181, -v63, v119, v181
    v_fma_f32 v185, v59, v119, v185
    v_cvt_pk_bf16_f32 v250, v178, v179
    v_mfma_f32_16x16x32_bf16 v[44:47], v[12:15], v[76:79], v[44:47]
    v_cvt_pk_bf16_f32 v254, v182, v183
    v_cvt_pk_bf16_f32 v251, v180, v181
    v_cvt_pk_bf16_f32 v255, v184, v185
    ds_write_b64 v162, v[248:249] offset:41984
    ds_write_b64 v162, v[252:253] offset:46592
    ds_write_b64 v162, v[250:251] offset:44288
    ds_write_b64 v162, v[254:255] offset:48896
    s_waitcnt lgkmcnt(0)
    s_barrier
    ds_read_b128 v[200:203], v163 offset:41984
    ds_read_b128 v[204:207], v163 offset:42048
    ds_read_b128 v[208:211], v163 offset:42560
    ds_read_b128 v[212:215], v163 offset:42624
    ds_read_b128 v[216:219], v163 offset:46592
    ds_read_b128 v[220:223], v163 offset:46656
    ds_read_b128 v[224:227], v163 offset:47168
    ds_read_b128 v[228:231], v163 offset:47232
    v_cvt_pk_bf16_f32 v136, v32, v33
    v_cvt_pk_bf16_f32 v140, v36, v37
    v_cvt_pk_bf16_f32 v137, v34, v35
    v_cvt_pk_bf16_f32 v141, v38, v39
    v_cvt_pk_bf16_f32 v138, v40, v41
    v_cvt_pk_bf16_f32 v142, v44, v45
    v_cvt_pk_bf16_f32 v139, v42, v43
    v_cvt_pk_bf16_f32 v143, v46, v47
    s_waitcnt lgkmcnt(0)
    v_mfma_f32_16x16x32_bf16 v[48:51], v[200:203], v[64:67], 0
    v_mfma_f32_16x16x32_bf16 v[52:55], v[216:219], v[64:67], 0
    v_mfma_f32_16x16x32_bf16 v[56:59], v[208:211], v[64:67], 0
    v_mfma_f32_16x16x32_bf16 v[60:63], v[224:227], v[64:67], 0
    s_cmp_eq_u32 s48, 1
    v_mfma_f32_16x16x32_bf16 v[48:51], v[216:219], v[80:83], v[48:51]
    v_mfma_f32_16x16x32_bf16 v[52:55], v[200:203], v[72:75], v[52:55]
    v_mfma_f32_16x16x32_bf16 v[56:59], v[224:227], v[80:83], v[56:59]
    v_mfma_f32_16x16x32_bf16 v[60:63], v[208:211], v[72:75], v[60:63]
    s_cselect_b32 s18, 0, 268435456
    v_mfma_f32_16x16x32_bf16 v[48:51], v[204:207], v[68:71], v[48:51]
    v_mfma_f32_16x16x32_bf16 v[52:55], v[220:223], v[68:71], v[52:55]
    v_mfma_f32_16x16x32_bf16 v[56:59], v[212:215], v[68:71], v[56:59]
    v_mfma_f32_16x16x32_bf16 v[60:63], v[228:231], v[68:71], v[60:63]
    buffer_store_dwordx4 v[136:139], v172, s[8:11], s46 offen sc1
    v_mfma_f32_16x16x32_bf16 v[48:51], v[220:223], v[84:87], v[48:51]
    v_mfma_f32_16x16x32_bf16 v[52:55], v[204:207], v[76:79], v[52:55]
    v_mfma_f32_16x16x32_bf16 v[56:59], v[228:231], v[84:87], v[56:59]
    v_mfma_f32_16x16x32_bf16 v[60:63], v[212:215], v[76:79], v[60:63]
    buffer_store_dwordx4 v[140:143], v172, s[16:19], s47 offen sc1
    s_nop 7
    v_cvt_pk_bf16_f32 v248, v48, v49
    v_cvt_pk_bf16_f32 v252, v52, v53
    v_cvt_pk_bf16_f32 v249, v50, v51
    v_cvt_pk_bf16_f32 v253, v54, v55
    v_cvt_pk_bf16_f32 v250, v56, v57
    v_cvt_pk_bf16_f32 v254, v60, v61
    v_cvt_pk_bf16_f32 v251, v58, v59
    v_cvt_pk_bf16_f32 v255, v62, v63
    buffer_store_dwordx4 v[248:251], v172, s[8:11], s50 offen sc1
    buffer_store_dwordx4 v[252:255], v172, s[8:11], s51 offen sc1
    s_cmp_lt_u32 s4, 192
    s_cbranch_scc1 gm_l2_kernel_col
    s_cmp_gt_u32 s4, 288
    s_cbranch_scc1 gm_l2_kernel_cole
    s_waitcnt vmcnt(4)
    s_barrier
    v_add_u32 v144, s6, v160
    ds_read_b64_tr_b16 v[0:1], v144 offset:0
    ds_read_b64_tr_b16 v[2:3], v144 offset:256
    ds_read_b64_tr_b16 v[4:5], v144 offset:2048
    ds_read_b64_tr_b16 v[6:7], v144 offset:2304
    ds_read_b64_tr_b16 v[8:9], v144 offset:32
    ds_read_b64_tr_b16 v[10:11], v144 offset:288
    ds_read_b64_tr_b16 v[12:13], v144 offset:2080
    ds_read_b64_tr_b16 v[14:15], v144 offset:2336
    ds_read_b64_tr_b16 v[16:17], v144 offset:4096
    ds_read_b64_tr_b16 v[18:19], v144 offset:4352
    ds_read_b64_tr_b16 v[20:21], v144 offset:6144
    ds_read_b64_tr_b16 v[22:23], v144 offset:6400
    ds_read_b64_tr_b16 v[24:25], v144 offset:4128
    ds_read_b64_tr_b16 v[26:27], v144 offset:4384
    ds_read_b64_tr_b16 v[28:29], v144 offset:6176
    ds_read_b64_tr_b16 v[30:31], v144 offset:6432
    s_mov_b32 s46, s42
    s_add_u32 s47, s42, 18432
    s_add_u32 s50, s42, 4096
    s_add_u32 s51, s42, 22528
    s_cmp_eq_u32 s4, 0
    s_cselect_b32 s48, 1, 0
    s_cmp_eq_u32 s4, 288
    s_cselect_b32 s48, 1, s48
    s_add_u32 s42, s42, 8192
    v_add_u32 v145, s6, v161
    v_add_u32 v145, 53248, v145
    ds_read_b32 v128, v145 offset:0
    ds_read_b32 v129, v145 offset:256
    ds_read_b32 v130, v145 offset:512
    ds_read_b32 v131, v145 offset:768
    ds_read_b32 v132, v145 offset:4096
    ds_read_b32 v133, v145 offset:4352
    ds_read_b32 v134, v145 offset:4608
    ds_read_b32 v135, v145 offset:4864
    s_waitcnt lgkmcnt(8)
    v_mfma_f32_16x16x32_bf16 v[32:35], v[0:3], v[64:67], 0
    v_mfma_f32_16x16x32_bf16 v[36:39], v[16:19], v[64:67], 0
    v_mfma_f32_16x16x32_bf16 v[40:43], v[8:11], v[64:67], 0
    v_mfma_f32_16x16x32_bf16 v[44:47], v[24:27], v[64:67], 0
    v_mfma_f32_16x16x32_bf16 v[32:35], v[16:19], v[72:75], v[32:35]
    v_mfma_f32_16x16x32_bf16 v[36:39], v[0:3], v[80:83], v[36:39]
    v_mfma_f32_16x16x32_bf16 v[40:43], v[24:27], v[72:75], v[40:43]
    v_mfma_f32_16x16x32_bf16 v[44:47], v[8:11], v[80:83], v[44:47]
    v_mfma_f32_16x16x32_bf16 v[32:35], v[4:7], v[68:71], v[32:35]
    v_mfma_f32_16x16x32_bf16 v[36:39], v[20:23], v[68:71], v[36:39]
    v_mfma_f32_16x16x32_bf16 v[40:43], v[12:15], v[68:71], v[40:43]
    v_mfma_f32_16x16x32_bf16 v[44:47], v[28:31], v[68:71], v[44:47]
    v_mfma_f32_16x16x32_bf16 v[32:35], v[20:23], v[76:79], v[32:35]
    v_mfma_f32_16x16x32_bf16 v[36:39], v[4:7], v[84:87], v[36:39]
    v_mfma_f32_16x16x32_bf16 v[40:43], v[28:31], v[76:79], v[40:43]
    v_mfma_f32_16x16x32_bf16 v[44:47], v[12:15], v[84:87], v[44:47]
    s_waitcnt lgkmcnt(0)
    s_nop 7
    v_mul_f32 v148, v32, v164
    v_mul_f32 v152, v36, v164
    v_mul_f32 v149, v33, v165
    v_mul_f32 v153, v37, v165
    v_mul_f32 v150, v34, v166
    v_mul_f32 v154, v38, v166
    v_mul_f32 v151, v35, v167
    v_mul_f32 v155, v39, v167
    v_fma_f32 v148, v36, v240, v148
    v_fma_f32 v152, -v32, v240, v152
    v_fma_f32 v149, v37, v241, v149
    v_fma_f32 v153, -v33, v241, v153
    v_fma_f32 v150, v38, v242, v150
    v_fma_f32 v154, -v34, v242, v154
    v_fma_f32 v151, v39, v243, v151
    v_fma_f32 v155, -v35, v243, v155
    v_cvt_pk_bf16_f32 v136, v148, v149
    v_cvt_pk_bf16_f32 v140, v152, v153
    v_cvt_pk_bf16_f32 v137, v150, v151
    v_cvt_pk_bf16_f32 v141, v154, v155
    v_mul_f32 v148, v40, v168
    v_mul_f32 v152, v44, v168
    v_mul_f32 v149, v41, v169
    v_mul_f32 v153, v45, v169
    v_mul_f32 v150, v42, v170
    v_mul_f32 v154, v46, v170
    v_mul_f32 v151, v43, v171
    v_mul_f32 v155, v47, v171
    v_fma_f32 v148, v44, v244, v148
    v_fma_f32 v152, -v40, v244, v152
    v_fma_f32 v149, v45, v245, v149
    v_fma_f32 v153, -v41, v245, v153
    v_fma_f32 v150, v46, v246, v150
    v_fma_f32 v154, -v42, v246, v154
    v_fma_f32 v151, v47, v247, v151
    v_fma_f32 v155, -v43, v247, v155
    v_cvt_pk_bf16_f32 v138, v148, v149
    v_cvt_pk_bf16_f32 v142, v152, v153
    v_cvt_pk_bf16_f32 v139, v150, v151
    v_cvt_pk_bf16_f32 v143, v154, v155
    s_nop 1
    v_mfma_f32_16x16x32_bf16 v[32:35], v[88:91], v[136:139], 0
    v_mfma_f32_16x16x32_bf16 v[36:39], v[88:91], v[140:143], 0
    v_mfma_f32_16x16x32_bf16 v[40:43], v[92:95], v[136:139], 0
    v_mfma_f32_16x16x32_bf16 v[44:47], v[92:95], v[140:143], 0
    v_mfma_f32_16x16x32_bf16 v[32:35], v[96:99], v[140:143], v[32:35]
    v_mfma_f32_16x16x32_bf16 v[36:39], v[104:107], v[136:139], v[36:39]
    v_mfma_f32_16x16x32_bf16 v[40:43], v[100:103], v[140:143], v[40:43]
    v_mfma_f32_16x16x32_bf16 v[44:47], v[108:111], v[136:139], v[44:47]
    s_nop 7
    v_lshlrev_b32 v144, 16, v128
    v_and_b32 v145, 0xffff0000, v128
    v_mul_f32 v148, v32, v144
    v_mul_f32 v152, v36, v144
    v_fma_f32 v148, -v36, v145, v148
    v_fmac_f32 v152, v32, v145
    v_lshlrev_b32 v146, 16, v129
    v_and_b32 v147, 0xffff0000, v129
    v_mul_f32 v149, v33, v146
    v_mul_f32 v153, v37, v146
    v_fma_f32 v149, -v37, v147, v149
    v_fmac_f32 v153, v33, v147
    v_lshlrev_b32 v144, 16, v130
    v_and_b32 v145, 0xffff0000, v130
    v_mul_f32 v150, v34, v144
    v_mul_f32 v154, v38, v144
    v_fma_f32 v150, -v38, v145, v150
    v_fmac_f32 v154, v34, v145
    v_lshlrev_b32 v146, 16, v131
    v_and_b32 v147, 0xffff0000, v131
    v_mul_f32 v151, v35, v146
    v_mul_f32 v155, v39, v146
    v_fma_f32 v151, -v39, v147, v151
    v_fmac_f32 v155, v35, v147
    v_cvt_pk_bf16_f32 v136, v148, v149
    v_cvt_pk_bf16_f32 v140, v152, v153
    v_cvt_pk_bf16_f32 v137, v150, v151
    v_cvt_pk_bf16_f32 v141, v154, v155
    v_lshlrev_b32 v144, 16, v132
    v_and_b32 v145, 0xffff0000, v132
    v_mul_f32 v148, v40, v144
    v_mul_f32 v152, v44, v144
    v_fma_f32 v148, -v44, v145, v148
    v_fmac_f32 v152, v40, v145
    v_lshlrev_b32 v146, 16, v133
    v_and_b32 v147, 0xffff0000, v133
    v_mul_f32 v149, v41, v146
    v_mul_f32 v153, v45, v146
    v_fma_f32 v149, -v45, v147, v149
    v_fmac_f32 v153, v41, v147
    v_lshlrev_b32 v144, 16, v134
    v_and_b32 v145, 0xffff0000, v134
    v_mul_f32 v150, v42, v144
    v_mul_f32 v154, v46, v144
    v_fma_f32 v150, -v46, v145, v150
    v_fmac_f32 v154, v42, v145
    v_lshlrev_b32 v146, 16, v135
    v_and_b32 v147, 0xffff0000, v135
    v_mul_f32 v151, v43, v146
    v_mul_f32 v155, v47, v146
    v_fma_f32 v151, -v47, v147, v151
    v_fmac_f32 v155, v43, v147
    v_cvt_pk_bf16_f32 v138, v148, v149
    v_cvt_pk_bf16_f32 v142, v152, v153
    v_cvt_pk_bf16_f32 v139, v150, v151
    v_cvt_pk_bf16_f32 v143, v154, v155
    s_nop 1
    v_mfma_f32_16x16x32_bf16 v[32:35], v[136:139], v[88:91], 0
    v_mfma_f32_16x16x32_bf16 v[36:39], v[140:143], v[88:91], 0
    v_mfma_f32_16x16x32_bf16 v[40:43], v[136:139], v[92:95], 0
    v_mfma_f32_16x16x32_bf16 v[44:47], v[140:143], v[92:95], 0
    v_mfma_f32_16x16x32_bf16 v[32:35], v[140:143], v[104:107], v[32:35]
    v_mfma_f32_16x16x32_bf16 v[36:39], v[136:139], v[96:99], v[36:39]
    v_mfma_f32_16x16x32_bf16 v[40:43], v[140:143], v[108:111], v[40:43]
    v_mfma_f32_16x16x32_bf16 v[44:47], v[136:139], v[100:103], v[44:47]
    s_nop 7
    v_mul_f32 v148, v32, v120
    v_mul_f32 v152, v36, v120
    v_mul_f32 v149, v33, v121
    v_mul_f32 v153, v37, v121
    v_mul_f32 v150, v34, v122
    v_mul_f32 v154, v38, v122
    v_mul_f32 v151, v35, v123
    v_mul_f32 v155, v39, v123
    v_fma_f32 v148, -v36, v112, v148
    v_fma_f32 v152, v32, v112, v152
    v_fma_f32 v149, -v37, v113, v149
    v_fma_f32 v153, v33, v113, v153
    v_fma_f32 v150, -v38, v114, v150
    v_fma_f32 v154, v34, v114, v154
    v_fma_f32 v151, -v39, v115, v151
    v_fma_f32 v155, v35, v115, v155
    v_cvt_pk_bf16_f32 v136, v148, v149
    v_cvt_pk_bf16_f32 v140, v152, v153
    v_cvt_pk_bf16_f32 v137, v150, v151
    v_cvt_pk_bf16_f32 v141, v154, v155
    v_mul_f32 v148, v40, v124
    v_mul_f32 v152, v44, v124
    v_mul_f32 v149, v41, v125
    v_mul_f32 v153, v45, v125
    v_mul_f32 v150, v42, v126
    v_mul_f32 v154, v46, v126
    v_mul_f32 v151, v43, v127
    v_mul_f32 v155, v47, v127
    v_fma_f32 v148, -v44, v116, v148
    v_fma_f32 v152, v40, v116, v152
    v_fma_f32 v149, -v45, v117, v149
    v_fma_f32 v153, v41, v117, v153
    v_fma_f32 v150, -v46, v118, v150
    v_fma_f32 v154, v42, v118, v154
    v_fma_f32 v151, -v47, v119, v151
    v_fma_f32 v155, v43, v119, v155
    v_cvt_pk_bf16_f32 v138, v148, v149
    v_cvt_pk_bf16_f32 v142, v152, v153
    v_cvt_pk_bf16_f32 v139, v150, v151
    v_cvt_pk_bf16_f32 v143, v154, v155
    ds_write_b64 v162, v[136:137] offset:32768
    ds_write_b64 v162, v[140:141] offset:37376
    ds_write_b64 v162, v[138:139] offset:35072
    ds_write_b64 v162, v[142:143] offset:39680
    s_waitcnt lgkmcnt(0)
    s_barrier
    ds_read_b128 v[0:3], v163 offset:32768
    ds_read_b128 v[4:7], v163 offset:32832
    ds_read_b128 v[8:11], v163 offset:33344
    ds_read_b128 v[12:15], v163 offset:33408
    ds_read_b128 v[16:19], v163 offset:37376
    ds_read_b128 v[20:23], v163 offset:37440
    ds_read_b128 v[24:27], v163 offset:37952
    ds_read_b128 v[28:31], v163 offset:38016
    s_waitcnt lgkmcnt(0)
    v_mfma_f32_16x16x32_bf16 v[32:35], v[0:3], v[64:67], 0
    v_mfma_f32_16x16x32_bf16 v[36:39], v[16:19], v[64:67], 0
    v_mfma_f32_16x16x32_bf16 v[40:43], v[8:11], v[64:67], 0
    v_mfma_f32_16x16x32_bf16 v[44:47], v[24:27], v[64:67], 0
    v_mfma_f32_16x16x32_bf16 v[32:35], v[16:19], v[80:83], v[32:35]
    v_mfma_f32_16x16x32_bf16 v[36:39], v[0:3], v[72:75], v[36:39]
    v_mfma_f32_16x16x32_bf16 v[40:43], v[24:27], v[80:83], v[40:43]
    v_mfma_f32_16x16x32_bf16 v[44:47], v[8:11], v[72:75], v[44:47]
    v_mfma_f32_16x16x32_bf16 v[32:35], v[4:7], v[68:71], v[32:35]
    v_mfma_f32_16x16x32_bf16 v[36:39], v[20:23], v[68:71], v[36:39]
    v_mfma_f32_16x16x32_bf16 v[40:43], v[12:15], v[68:71], v[40:43]
    v_mfma_f32_16x16x32_bf16 v[44:47], v[28:31], v[68:71], v[44:47]
    v_mfma_f32_16x16x32_bf16 v[32:35], v[20:23], v[84:87], v[32:35]
    v_mfma_f32_16x16x32_bf16 v[36:39], v[4:7], v[76:79], v[36:39]
    v_mfma_f32_16x16x32_bf16 v[40:43], v[28:31], v[84:87], v[40:43]
    v_mfma_f32_16x16x32_bf16 v[44:47], v[12:15], v[76:79], v[44:47]
    s_nop 7
    v_cvt_pk_bf16_f32 v136, v32, v33
    v_cvt_pk_bf16_f32 v140, v36, v37
    v_cvt_pk_bf16_f32 v137, v34, v35
    v_cvt_pk_bf16_f32 v141, v38, v39
    v_cvt_pk_bf16_f32 v138, v40, v41
    v_cvt_pk_bf16_f32 v142, v44, v45
    v_cvt_pk_bf16_f32 v139, v42, v43
    v_cvt_pk_bf16_f32 v143, v46, v47
    s_cmp_eq_u32 s48, 1
    s_cselect_b32 s18, 0, 268435456
    buffer_store_dwordx4 v[136:139], v172, s[8:11], s46 offen sc1
    buffer_store_dwordx4 v[140:143], v172, s[16:19], s47 offen sc1
gm_l2_kernel_cole:
    s_waitcnt vmcnt(0)
    s_barrier
    s_cmp_eq_u32 s3, 0
    s_cbranch_scc0 gm_l2_kernel_fin
    s_xor_b32 s52, s5, 0
    s_lshl_b32 s52, s52, 2
    s_add_u32 s52, s52, 37789696
    v_mov_b32 v144, 1
    v_lshlrev_b32 v145, 8, v192
    v_cmp_gt_u32 vcc, 8, v192
    s_and_saveexec_b64 s[54:55], vcc
    buffer_store_dword v144, v145, s[8:11], s52 offen sc1
    s_mov_b64 exec, s[54:55]
gm_l2_kernel_fin:
gm_l2_kernel_end:
    s_endpgm
.section .rodata,"a"
.p2align 6
.amdhsa_kernel gated_mix__spectral_gfnet__glu_gated_geglu__prompt_kernel
  .amdhsa_next_free_vgpr 512
  .amdhsa_next_free_sgpr 102
  .amdhsa_accum_offset 256
  .amdhsa_group_segment_fixed_size 0
  .amdhsa_kernarg_size 88
  .amdhsa_user_sgpr_count 2
  .amdhsa_user_sgpr_kernarg_segment_ptr 1
  .amdhsa_system_sgpr_workgroup_id_x 1
  .amdhsa_float_denorm_mode_32 3
.end_amdhsa_kernel
```
